```python
import torch

def _softmax(x, axis=-1):
    return torch.softmax(x, dim=axis)
def _gelu(x):
    return torch.nn.functional.gelu(x, approximate="tanh")
def _silu(x):
    return torch.nn.functional.silu(x)
def _sigmoid(x):
    return torch.sigmoid(x)
def _layernorm(x, axis=-1, eps=1e-5):
    m = x.mean(dim=axis, keepdim=True)
    v = x.var(dim=axis, keepdim=True, unbiased=False)
    return (x - m) / torch.sqrt(v + eps)
def _scatter_add(tgt, idx, src, axis=0):
    return tgt.clone().index_add_(axis, idx, src)
def _segment_sum(src, seg, n):
    out = torch.zeros((n,) + src.shape[1:], dtype=src.dtype)
    return out.index_add_(0, seg, src)
def _pad(x, pw):
    flat = tuple(v for pair in reversed(pw) for v in pair)
    return torch.nn.functional.pad(x, flat)

kernel_name = 'parallel_sum__ssm_conv_h3__glu_gated_bilinear__prompt'

def setup_inputs():

    _w = (lambda a: (lambda t: t.to(torch.bfloat16) if t.is_floating_point() else t)(torch.as_tensor(a)))
    def _A_setup():
        B, S, D = 1, 2048, 576
        ks = 4
        return {
            "q": _w((lambda *s: torch.randn(*s, dtype=torch.bfloat16) * 0.05)(B, S, D)),
            "k": _w((lambda *s: torch.randn(*s, dtype=torch.bfloat16) * 0.2)(B, S, D)),
            "v": _w((lambda *s: torch.randn(*s, dtype=torch.bfloat16) * 0.2)(B, S, D)),
            "shift_k": _w((lambda *s: torch.randn(*s, dtype=torch.bfloat16) * 0.2)(D, ks) * 0.5),
            "ssm_k": _w((lambda *s: torch.randn(*s, dtype=torch.bfloat16) * 0.4)(D, S) * (1.0 / S ** 0.5)),
            "ssm_D": _w((lambda *s: torch.randn(*s, dtype=torch.bfloat16) * 0.2)(D)),
        }
    _A_in = _A_setup()

    def _B_setup():
        B, S, D, F = 1, 2048, 576, 4608
        return {
            "x": _w((lambda *s: torch.randn(*s, dtype=torch.bfloat16) * 0.05)(B, S, D)),
            "w_gate": _w((lambda *s: torch.randn(*s, dtype=torch.bfloat16) * 0.2)(D, F) * (D ** -0.5)),
            "w_up": _w((lambda *s: torch.randn(*s, dtype=torch.bfloat16) * 0.2)(D, F) * (D ** -0.5)),
            "w_down": _w((lambda *s: torch.randn(*s, dtype=torch.bfloat16) * 0.2)(F, D) * (F ** -0.5)),
        }
    _B_in = _B_setup()

    return {
        "A_q": _A_in["q"],
        "A_k": _A_in["k"],
        "A_v": _A_in["v"],
        "A_shift_k": _A_in["shift_k"],
        "A_ssm_k": _A_in["ssm_k"],
        "A_ssm_D": _A_in["ssm_D"],
        "B_x": _B_in["x"],
        "B_w_gate": _B_in["w_gate"],
        "B_w_up": _B_in["w_up"],
        "B_w_down": _B_in["w_down"],
    }

def reference(A_q, A_k, A_v, A_shift_k, A_ssm_k, A_ssm_D, B_x, B_w_gate, B_w_up, B_w_down):
    def _A_ref(q, k, v, shift_k, ssm_k, ssm_D):
        B, S, D = q.shape
        ks = shift_k.shape[-1]
        k_pad = _pad(k, ((0, 0), (ks - 1, 0), (0, 0)))
        k_shift = torch.zeros_like(k)
        for t in range(ks):
            k_shift = k_shift + k_pad[:, t:t + S, :] * shift_k[:, ks - 1 - t][None, None, :]
        kv = k_shift * v
        L = 2 * S
        kv_pad = _pad(kv, ((0, 0), (0, S), (0, 0)))
        kf_pad = _pad(ssm_k, ((0, 0), (0, S)))
        kv_f = (lambda x, axes=(-2,-1): torch.fft.rfft2(x.float(), dim=axes))(kv_pad[:, None, :, :], axes=(1, 2))
        kf_f = (lambda x, axes=(-2,-1): torch.fft.rfft2(x.float(), dim=axes))(kf_pad[:, None, :], axes=(1, 2))
        kf_f = (lambda x, *d: x.permute(*d))(kf_f, 1, 2, 0)
        y_f = kv_f * kf_f[None, :, :, :]
        y = (lambda x, s, axes=(-2,-1): torch.fft.irfft2(x, s=s, dim=axes).to(torch.bfloat16))(y_f, (1, L), axes=(1, 2))[:, 0, :S, :]
        y = y + kv * ssm_D[None, None, :]
        return q * y

    def _B_ref(x, w_gate, w_up, w_down):
        g = torch.einsum("bsd,df->bsf", x, w_gate)
        u = torch.einsum("bsd,df->bsf", x, w_up)
        h = g * u
        return torch.einsum("bsf,fd->bsd", h, w_down)

    x = A_q
    xn = _layernorm(x, axis=-1)
    return x + _A_ref(xn, A_k, A_v, A_shift_k, A_ssm_k, A_ssm_D) + _B_ref(xn, B_w_gate, B_w_up, B_w_down)
```

```asm
; @launch kernel=prep_kernel grid=(464,1,1) block=(256,1,1) lds=0
; @launch kernel=gemm1_kernel grid=(256,1,1) block=(256,1,1) lds=147456
; @launch kernel=gemm2_kernel grid=(256,1,1) block=(512,1,1) lds=163840
; @launch kernel=final_kernel grid=(1152,1,1) block=(256,1,1) lds=0
.amdgcn_target "amdgcn-amd-amdhsa--gfx950"
.text
.globl prep_kernel
.p2align 8
.type prep_kernel,@function
prep_kernel:

    s_cmp_ge_u32 s2, 464
    s_cbranch_scc1 L_prep_exit
    s_load_dwordx4 s[4:7], s[0:1], 0
    s_load_dwordx4 s[8:11], s[0:1], 16
    s_load_dwordx4 s[12:15], s[0:1], 32
    s_load_dwordx2 s[16:17], s[0:1], 96
    s_waitcnt lgkmcnt(0)
    s_cmp_ge_u32 s2, 208
    s_cbranch_scc1 L_prep_pf
    s_cmp_ge_u32 s2, 64
    s_cbranch_scc1 L_prep_kv
    s_mov_b32 s20, s4
    s_mov_b32 s21, s5
    s_mov_b32 s22, 2359296
    s_mov_b32 s23, 0x00020000
    s_mov_b32 s24, s16
    s_mov_b32 s25, s17
    s_mov_b32 s26, 2359296
    s_mov_b32 s27, 0x00020000
    s_add_u32 s28, s16, 2359296
    s_addc_u32 s29, s17, 0
    s_mov_b32 s30, 2359296
    s_mov_b32 s31, 0x00020000
    s_lshl_b32 s3, s2, 5
    v_lshrrev_b32 v3, 3, v0
    v_add_u32 v3, s3, v3
    v_and_b32 v4, 7, v0
    s_movk_i32 s73, 1152
    v_mul_lo_u32 v5, v3, s73
    v_lshl_add_u32 v5, v4, 4, v5
    buffer_load_dwordx4 v[8:11], v5, s[20:23], 0 offen offset:0
    buffer_load_dwordx4 v[12:15], v5, s[20:23], 0 offen offset:128
    buffer_load_dwordx4 v[16:19], v5, s[20:23], 0 offen offset:256
    buffer_load_dwordx4 v[20:23], v5, s[20:23], 0 offen offset:384
    buffer_load_dwordx4 v[24:27], v5, s[20:23], 0 offen offset:512
    buffer_load_dwordx4 v[28:31], v5, s[20:23], 0 offen offset:640
    buffer_load_dwordx4 v[32:35], v5, s[20:23], 0 offen offset:768
    buffer_load_dwordx4 v[36:39], v5, s[20:23], 0 offen offset:896
    buffer_load_dwordx4 v[40:43], v5, s[20:23], 0 offen offset:1024
    s_mov_b32 s70, 0x3ae38e39
    s_mov_b32 s71, 0x44100000
    s_mov_b32 s72, 0x3727c5ac
    v_lshrrev_b32 v6, 4, v3
    s_movk_i32 s73, 18432
    v_mul_lo_u32 v6, v6, s73
    v_lshrrev_b32 v7, 2, v4
    v_lshl_add_u32 v6, v7, 10, v6
    v_and_b32 v7, 3, v4
    v_lshl_add_u32 v6, v7, 8, v6
    v_and_b32 v7, 15, v3
    v_lshl_add_u32 v6, v7, 4, v6
    s_waitcnt vmcnt(0) lgkmcnt(0)
    v_lshlrev_b32 v44, 16, v8
    v_and_b32 v45, 0xffff0000, v8
    v_lshlrev_b32 v46, 16, v9
    v_and_b32 v47, 0xffff0000, v9
    v_lshlrev_b32 v48, 16, v10
    v_and_b32 v49, 0xffff0000, v10
    v_lshlrev_b32 v50, 16, v11
    v_and_b32 v51, 0xffff0000, v11
    v_lshlrev_b32 v52, 16, v12
    v_and_b32 v53, 0xffff0000, v12
    v_lshlrev_b32 v54, 16, v13
    v_and_b32 v55, 0xffff0000, v13
    v_lshlrev_b32 v56, 16, v14
    v_and_b32 v57, 0xffff0000, v14
    v_lshlrev_b32 v58, 16, v15
    v_and_b32 v59, 0xffff0000, v15
    v_lshlrev_b32 v60, 16, v16
    v_and_b32 v61, 0xffff0000, v16
    v_lshlrev_b32 v62, 16, v17
    v_and_b32 v63, 0xffff0000, v17
    v_lshlrev_b32 v64, 16, v18
    v_and_b32 v65, 0xffff0000, v18
    v_lshlrev_b32 v66, 16, v19
    v_and_b32 v67, 0xffff0000, v19
    v_lshlrev_b32 v68, 16, v20
    v_and_b32 v69, 0xffff0000, v20
    v_lshlrev_b32 v70, 16, v21
    v_and_b32 v71, 0xffff0000, v21
    v_lshlrev_b32 v72, 16, v22
    v_and_b32 v73, 0xffff0000, v22
    v_lshlrev_b32 v74, 16, v23
    v_and_b32 v75, 0xffff0000, v23
    v_lshlrev_b32 v76, 16, v24
    v_and_b32 v77, 0xffff0000, v24
    v_lshlrev_b32 v78, 16, v25
    v_and_b32 v79, 0xffff0000, v25
    v_lshlrev_b32 v80, 16, v26
    v_and_b32 v81, 0xffff0000, v26
    v_lshlrev_b32 v82, 16, v27
    v_and_b32 v83, 0xffff0000, v27
    v_lshlrev_b32 v84, 16, v28
    v_and_b32 v85, 0xffff0000, v28
    v_lshlrev_b32 v86, 16, v29
    v_and_b32 v87, 0xffff0000, v29
    v_lshlrev_b32 v88, 16, v30
    v_and_b32 v89, 0xffff0000, v30
    v_lshlrev_b32 v90, 16, v31
    v_and_b32 v91, 0xffff0000, v31
    v_lshlrev_b32 v92, 16, v32
    v_and_b32 v93, 0xffff0000, v32
    v_lshlrev_b32 v94, 16, v33
    v_and_b32 v95, 0xffff0000, v33
    v_lshlrev_b32 v96, 16, v34
    v_and_b32 v97, 0xffff0000, v34
    v_lshlrev_b32 v98, 16, v35
    v_and_b32 v99, 0xffff0000, v35
    v_lshlrev_b32 v100, 16, v36
    v_and_b32 v101, 0xffff0000, v36
    v_lshlrev_b32 v102, 16, v37
    v_and_b32 v103, 0xffff0000, v37
    v_lshlrev_b32 v104, 16, v38
    v_and_b32 v105, 0xffff0000, v38
    v_lshlrev_b32 v106, 16, v39
    v_and_b32 v107, 0xffff0000, v39
    v_lshlrev_b32 v108, 16, v40
    v_and_b32 v109, 0xffff0000, v40
    v_lshlrev_b32 v110, 16, v41
    v_and_b32 v111, 0xffff0000, v41
    v_lshlrev_b32 v112, 16, v42
    v_and_b32 v113, 0xffff0000, v42
    v_lshlrev_b32 v114, 16, v43
    v_and_b32 v115, 0xffff0000, v43
    v_add_f32 v116, v44, v48
    v_add_f32 v117, v45, v49
    v_add_f32 v118, v46, v50
    v_add_f32 v119, v47, v51
    v_add_f32 v116, v116, v52
    v_add_f32 v117, v117, v53
    v_add_f32 v118, v118, v54
    v_add_f32 v119, v119, v55
    v_add_f32 v116, v116, v56
    v_add_f32 v117, v117, v57
    v_add_f32 v118, v118, v58
    v_add_f32 v119, v119, v59
    v_add_f32 v116, v116, v60
    v_add_f32 v117, v117, v61
    v_add_f32 v118, v118, v62
    v_add_f32 v119, v119, v63
    v_add_f32 v116, v116, v64
    v_add_f32 v117, v117, v65
    v_add_f32 v118, v118, v66
    v_add_f32 v119, v119, v67
    v_add_f32 v116, v116, v68
    v_add_f32 v117, v117, v69
    v_add_f32 v118, v118, v70
    v_add_f32 v119, v119, v71
    v_add_f32 v116, v116, v72
    v_add_f32 v117, v117, v73
    v_add_f32 v118, v118, v74
    v_add_f32 v119, v119, v75
    v_add_f32 v116, v116, v76
    v_add_f32 v117, v117, v77
    v_add_f32 v118, v118, v78
    v_add_f32 v119, v119, v79
    v_add_f32 v116, v116, v80
    v_add_f32 v117, v117, v81
    v_add_f32 v118, v118, v82
    v_add_f32 v119, v119, v83
    v_add_f32 v116, v116, v84
    v_add_f32 v117, v117, v85
    v_add_f32 v118, v118, v86
    v_add_f32 v119, v119, v87
    v_add_f32 v116, v116, v88
    v_add_f32 v117, v117, v89
    v_add_f32 v118, v118, v90
    v_add_f32 v119, v119, v91
    v_add_f32 v116, v116, v92
    v_add_f32 v117, v117, v93
    v_add_f32 v118, v118, v94
    v_add_f32 v119, v119, v95
    v_add_f32 v116, v116, v96
    v_add_f32 v117, v117, v97
    v_add_f32 v118, v118, v98
    v_add_f32 v119, v119, v99
    v_add_f32 v116, v116, v100
    v_add_f32 v117, v117, v101
    v_add_f32 v118, v118, v102
    v_add_f32 v119, v119, v103
    v_add_f32 v116, v116, v104
    v_add_f32 v117, v117, v105
    v_add_f32 v118, v118, v106
    v_add_f32 v119, v119, v107
    v_add_f32 v116, v116, v108
    v_add_f32 v117, v117, v109
    v_add_f32 v118, v118, v110
    v_add_f32 v119, v119, v111
    v_add_f32 v116, v116, v112
    v_add_f32 v117, v117, v113
    v_add_f32 v118, v118, v114
    v_add_f32 v119, v119, v115
    v_add_f32 v116, v116, v117
    v_add_f32 v118, v118, v119
    v_add_f32 v116, v116, v118
    s_nop 1
    v_add_f32_dpp v117, v116, v116 quad_perm:[1,0,3,2] row_mask:0xf bank_mask:0xf
    s_nop 1
    v_add_f32_dpp v116, v117, v117 quad_perm:[2,3,0,1] row_mask:0xf bank_mask:0xf
    s_nop 1
    v_add_f32_dpp v117, v116, v116 row_half_mirror row_mask:0xf bank_mask:0xf
    v_mov_b32 v116, v117
    v_mul_f32 v117, s70, v116
    v_fma_f32 v118, -v117, s71, v116
    v_fma_f32 v116, v118, s70, v117
    v_mov_b32 v120, 0
    v_mov_b32 v121, 0
    v_mov_b32 v122, 0
    v_mov_b32 v123, 0
    v_sub_f32 v124, v44, v116
    v_fmac_f32 v120, v124, v124
    v_sub_f32 v125, v45, v116
    v_fmac_f32 v121, v125, v125
    v_sub_f32 v124, v46, v116
    v_fmac_f32 v122, v124, v124
    v_sub_f32 v125, v47, v116
    v_fmac_f32 v123, v125, v125
    v_sub_f32 v124, v48, v116
    v_fmac_f32 v120, v124, v124
    v_sub_f32 v125, v49, v116
    v_fmac_f32 v121, v125, v125
    v_sub_f32 v124, v50, v116
    v_fmac_f32 v122, v124, v124
    v_sub_f32 v125, v51, v116
    v_fmac_f32 v123, v125, v125
    v_sub_f32 v124, v52, v116
    v_fmac_f32 v120, v124, v124
    v_sub_f32 v125, v53, v116
    v_fmac_f32 v121, v125, v125
    v_sub_f32 v124, v54, v116
    v_fmac_f32 v122, v124, v124
    v_sub_f32 v125, v55, v116
    v_fmac_f32 v123, v125, v125
    v_sub_f32 v124, v56, v116
    v_fmac_f32 v120, v124, v124
    v_sub_f32 v125, v57, v116
    v_fmac_f32 v121, v125, v125
    v_sub_f32 v124, v58, v116
    v_fmac_f32 v122, v124, v124
    v_sub_f32 v125, v59, v116
    v_fmac_f32 v123, v125, v125
    v_sub_f32 v124, v60, v116
    v_fmac_f32 v120, v124, v124
    v_sub_f32 v125, v61, v116
    v_fmac_f32 v121, v125, v125
    v_sub_f32 v124, v62, v116
    v_fmac_f32 v122, v124, v124
    v_sub_f32 v125, v63, v116
    v_fmac_f32 v123, v125, v125
    v_sub_f32 v124, v64, v116
    v_fmac_f32 v120, v124, v124
    v_sub_f32 v125, v65, v116
    v_fmac_f32 v121, v125, v125
    v_sub_f32 v124, v66, v116
    v_fmac_f32 v122, v124, v124
    v_sub_f32 v125, v67, v116
    v_fmac_f32 v123, v125, v125
    v_sub_f32 v124, v68, v116
    v_fmac_f32 v120, v124, v124
    v_sub_f32 v125, v69, v116
    v_fmac_f32 v121, v125, v125
    v_sub_f32 v124, v70, v116
    v_fmac_f32 v122, v124, v124
    v_sub_f32 v125, v71, v116
    v_fmac_f32 v123, v125, v125
    v_sub_f32 v124, v72, v116
    v_fmac_f32 v120, v124, v124
    v_sub_f32 v125, v73, v116
    v_fmac_f32 v121, v125, v125
    v_sub_f32 v124, v74, v116
    v_fmac_f32 v122, v124, v124
    v_sub_f32 v125, v75, v116
    v_fmac_f32 v123, v125, v125
    v_sub_f32 v124, v76, v116
    v_fmac_f32 v120, v124, v124
    v_sub_f32 v125, v77, v116
    v_fmac_f32 v121, v125, v125
    v_sub_f32 v124, v78, v116
    v_fmac_f32 v122, v124, v124
    v_sub_f32 v125, v79, v116
    v_fmac_f32 v123, v125, v125
    v_sub_f32 v124, v80, v116
    v_fmac_f32 v120, v124, v124
    v_sub_f32 v125, v81, v116
    v_fmac_f32 v121, v125, v125
    v_sub_f32 v124, v82, v116
    v_fmac_f32 v122, v124, v124
    v_sub_f32 v125, v83, v116
    v_fmac_f32 v123, v125, v125
    v_sub_f32 v124, v84, v116
    v_fmac_f32 v120, v124, v124
    v_sub_f32 v125, v85, v116
    v_fmac_f32 v121, v125, v125
    v_sub_f32 v124, v86, v116
    v_fmac_f32 v122, v124, v124
    v_sub_f32 v125, v87, v116
    v_fmac_f32 v123, v125, v125
    v_sub_f32 v124, v88, v116
    v_fmac_f32 v120, v124, v124
    v_sub_f32 v125, v89, v116
    v_fmac_f32 v121, v125, v125
    v_sub_f32 v124, v90, v116
    v_fmac_f32 v122, v124, v124
    v_sub_f32 v125, v91, v116
    v_fmac_f32 v123, v125, v125
    v_sub_f32 v124, v92, v116
    v_fmac_f32 v120, v124, v124
    v_sub_f32 v125, v93, v116
    v_fmac_f32 v121, v125, v125
    v_sub_f32 v124, v94, v116
    v_fmac_f32 v122, v124, v124
    v_sub_f32 v125, v95, v116
    v_fmac_f32 v123, v125, v125
    v_sub_f32 v124, v96, v116
    v_fmac_f32 v120, v124, v124
    v_sub_f32 v125, v97, v116
    v_fmac_f32 v121, v125, v125
    v_sub_f32 v124, v98, v116
    v_fmac_f32 v122, v124, v124
    v_sub_f32 v125, v99, v116
    v_fmac_f32 v123, v125, v125
    v_sub_f32 v124, v100, v116
    v_fmac_f32 v120, v124, v124
    v_sub_f32 v125, v101, v116
    v_fmac_f32 v121, v125, v125
    v_sub_f32 v124, v102, v116
    v_fmac_f32 v122, v124, v124
    v_sub_f32 v125, v103, v116
    v_fmac_f32 v123, v125, v125
    v_sub_f32 v124, v104, v116
    v_fmac_f32 v120, v124, v124
    v_sub_f32 v125, v105, v116
    v_fmac_f32 v121, v125, v125
    v_sub_f32 v124, v106, v116
    v_fmac_f32 v122, v124, v124
    v_sub_f32 v125, v107, v116
    v_fmac_f32 v123, v125, v125
    v_sub_f32 v124, v108, v116
    v_fmac_f32 v120, v124, v124
    v_sub_f32 v125, v109, v116
    v_fmac_f32 v121, v125, v125
    v_sub_f32 v124, v110, v116
    v_fmac_f32 v122, v124, v124
    v_sub_f32 v125, v111, v116
    v_fmac_f32 v123, v125, v125
    v_sub_f32 v124, v112, v116
    v_fmac_f32 v120, v124, v124
    v_sub_f32 v125, v113, v116
    v_fmac_f32 v121, v125, v125
    v_sub_f32 v124, v114, v116
    v_fmac_f32 v122, v124, v124
    v_sub_f32 v125, v115, v116
    v_fmac_f32 v123, v125, v125
    v_add_f32 v120, v120, v121
    v_add_f32 v122, v122, v123
    v_add_f32 v120, v120, v122
    s_nop 1
    v_add_f32_dpp v121, v120, v120 quad_perm:[1,0,3,2] row_mask:0xf bank_mask:0xf
    s_nop 1
    v_add_f32_dpp v120, v121, v121 quad_perm:[2,3,0,1] row_mask:0xf bank_mask:0xf
    s_nop 1
    v_add_f32_dpp v121, v120, v120 row_half_mirror row_mask:0xf bank_mask:0xf
    v_mov_b32 v120, v121
    v_mul_f32 v121, s70, v120
    v_fma_f32 v122, -v121, s71, v120
    v_fma_f32 v120, v122, s70, v121
    v_cvt_pk_bf16_f32 v120, v120, v120
    v_lshlrev_b32 v120, 16, v120
    v_cvt_pk_bf16_f32 v116, v116, v116
    v_lshlrev_b32 v116, 16, v116
    v_add_f32 v120, s72, v120
    v_cvt_pk_bf16_f32 v120, v120, v120
    v_lshlrev_b32 v120, 16, v120
    v_sqrt_f32 v120, v120
    s_nop 0
    v_cvt_pk_bf16_f32 v120, v120, v120
    v_lshlrev_b32 v120, 16, v120
    v_rcp_f32 v121, v120
    s_nop 0
    v_fma_f32 v122, -v120, v121, 1.0
    v_fma_f32 v121, v122, v121, v121
    v_sub_f32 v44, v44, v116
    v_sub_f32 v45, v45, v116
    v_cvt_pk_bf16_f32 v124, v44, v45
    v_lshlrev_b32 v44, 16, v124
    v_and_b32 v45, 0xffff0000, v124
    v_mul_f32 v125, v44, v121
    v_mul_f32 v126, v45, v121
    v_fma_f32 v44, -v125, v120, v44
    v_fma_f32 v45, -v126, v120, v45
    v_fma_f32 v125, v44, v121, v125
    v_fma_f32 v126, v45, v121, v126
    v_cvt_pk_bf16_f32 v8, v125, v126
    v_sub_f32 v46, v46, v116
    v_sub_f32 v47, v47, v116
    v_cvt_pk_bf16_f32 v124, v46, v47
    v_lshlrev_b32 v46, 16, v124
    v_and_b32 v47, 0xffff0000, v124
    v_mul_f32 v125, v46, v121
    v_mul_f32 v126, v47, v121
    v_fma_f32 v46, -v125, v120, v46
    v_fma_f32 v47, -v126, v120, v47
    v_fma_f32 v125, v46, v121, v125
    v_fma_f32 v126, v47, v121, v126
    v_cvt_pk_bf16_f32 v9, v125, v126
    v_sub_f32 v48, v48, v116
    v_sub_f32 v49, v49, v116
    v_cvt_pk_bf16_f32 v124, v48, v49
    v_lshlrev_b32 v48, 16, v124
    v_and_b32 v49, 0xffff0000, v124
    v_mul_f32 v125, v48, v121
    v_mul_f32 v126, v49, v121
    v_fma_f32 v48, -v125, v120, v48
    v_fma_f32 v49, -v126, v120, v49
    v_fma_f32 v125, v48, v121, v125
    v_fma_f32 v126, v49, v121, v126
    v_cvt_pk_bf16_f32 v10, v125, v126
    v_sub_f32 v50, v50, v116
    v_sub_f32 v51, v51, v116
    v_cvt_pk_bf16_f32 v124, v50, v51
    v_lshlrev_b32 v50, 16, v124
    v_and_b32 v51, 0xffff0000, v124
    v_mul_f32 v125, v50, v121
    v_mul_f32 v126, v51, v121
    v_fma_f32 v50, -v125, v120, v50
    v_fma_f32 v51, -v126, v120, v51
    v_fma_f32 v125, v50, v121, v125
    v_fma_f32 v126, v51, v121, v126
    v_cvt_pk_bf16_f32 v11, v125, v126
    s_movk_i32 s73, 0
    buffer_store_dwordx4 v[8:11], v6, s[24:27], s73 offen
    buffer_store_dwordx4 v[8:11], v5, s[28:31], 0 offen offset:0
    v_sub_f32 v52, v52, v116
    v_sub_f32 v53, v53, v116
    v_cvt_pk_bf16_f32 v124, v52, v53
    v_lshlrev_b32 v52, 16, v124
    v_and_b32 v53, 0xffff0000, v124
    v_mul_f32 v125, v52, v121
    v_mul_f32 v126, v53, v121
    v_fma_f32 v52, -v125, v120, v52
    v_fma_f32 v53, -v126, v120, v53
    v_fma_f32 v125, v52, v121, v125
    v_fma_f32 v126, v53, v121, v126
    v_cvt_pk_bf16_f32 v12, v125, v126
    v_sub_f32 v54, v54, v116
    v_sub_f32 v55, v55, v116
    v_cvt_pk_bf16_f32 v124, v54, v55
    v_lshlrev_b32 v54, 16, v124
    v_and_b32 v55, 0xffff0000, v124
    v_mul_f32 v125, v54, v121
    v_mul_f32 v126, v55, v121
    v_fma_f32 v54, -v125, v120, v54
    v_fma_f32 v55, -v126, v120, v55
    v_fma_f32 v125, v54, v121, v125
    v_fma_f32 v126, v55, v121, v126
    v_cvt_pk_bf16_f32 v13, v125, v126
    v_sub_f32 v56, v56, v116
    v_sub_f32 v57, v57, v116
    v_cvt_pk_bf16_f32 v124, v56, v57
    v_lshlrev_b32 v56, 16, v124
    v_and_b32 v57, 0xffff0000, v124
    v_mul_f32 v125, v56, v121
    v_mul_f32 v126, v57, v121
    v_fma_f32 v56, -v125, v120, v56
    v_fma_f32 v57, -v126, v120, v57
    v_fma_f32 v125, v56, v121, v125
    v_fma_f32 v126, v57, v121, v126
    v_cvt_pk_bf16_f32 v14, v125, v126
    v_sub_f32 v58, v58, v116
    v_sub_f32 v59, v59, v116
    v_cvt_pk_bf16_f32 v124, v58, v59
    v_lshlrev_b32 v58, 16, v124
    v_and_b32 v59, 0xffff0000, v124
    v_mul_f32 v125, v58, v121
    v_mul_f32 v126, v59, v121
    v_fma_f32 v58, -v125, v120, v58
    v_fma_f32 v59, -v126, v120, v59
    v_fma_f32 v125, v58, v121, v125
    v_fma_f32 v126, v59, v121, v126
    v_cvt_pk_bf16_f32 v15, v125, v126
    s_movk_i32 s73, 2048
    buffer_store_dwordx4 v[12:15], v6, s[24:27], s73 offen
    buffer_store_dwordx4 v[12:15], v5, s[28:31], 0 offen offset:128
    v_sub_f32 v60, v60, v116
    v_sub_f32 v61, v61, v116
    v_cvt_pk_bf16_f32 v124, v60, v61
    v_lshlrev_b32 v60, 16, v124
    v_and_b32 v61, 0xffff0000, v124
    v_mul_f32 v125, v60, v121
    v_mul_f32 v126, v61, v121
    v_fma_f32 v60, -v125, v120, v60
    v_fma_f32 v61, -v126, v120, v61
    v_fma_f32 v125, v60, v121, v125
    v_fma_f32 v126, v61, v121, v126
    v_cvt_pk_bf16_f32 v16, v125, v126
    v_sub_f32 v62, v62, v116
    v_sub_f32 v63, v63, v116
    v_cvt_pk_bf16_f32 v124, v62, v63
    v_lshlrev_b32 v62, 16, v124
    v_and_b32 v63, 0xffff0000, v124
    v_mul_f32 v125, v62, v121
    v_mul_f32 v126, v63, v121
    v_fma_f32 v62, -v125, v120, v62
    v_fma_f32 v63, -v126, v120, v63
    v_fma_f32 v125, v62, v121, v125
    v_fma_f32 v126, v63, v121, v126
    v_cvt_pk_bf16_f32 v17, v125, v126
    v_sub_f32 v64, v64, v116
    v_sub_f32 v65, v65, v116
    v_cvt_pk_bf16_f32 v124, v64, v65
    v_lshlrev_b32 v64, 16, v124
    v_and_b32 v65, 0xffff0000, v124
    v_mul_f32 v125, v64, v121
    v_mul_f32 v126, v65, v121
    v_fma_f32 v64, -v125, v120, v64
    v_fma_f32 v65, -v126, v120, v65
    v_fma_f32 v125, v64, v121, v125
    v_fma_f32 v126, v65, v121, v126
    v_cvt_pk_bf16_f32 v18, v125, v126
    v_sub_f32 v66, v66, v116
    v_sub_f32 v67, v67, v116
    v_cvt_pk_bf16_f32 v124, v66, v67
    v_lshlrev_b32 v66, 16, v124
    v_and_b32 v67, 0xffff0000, v124
    v_mul_f32 v125, v66, v121
    v_mul_f32 v126, v67, v121
    v_fma_f32 v66, -v125, v120, v66
    v_fma_f32 v67, -v126, v120, v67
    v_fma_f32 v125, v66, v121, v125
    v_fma_f32 v126, v67, v121, v126
    v_cvt_pk_bf16_f32 v19, v125, v126
    s_movk_i32 s73, 4096
    buffer_store_dwordx4 v[16:19], v6, s[24:27], s73 offen
    buffer_store_dwordx4 v[16:19], v5, s[28:31], 0 offen offset:256
    v_sub_f32 v68, v68, v116
    v_sub_f32 v69, v69, v116
    v_cvt_pk_bf16_f32 v124, v68, v69
    v_lshlrev_b32 v68, 16, v124
    v_and_b32 v69, 0xffff0000, v124
    v_mul_f32 v125, v68, v121
    v_mul_f32 v126, v69, v121
    v_fma_f32 v68, -v125, v120, v68
    v_fma_f32 v69, -v126, v120, v69
    v_fma_f32 v125, v68, v121, v125
    v_fma_f32 v126, v69, v121, v126
    v_cvt_pk_bf16_f32 v20, v125, v126
    v_sub_f32 v70, v70, v116
    v_sub_f32 v71, v71, v116
    v_cvt_pk_bf16_f32 v124, v70, v71
    v_lshlrev_b32 v70, 16, v124
    v_and_b32 v71, 0xffff0000, v124
    v_mul_f32 v125, v70, v121
    v_mul_f32 v126, v71, v121
    v_fma_f32 v70, -v125, v120, v70
    v_fma_f32 v71, -v126, v120, v71
    v_fma_f32 v125, v70, v121, v125
    v_fma_f32 v126, v71, v121, v126
    v_cvt_pk_bf16_f32 v21, v125, v126
    v_sub_f32 v72, v72, v116
    v_sub_f32 v73, v73, v116
    v_cvt_pk_bf16_f32 v124, v72, v73
    v_lshlrev_b32 v72, 16, v124
    v_and_b32 v73, 0xffff0000, v124
    v_mul_f32 v125, v72, v121
    v_mul_f32 v126, v73, v121
    v_fma_f32 v72, -v125, v120, v72
    v_fma_f32 v73, -v126, v120, v73
    v_fma_f32 v125, v72, v121, v125
    v_fma_f32 v126, v73, v121, v126
    v_cvt_pk_bf16_f32 v22, v125, v126
    v_sub_f32 v74, v74, v116
    v_sub_f32 v75, v75, v116
    v_cvt_pk_bf16_f32 v124, v74, v75
    v_lshlrev_b32 v74, 16, v124
    v_and_b32 v75, 0xffff0000, v124
    v_mul_f32 v125, v74, v121
    v_mul_f32 v126, v75, v121
    v_fma_f32 v74, -v125, v120, v74
    v_fma_f32 v75, -v126, v120, v75
    v_fma_f32 v125, v74, v121, v125
    v_fma_f32 v126, v75, v121, v126
    v_cvt_pk_bf16_f32 v23, v125, v126
    s_movk_i32 s73, 6144
    buffer_store_dwordx4 v[20:23], v6, s[24:27], s73 offen
    buffer_store_dwordx4 v[20:23], v5, s[28:31], 0 offen offset:384
    v_sub_f32 v76, v76, v116
    v_sub_f32 v77, v77, v116
    v_cvt_pk_bf16_f32 v124, v76, v77
    v_lshlrev_b32 v76, 16, v124
    v_and_b32 v77, 0xffff0000, v124
    v_mul_f32 v125, v76, v121
    v_mul_f32 v126, v77, v121
    v_fma_f32 v76, -v125, v120, v76
    v_fma_f32 v77, -v126, v120, v77
    v_fma_f32 v125, v76, v121, v125
    v_fma_f32 v126, v77, v121, v126
    v_cvt_pk_bf16_f32 v24, v125, v126
    v_sub_f32 v78, v78, v116
    v_sub_f32 v79, v79, v116
    v_cvt_pk_bf16_f32 v124, v78, v79
    v_lshlrev_b32 v78, 16, v124
    v_and_b32 v79, 0xffff0000, v124
    v_mul_f32 v125, v78, v121
    v_mul_f32 v126, v79, v121
    v_fma_f32 v78, -v125, v120, v78
    v_fma_f32 v79, -v126, v120, v79
    v_fma_f32 v125, v78, v121, v125
    v_fma_f32 v126, v79, v121, v126
    v_cvt_pk_bf16_f32 v25, v125, v126
    v_sub_f32 v80, v80, v116
    v_sub_f32 v81, v81, v116
    v_cvt_pk_bf16_f32 v124, v80, v81
    v_lshlrev_b32 v80, 16, v124
    v_and_b32 v81, 0xffff0000, v124
    v_mul_f32 v125, v80, v121
    v_mul_f32 v126, v81, v121
    v_fma_f32 v80, -v125, v120, v80
    v_fma_f32 v81, -v126, v120, v81
    v_fma_f32 v125, v80, v121, v125
    v_fma_f32 v126, v81, v121, v126
    v_cvt_pk_bf16_f32 v26, v125, v126
    v_sub_f32 v82, v82, v116
    v_sub_f32 v83, v83, v116
    v_cvt_pk_bf16_f32 v124, v82, v83
    v_lshlrev_b32 v82, 16, v124
    v_and_b32 v83, 0xffff0000, v124
    v_mul_f32 v125, v82, v121
    v_mul_f32 v126, v83, v121
    v_fma_f32 v82, -v125, v120, v82
    v_fma_f32 v83, -v126, v120, v83
    v_fma_f32 v125, v82, v121, v125
    v_fma_f32 v126, v83, v121, v126
    v_cvt_pk_bf16_f32 v27, v125, v126
    s_movk_i32 s73, 8192
    buffer_store_dwordx4 v[24:27], v6, s[24:27], s73 offen
    buffer_store_dwordx4 v[24:27], v5, s[28:31], 0 offen offset:512
    v_sub_f32 v84, v84, v116
    v_sub_f32 v85, v85, v116
    v_cvt_pk_bf16_f32 v124, v84, v85
    v_lshlrev_b32 v84, 16, v124
    v_and_b32 v85, 0xffff0000, v124
    v_mul_f32 v125, v84, v121
    v_mul_f32 v126, v85, v121
    v_fma_f32 v84, -v125, v120, v84
    v_fma_f32 v85, -v126, v120, v85
    v_fma_f32 v125, v84, v121, v125
    v_fma_f32 v126, v85, v121, v126
    v_cvt_pk_bf16_f32 v28, v125, v126
    v_sub_f32 v86, v86, v116
    v_sub_f32 v87, v87, v116
    v_cvt_pk_bf16_f32 v124, v86, v87
    v_lshlrev_b32 v86, 16, v124
    v_and_b32 v87, 0xffff0000, v124
    v_mul_f32 v125, v86, v121
    v_mul_f32 v126, v87, v121
    v_fma_f32 v86, -v125, v120, v86
    v_fma_f32 v87, -v126, v120, v87
    v_fma_f32 v125, v86, v121, v125
    v_fma_f32 v126, v87, v121, v126
    v_cvt_pk_bf16_f32 v29, v125, v126
    v_sub_f32 v88, v88, v116
    v_sub_f32 v89, v89, v116
    v_cvt_pk_bf16_f32 v124, v88, v89
    v_lshlrev_b32 v88, 16, v124
    v_and_b32 v89, 0xffff0000, v124
    v_mul_f32 v125, v88, v121
    v_mul_f32 v126, v89, v121
    v_fma_f32 v88, -v125, v120, v88
    v_fma_f32 v89, -v126, v120, v89
    v_fma_f32 v125, v88, v121, v125
    v_fma_f32 v126, v89, v121, v126
    v_cvt_pk_bf16_f32 v30, v125, v126
    v_sub_f32 v90, v90, v116
    v_sub_f32 v91, v91, v116
    v_cvt_pk_bf16_f32 v124, v90, v91
    v_lshlrev_b32 v90, 16, v124
    v_and_b32 v91, 0xffff0000, v124
    v_mul_f32 v125, v90, v121
    v_mul_f32 v126, v91, v121
    v_fma_f32 v90, -v125, v120, v90
    v_fma_f32 v91, -v126, v120, v91
    v_fma_f32 v125, v90, v121, v125
    v_fma_f32 v126, v91, v121, v126
    v_cvt_pk_bf16_f32 v31, v125, v126
    s_movk_i32 s73, 10240
    buffer_store_dwordx4 v[28:31], v6, s[24:27], s73 offen
    buffer_store_dwordx4 v[28:31], v5, s[28:31], 0 offen offset:640
    v_sub_f32 v92, v92, v116
    v_sub_f32 v93, v93, v116
    v_cvt_pk_bf16_f32 v124, v92, v93
    v_lshlrev_b32 v92, 16, v124
    v_and_b32 v93, 0xffff0000, v124
    v_mul_f32 v125, v92, v121
    v_mul_f32 v126, v93, v121
    v_fma_f32 v92, -v125, v120, v92
    v_fma_f32 v93, -v126, v120, v93
    v_fma_f32 v125, v92, v121, v125
    v_fma_f32 v126, v93, v121, v126
    v_cvt_pk_bf16_f32 v32, v125, v126
    v_sub_f32 v94, v94, v116
    v_sub_f32 v95, v95, v116
    v_cvt_pk_bf16_f32 v124, v94, v95
    v_lshlrev_b32 v94, 16, v124
    v_and_b32 v95, 0xffff0000, v124
    v_mul_f32 v125, v94, v121
    v_mul_f32 v126, v95, v121
    v_fma_f32 v94, -v125, v120, v94
    v_fma_f32 v95, -v126, v120, v95
    v_fma_f32 v125, v94, v121, v125
    v_fma_f32 v126, v95, v121, v126
    v_cvt_pk_bf16_f32 v33, v125, v126
    v_sub_f32 v96, v96, v116
    v_sub_f32 v97, v97, v116
    v_cvt_pk_bf16_f32 v124, v96, v97
    v_lshlrev_b32 v96, 16, v124
    v_and_b32 v97, 0xffff0000, v124
    v_mul_f32 v125, v96, v121
    v_mul_f32 v126, v97, v121
    v_fma_f32 v96, -v125, v120, v96
    v_fma_f32 v97, -v126, v120, v97
    v_fma_f32 v125, v96, v121, v125
    v_fma_f32 v126, v97, v121, v126
    v_cvt_pk_bf16_f32 v34, v125, v126
    v_sub_f32 v98, v98, v116
    v_sub_f32 v99, v99, v116
    v_cvt_pk_bf16_f32 v124, v98, v99
    v_lshlrev_b32 v98, 16, v124
    v_and_b32 v99, 0xffff0000, v124
    v_mul_f32 v125, v98, v121
    v_mul_f32 v126, v99, v121
    v_fma_f32 v98, -v125, v120, v98
    v_fma_f32 v99, -v126, v120, v99
    v_fma_f32 v125, v98, v121, v125
    v_fma_f32 v126, v99, v121, v126
    v_cvt_pk_bf16_f32 v35, v125, v126
    s_movk_i32 s73, 12288
    buffer_store_dwordx4 v[32:35], v6, s[24:27], s73 offen
    buffer_store_dwordx4 v[32:35], v5, s[28:31], 0 offen offset:768
    v_sub_f32 v100, v100, v116
    v_sub_f32 v101, v101, v116
    v_cvt_pk_bf16_f32 v124, v100, v101
    v_lshlrev_b32 v100, 16, v124
    v_and_b32 v101, 0xffff0000, v124
    v_mul_f32 v125, v100, v121
    v_mul_f32 v126, v101, v121
    v_fma_f32 v100, -v125, v120, v100
    v_fma_f32 v101, -v126, v120, v101
    v_fma_f32 v125, v100, v121, v125
    v_fma_f32 v126, v101, v121, v126
    v_cvt_pk_bf16_f32 v36, v125, v126
    v_sub_f32 v102, v102, v116
    v_sub_f32 v103, v103, v116
    v_cvt_pk_bf16_f32 v124, v102, v103
    v_lshlrev_b32 v102, 16, v124
    v_and_b32 v103, 0xffff0000, v124
    v_mul_f32 v125, v102, v121
    v_mul_f32 v126, v103, v121
    v_fma_f32 v102, -v125, v120, v102
    v_fma_f32 v103, -v126, v120, v103
    v_fma_f32 v125, v102, v121, v125
    v_fma_f32 v126, v103, v121, v126
    v_cvt_pk_bf16_f32 v37, v125, v126
    v_sub_f32 v104, v104, v116
    v_sub_f32 v105, v105, v116
    v_cvt_pk_bf16_f32 v124, v104, v105
    v_lshlrev_b32 v104, 16, v124
    v_and_b32 v105, 0xffff0000, v124
    v_mul_f32 v125, v104, v121
    v_mul_f32 v126, v105, v121
    v_fma_f32 v104, -v125, v120, v104
    v_fma_f32 v105, -v126, v120, v105
    v_fma_f32 v125, v104, v121, v125
    v_fma_f32 v126, v105, v121, v126
    v_cvt_pk_bf16_f32 v38, v125, v126
    v_sub_f32 v106, v106, v116
    v_sub_f32 v107, v107, v116
    v_cvt_pk_bf16_f32 v124, v106, v107
    v_lshlrev_b32 v106, 16, v124
    v_and_b32 v107, 0xffff0000, v124
    v_mul_f32 v125, v106, v121
    v_mul_f32 v126, v107, v121
    v_fma_f32 v106, -v125, v120, v106
    v_fma_f32 v107, -v126, v120, v107
    v_fma_f32 v125, v106, v121, v125
    v_fma_f32 v126, v107, v121, v126
    v_cvt_pk_bf16_f32 v39, v125, v126
    s_movk_i32 s73, 14336
    buffer_store_dwordx4 v[36:39], v6, s[24:27], s73 offen
    buffer_store_dwordx4 v[36:39], v5, s[28:31], 0 offen offset:896
    v_sub_f32 v108, v108, v116
    v_sub_f32 v109, v109, v116
    v_cvt_pk_bf16_f32 v124, v108, v109
    v_lshlrev_b32 v108, 16, v124
    v_and_b32 v109, 0xffff0000, v124
    v_mul_f32 v125, v108, v121
    v_mul_f32 v126, v109, v121
    v_fma_f32 v108, -v125, v120, v108
    v_fma_f32 v109, -v126, v120, v109
    v_fma_f32 v125, v108, v121, v125
    v_fma_f32 v126, v109, v121, v126
    v_cvt_pk_bf16_f32 v40, v125, v126
    v_sub_f32 v110, v110, v116
    v_sub_f32 v111, v111, v116
    v_cvt_pk_bf16_f32 v124, v110, v111
    v_lshlrev_b32 v110, 16, v124
    v_and_b32 v111, 0xffff0000, v124
    v_mul_f32 v125, v110, v121
    v_mul_f32 v126, v111, v121
    v_fma_f32 v110, -v125, v120, v110
    v_fma_f32 v111, -v126, v120, v111
    v_fma_f32 v125, v110, v121, v125
    v_fma_f32 v126, v111, v121, v126
    v_cvt_pk_bf16_f32 v41, v125, v126
    v_sub_f32 v112, v112, v116
    v_sub_f32 v113, v113, v116
    v_cvt_pk_bf16_f32 v124, v112, v113
    v_lshlrev_b32 v112, 16, v124
    v_and_b32 v113, 0xffff0000, v124
    v_mul_f32 v125, v112, v121
    v_mul_f32 v126, v113, v121
    v_fma_f32 v112, -v125, v120, v112
    v_fma_f32 v113, -v126, v120, v113
    v_fma_f32 v125, v112, v121, v125
    v_fma_f32 v126, v113, v121, v126
    v_cvt_pk_bf16_f32 v42, v125, v126
    v_sub_f32 v114, v114, v116
    v_sub_f32 v115, v115, v116
    v_cvt_pk_bf16_f32 v124, v114, v115
    v_lshlrev_b32 v114, 16, v124
    v_and_b32 v115, 0xffff0000, v124
    v_mul_f32 v125, v114, v121
    v_mul_f32 v126, v115, v121
    v_fma_f32 v114, -v125, v120, v114
    v_fma_f32 v115, -v126, v120, v115
    v_fma_f32 v125, v114, v121, v125
    v_fma_f32 v126, v115, v121, v126
    v_cvt_pk_bf16_f32 v43, v125, v126
    s_movk_i32 s73, 16384
    buffer_store_dwordx4 v[40:43], v6, s[24:27], s73 offen
    buffer_store_dwordx4 v[40:43], v5, s[28:31], 0 offen offset:1024
    s_endpgm
L_prep_kv:
    s_mov_b32 s20, s6
    s_mov_b32 s21, s7
    s_mov_b32 s22, 2359296
    s_mov_b32 s23, 0x00020000
    s_mov_b32 s24, s8
    s_mov_b32 s25, s9
    s_mov_b32 s26, 2359296
    s_mov_b32 s27, 0x00020000
    s_mov_b32 s28, s10
    s_mov_b32 s29, s11
    s_mov_b32 s30, 4608
    s_mov_b32 s31, 0x00020000
    s_add_u32 s32, s16, 47222784
    s_addc_u32 s33, s17, 0
    s_mov_b32 s34, 2654208
    s_mov_b32 s35, 0x00020000
    s_sub_u32 s3, s2, 64
    s_mul_i32 s70, s3, 7282
    s_lshr_b32 s70, s70, 16
    s_mul_i32 s71, s70, 9
    s_sub_u32 s71, s3, s71
    s_lshl_b32 s70, s70, 5
    s_lshl_b32 s71, s71, 3
    v_lshrrev_b32 v2, 3, v0
    v_add_u32 v2, s70, v2
    v_and_b32 v3, 7, v0
    v_add_u32 v3, s71, v3
    s_movk_i32 s73, 4608
    v_mul_lo_u32 v4, v2, s73
    v_lshl_add_u32 v4, v3, 4, v4
    v_subrev_u32 v5, 3456, v4
    v_cmp_eq_u32 vcc, 0, v2
    v_mov_b32 v6, 0x7fffff00
    s_nop 0
    v_cndmask_b32 v5, v5, v6, vcc
    buffer_load_dwordx4 v[8:11], v5, s[20:23], 0 offen offset:0
    buffer_load_dwordx4 v[12:15], v5, s[20:23], 0 offen offset:1152
    buffer_load_dwordx4 v[16:19], v5, s[20:23], 0 offen offset:2304
    buffer_load_dwordx4 v[20:23], v4, s[20:23], 0 offen offset:0
    buffer_load_dwordx4 v[24:27], v4, s[20:23], 0 offen offset:1152
    buffer_load_dwordx4 v[28:31], v4, s[20:23], 0 offen offset:2304
    buffer_load_dwordx4 v[32:35], v4, s[20:23], 0 offen offset:3456
    buffer_load_dwordx4 v[36:39], v4, s[24:27], 0 offen offset:0
    buffer_load_dwordx4 v[40:43], v4, s[24:27], 0 offen offset:1152
    buffer_load_dwordx4 v[44:47], v4, s[24:27], 0 offen offset:2304
    buffer_load_dwordx4 v[48:51], v4, s[24:27], 0 offen offset:3456
    v_lshlrev_b32 v6, 6, v3
    buffer_load_dwordx4 v[52:55], v6, s[28:31], 0 offen offset:0
    buffer_load_dwordx4 v[56:59], v6, s[28:31], 0 offen offset:16
    buffer_load_dwordx4 v[60:63], v6, s[28:31], 0 offen offset:32
    buffer_load_dwordx4 v[64:67], v6, s[28:31], 0 offen offset:48
    s_mov_b32 s73, 36864
    v_mul_lo_u32 v7, v3, s73
    v_lshlrev_b32 v1, 3, v2
    v_sub_u32 v7, v7, v1
    v_add_u32 v7, 4088, v7
    s_waitcnt vmcnt(0) lgkmcnt(0)
    s_cmp_lg_u32 s70, 0
    s_cbranch_scc1 L_kv_nopad
    v_mov_b32 v120, 0
    v_mov_b32 v121, 0
    v_mov_b32 v122, 0
    v_mov_b32 v123, 0
    v_lshrrev_b32 v1, 5, v0
    s_lshl_b32 s73, s71, 3
    v_add_u32 v1, s73, v1
    s_movk_i32 s73, 4608
    v_mul_lo_u32 v1, v1, s73
    v_and_b32 v2, 31, v0
    v_lshl_add_u32 v1, v2, 4, v1
    v_add_u32 v1, 4096, v1
    s_mov_b32 s73, 0
    buffer_store_dwordx4 v[120:123], v1, s[32:35], s73 offen
    s_mov_b32 s73, 36864
    buffer_store_dwordx4 v[120:123], v1, s[32:35], s73 offen
    s_mov_b32 s73, 73728
    buffer_store_dwordx4 v[120:123], v1, s[32:35], s73 offen
    s_mov_b32 s73, 110592
    buffer_store_dwordx4 v[120:123], v1, s[32:35], s73 offen
    s_mov_b32 s73, 147456
    buffer_store_dwordx4 v[120:123], v1, s[32:35], s73 offen
    s_mov_b32 s73, 184320
    buffer_store_dwordx4 v[120:123], v1, s[32:35], s73 offen
    s_mov_b32 s73, 221184
    buffer_store_dwordx4 v[120:123], v1, s[32:35], s73 offen
    s_mov_b32 s73, 258048
    buffer_store_dwordx4 v[120:123], v1, s[32:35], s73 offen
    s_nop 1
L_kv_nopad:
    v_lshlrev_b32 v72, 16, v8
    v_lshlrev_b32 v73, 16, v12
    v_lshlrev_b32 v74, 16, v16
    v_lshlrev_b32 v75, 16, v20
    v_lshlrev_b32 v76, 16, v24
    v_lshlrev_b32 v77, 16, v28
    v_lshlrev_b32 v78, 16, v32
    v_lshlrev_b32 v100, 16, v36
    v_lshlrev_b32 v101, 16, v40
    v_lshlrev_b32 v102, 16, v44
    v_lshlrev_b32 v103, 16, v48
    v_lshlrev_b32 v116, 16, v52
    v_and_b32 v117, 0xffff0000, v52
    v_lshlrev_b32 v118, 16, v53
    v_and_b32 v119, 0xffff0000, v53
    v_mul_f32 v104, v119, v75
    v_mul_f32 v105, v119, v74
    v_cvt_pk_bf16_f32 v108, v104, v105
    v_lshlrev_b32 v104, 16, v108
    v_and_b32 v105, 0xffff0000, v108
    v_mul_f32 v106, v118, v76
    v_mul_f32 v107, v118, v75
    v_cvt_pk_bf16_f32 v108, v106, v107
    v_lshlrev_b32 v106, 16, v108
    v_and_b32 v107, 0xffff0000, v108
    v_add_f32 v104, v104, v106
    v_add_f32 v105, v105, v107
    v_cvt_pk_bf16_f32 v108, v104, v105
    v_lshlrev_b32 v104, 16, v108
    v_and_b32 v105, 0xffff0000, v108
    v_mul_f32 v106, v117, v77
    v_mul_f32 v107, v117, v76
    v_cvt_pk_bf16_f32 v108, v106, v107
    v_lshlrev_b32 v106, 16, v108
    v_and_b32 v107, 0xffff0000, v108
    v_add_f32 v104, v104, v106
    v_add_f32 v105, v105, v107
    v_cvt_pk_bf16_f32 v108, v104, v105
    v_lshlrev_b32 v104, 16, v108
    v_and_b32 v105, 0xffff0000, v108
    v_mul_f32 v106, v116, v78
    v_mul_f32 v107, v116, v77
    v_cvt_pk_bf16_f32 v108, v106, v107
    v_lshlrev_b32 v106, 16, v108
    v_and_b32 v107, 0xffff0000, v108
    v_add_f32 v104, v104, v106
    v_add_f32 v105, v105, v107
    v_cvt_pk_bf16_f32 v108, v104, v105
    v_lshlrev_b32 v104, 16, v108
    v_and_b32 v105, 0xffff0000, v108
    v_mul_f32 v104, v104, v103
    v_mul_f32 v105, v105, v102
    v_cvt_pk_bf16_f32 v124, v104, v105
    v_mul_f32 v104, v119, v73
    v_mul_f32 v105, v119, v72
    v_cvt_pk_bf16_f32 v108, v104, v105
    v_lshlrev_b32 v104, 16, v108
    v_and_b32 v105, 0xffff0000, v108
    v_mul_f32 v106, v118, v74
    v_mul_f32 v107, v118, v73
    v_cvt_pk_bf16_f32 v108, v106, v107
    v_lshlrev_b32 v106, 16, v108
    v_and_b32 v107, 0xffff0000, v108
    v_add_f32 v104, v104, v106
    v_add_f32 v105, v105, v107
    v_cvt_pk_bf16_f32 v108, v104, v105
    v_lshlrev_b32 v104, 16, v108
    v_and_b32 v105, 0xffff0000, v108
    v_mul_f32 v106, v117, v75
    v_mul_f32 v107, v117, v74
    v_cvt_pk_bf16_f32 v108, v106, v107
    v_lshlrev_b32 v106, 16, v108
    v_and_b32 v107, 0xffff0000, v108
    v_add_f32 v104, v104, v106
    v_add_f32 v105, v105, v107
    v_cvt_pk_bf16_f32 v108, v104, v105
    v_lshlrev_b32 v104, 16, v108
    v_and_b32 v105, 0xffff0000, v108
    v_mul_f32 v106, v116, v76
    v_mul_f32 v107, v116, v75
    v_cvt_pk_bf16_f32 v108, v106, v107
    v_lshlrev_b32 v106, 16, v108
    v_and_b32 v107, 0xffff0000, v108
    v_add_f32 v104, v104, v106
    v_add_f32 v105, v105, v107
    v_cvt_pk_bf16_f32 v108, v104, v105
    v_lshlrev_b32 v104, 16, v108
    v_and_b32 v105, 0xffff0000, v108
    v_mul_f32 v104, v104, v101
    v_mul_f32 v105, v105, v100
    v_cvt_pk_bf16_f32 v125, v104, v105
    s_mov_b32 s73, 0
    buffer_store_dwordx2 v[124:125], v7, s[32:35], s73 offen
    v_and_b32 v72, 0xffff0000, v8
    v_and_b32 v73, 0xffff0000, v12
    v_and_b32 v74, 0xffff0000, v16
    v_and_b32 v75, 0xffff0000, v20
    v_and_b32 v76, 0xffff0000, v24
    v_and_b32 v77, 0xffff0000, v28
    v_and_b32 v78, 0xffff0000, v32
    v_and_b32 v100, 0xffff0000, v36
    v_and_b32 v101, 0xffff0000, v40
    v_and_b32 v102, 0xffff0000, v44
    v_and_b32 v103, 0xffff0000, v48
    v_lshlrev_b32 v116, 16, v54
    v_and_b32 v117, 0xffff0000, v54
    v_lshlrev_b32 v118, 16, v55
    v_and_b32 v119, 0xffff0000, v55
    v_mul_f32 v104, v119, v75
    v_mul_f32 v105, v119, v74
    v_cvt_pk_bf16_f32 v108, v104, v105
    v_lshlrev_b32 v104, 16, v108
    v_and_b32 v105, 0xffff0000, v108
    v_mul_f32 v106, v118, v76
    v_mul_f32 v107, v118, v75
    v_cvt_pk_bf16_f32 v108, v106, v107
    v_lshlrev_b32 v106, 16, v108
    v_and_b32 v107, 0xffff0000, v108
    v_add_f32 v104, v104, v106
    v_add_f32 v105, v105, v107
    v_cvt_pk_bf16_f32 v108, v104, v105
    v_lshlrev_b32 v104, 16, v108
    v_and_b32 v105, 0xffff0000, v108
    v_mul_f32 v106, v117, v77
    v_mul_f32 v107, v117, v76
    v_cvt_pk_bf16_f32 v108, v106, v107
    v_lshlrev_b32 v106, 16, v108
    v_and_b32 v107, 0xffff0000, v108
    v_add_f32 v104, v104, v106
    v_add_f32 v105, v105, v107
    v_cvt_pk_bf16_f32 v108, v104, v105
    v_lshlrev_b32 v104, 16, v108
    v_and_b32 v105, 0xffff0000, v108
    v_mul_f32 v106, v116, v78
    v_mul_f32 v107, v116, v77
    v_cvt_pk_bf16_f32 v108, v106, v107
    v_lshlrev_b32 v106, 16, v108
    v_and_b32 v107, 0xffff0000, v108
    v_add_f32 v104, v104, v106
    v_add_f32 v105, v105, v107
    v_cvt_pk_bf16_f32 v108, v104, v105
    v_lshlrev_b32 v104, 16, v108
    v_and_b32 v105, 0xffff0000, v108
    v_mul_f32 v104, v104, v103
    v_mul_f32 v105, v105, v102
    v_cvt_pk_bf16_f32 v126, v104, v105
    v_mul_f32 v104, v119, v73
    v_mul_f32 v105, v119, v72
    v_cvt_pk_bf16_f32 v108, v104, v105
    v_lshlrev_b32 v104, 16, v108
    v_and_b32 v105, 0xffff0000, v108
    v_mul_f32 v106, v118, v74
    v_mul_f32 v107, v118, v73
    v_cvt_pk_bf16_f32 v108, v106, v107
    v_lshlrev_b32 v106, 16, v108
    v_and_b32 v107, 0xffff0000, v108
    v_add_f32 v104, v104, v106
    v_add_f32 v105, v105, v107
    v_cvt_pk_bf16_f32 v108, v104, v105
    v_lshlrev_b32 v104, 16, v108
    v_and_b32 v105, 0xffff0000, v108
    v_mul_f32 v106, v117, v75
    v_mul_f32 v107, v117, v74
    v_cvt_pk_bf16_f32 v108, v106, v107
    v_lshlrev_b32 v106, 16, v108
    v_and_b32 v107, 0xffff0000, v108
    v_add_f32 v104, v104, v106
    v_add_f32 v105, v105, v107
    v_cvt_pk_bf16_f32 v108, v104, v105
    v_lshlrev_b32 v104, 16, v108
    v_and_b32 v105, 0xffff0000, v108
    v_mul_f32 v106, v116, v76
    v_mul_f32 v107, v116, v75
    v_cvt_pk_bf16_f32 v108, v106, v107
    v_lshlrev_b32 v106, 16, v108
    v_and_b32 v107, 0xffff0000, v108
    v_add_f32 v104, v104, v106
    v_add_f32 v105, v105, v107
    v_cvt_pk_bf16_f32 v108, v104, v105
    v_lshlrev_b32 v104, 16, v108
    v_and_b32 v105, 0xffff0000, v108
    v_mul_f32 v104, v104, v101
    v_mul_f32 v105, v105, v100
    v_cvt_pk_bf16_f32 v127, v104, v105
    s_mov_b32 s73, 4608
    buffer_store_dwordx2 v[126:127], v7, s[32:35], s73 offen
    v_lshlrev_b32 v72, 16, v9
    v_lshlrev_b32 v73, 16, v13
    v_lshlrev_b32 v74, 16, v17
    v_lshlrev_b32 v75, 16, v21
    v_lshlrev_b32 v76, 16, v25
    v_lshlrev_b32 v77, 16, v29
    v_lshlrev_b32 v78, 16, v33
    v_lshlrev_b32 v100, 16, v37
    v_lshlrev_b32 v101, 16, v41
    v_lshlrev_b32 v102, 16, v45
    v_lshlrev_b32 v103, 16, v49
    v_lshlrev_b32 v116, 16, v56
    v_and_b32 v117, 0xffff0000, v56
    v_lshlrev_b32 v118, 16, v57
    v_and_b32 v119, 0xffff0000, v57
    v_mul_f32 v104, v119, v75
    v_mul_f32 v105, v119, v74
    v_cvt_pk_bf16_f32 v108, v104, v105
    v_lshlrev_b32 v104, 16, v108
    v_and_b32 v105, 0xffff0000, v108
    v_mul_f32 v106, v118, v76
    v_mul_f32 v107, v118, v75
    v_cvt_pk_bf16_f32 v108, v106, v107
    v_lshlrev_b32 v106, 16, v108
    v_and_b32 v107, 0xffff0000, v108
    v_add_f32 v104, v104, v106
    v_add_f32 v105, v105, v107
    v_cvt_pk_bf16_f32 v108, v104, v105
    v_lshlrev_b32 v104, 16, v108
    v_and_b32 v105, 0xffff0000, v108
    v_mul_f32 v106, v117, v77
    v_mul_f32 v107, v117, v76
    v_cvt_pk_bf16_f32 v108, v106, v107
    v_lshlrev_b32 v106, 16, v108
    v_and_b32 v107, 0xffff0000, v108
    v_add_f32 v104, v104, v106
    v_add_f32 v105, v105, v107
    v_cvt_pk_bf16_f32 v108, v104, v105
    v_lshlrev_b32 v104, 16, v108
    v_and_b32 v105, 0xffff0000, v108
    v_mul_f32 v106, v116, v78
    v_mul_f32 v107, v116, v77
    v_cvt_pk_bf16_f32 v108, v106, v107
    v_lshlrev_b32 v106, 16, v108
    v_and_b32 v107, 0xffff0000, v108
    v_add_f32 v104, v104, v106
    v_add_f32 v105, v105, v107
    v_cvt_pk_bf16_f32 v108, v104, v105
    v_lshlrev_b32 v104, 16, v108
    v_and_b32 v105, 0xffff0000, v108
    v_mul_f32 v104, v104, v103
    v_mul_f32 v105, v105, v102
    v_cvt_pk_bf16_f32 v124, v104, v105
    v_mul_f32 v104, v119, v73
    v_mul_f32 v105, v119, v72
    v_cvt_pk_bf16_f32 v108, v104, v105
    v_lshlrev_b32 v104, 16, v108
    v_and_b32 v105, 0xffff0000, v108
    v_mul_f32 v106, v118, v74
    v_mul_f32 v107, v118, v73
    v_cvt_pk_bf16_f32 v108, v106, v107
    v_lshlrev_b32 v106, 16, v108
    v_and_b32 v107, 0xffff0000, v108
    v_add_f32 v104, v104, v106
    v_add_f32 v105, v105, v107
    v_cvt_pk_bf16_f32 v108, v104, v105
    v_lshlrev_b32 v104, 16, v108
    v_and_b32 v105, 0xffff0000, v108
    v_mul_f32 v106, v117, v75
    v_mul_f32 v107, v117, v74
    v_cvt_pk_bf16_f32 v108, v106, v107
    v_lshlrev_b32 v106, 16, v108
    v_and_b32 v107, 0xffff0000, v108
    v_add_f32 v104, v104, v106
    v_add_f32 v105, v105, v107
    v_cvt_pk_bf16_f32 v108, v104, v105
    v_lshlrev_b32 v104, 16, v108
    v_and_b32 v105, 0xffff0000, v108
    v_mul_f32 v106, v116, v76
    v_mul_f32 v107, v116, v75
    v_cvt_pk_bf16_f32 v108, v106, v107
    v_lshlrev_b32 v106, 16, v108
    v_and_b32 v107, 0xffff0000, v108
    v_add_f32 v104, v104, v106
    v_add_f32 v105, v105, v107
    v_cvt_pk_bf16_f32 v108, v104, v105
    v_lshlrev_b32 v104, 16, v108
    v_and_b32 v105, 0xffff0000, v108
    v_mul_f32 v104, v104, v101
    v_mul_f32 v105, v105, v100
    v_cvt_pk_bf16_f32 v125, v104, v105
    s_mov_b32 s73, 9216
    buffer_store_dwordx2 v[124:125], v7, s[32:35], s73 offen
    v_and_b32 v72, 0xffff0000, v9
    v_and_b32 v73, 0xffff0000, v13
    v_and_b32 v74, 0xffff0000, v17
    v_and_b32 v75, 0xffff0000, v21
    v_and_b32 v76, 0xffff0000, v25
    v_and_b32 v77, 0xffff0000, v29
    v_and_b32 v78, 0xffff0000, v33
    v_and_b32 v100, 0xffff0000, v37
    v_and_b32 v101, 0xffff0000, v41
    v_and_b32 v102, 0xffff0000, v45
    v_and_b32 v103, 0xffff0000, v49
    v_lshlrev_b32 v116, 16, v58
    v_and_b32 v117, 0xffff0000, v58
    v_lshlrev_b32 v118, 16, v59
    v_and_b32 v119, 0xffff0000, v59
    v_mul_f32 v104, v119, v75
    v_mul_f32 v105, v119, v74
    v_cvt_pk_bf16_f32 v108, v104, v105
    v_lshlrev_b32 v104, 16, v108
    v_and_b32 v105, 0xffff0000, v108
    v_mul_f32 v106, v118, v76
    v_mul_f32 v107, v118, v75
    v_cvt_pk_bf16_f32 v108, v106, v107
    v_lshlrev_b32 v106, 16, v108
    v_and_b32 v107, 0xffff0000, v108
    v_add_f32 v104, v104, v106
    v_add_f32 v105, v105, v107
    v_cvt_pk_bf16_f32 v108, v104, v105
    v_lshlrev_b32 v104, 16, v108
    v_and_b32 v105, 0xffff0000, v108
    v_mul_f32 v106, v117, v77
    v_mul_f32 v107, v117, v76
    v_cvt_pk_bf16_f32 v108, v106, v107
    v_lshlrev_b32 v106, 16, v108
    v_and_b32 v107, 0xffff0000, v108
    v_add_f32 v104, v104, v106
    v_add_f32 v105, v105, v107
    v_cvt_pk_bf16_f32 v108, v104, v105
    v_lshlrev_b32 v104, 16, v108
    v_and_b32 v105, 0xffff0000, v108
    v_mul_f32 v106, v116, v78
    v_mul_f32 v107, v116, v77
    v_cvt_pk_bf16_f32 v108, v106, v107
    v_lshlrev_b32 v106, 16, v108
    v_and_b32 v107, 0xffff0000, v108
    v_add_f32 v104, v104, v106
    v_add_f32 v105, v105, v107
    v_cvt_pk_bf16_f32 v108, v104, v105
    v_lshlrev_b32 v104, 16, v108
    v_and_b32 v105, 0xffff0000, v108
    v_mul_f32 v104, v104, v103
    v_mul_f32 v105, v105, v102
    v_cvt_pk_bf16_f32 v126, v104, v105
    v_mul_f32 v104, v119, v73
    v_mul_f32 v105, v119, v72
    v_cvt_pk_bf16_f32 v108, v104, v105
    v_lshlrev_b32 v104, 16, v108
    v_and_b32 v105, 0xffff0000, v108
    v_mul_f32 v106, v118, v74
    v_mul_f32 v107, v118, v73
    v_cvt_pk_bf16_f32 v108, v106, v107
    v_lshlrev_b32 v106, 16, v108
    v_and_b32 v107, 0xffff0000, v108
    v_add_f32 v104, v104, v106
    v_add_f32 v105, v105, v107
    v_cvt_pk_bf16_f32 v108, v104, v105
    v_lshlrev_b32 v104, 16, v108
    v_and_b32 v105, 0xffff0000, v108
    v_mul_f32 v106, v117, v75
    v_mul_f32 v107, v117, v74
    v_cvt_pk_bf16_f32 v108, v106, v107
    v_lshlrev_b32 v106, 16, v108
    v_and_b32 v107, 0xffff0000, v108
    v_add_f32 v104, v104, v106
    v_add_f32 v105, v105, v107
    v_cvt_pk_bf16_f32 v108, v104, v105
    v_lshlrev_b32 v104, 16, v108
    v_and_b32 v105, 0xffff0000, v108
    v_mul_f32 v106, v116, v76
    v_mul_f32 v107, v116, v75
    v_cvt_pk_bf16_f32 v108, v106, v107
    v_lshlrev_b32 v106, 16, v108
    v_and_b32 v107, 0xffff0000, v108
    v_add_f32 v104, v104, v106
    v_add_f32 v105, v105, v107
    v_cvt_pk_bf16_f32 v108, v104, v105
    v_lshlrev_b32 v104, 16, v108
    v_and_b32 v105, 0xffff0000, v108
    v_mul_f32 v104, v104, v101
    v_mul_f32 v105, v105, v100
    v_cvt_pk_bf16_f32 v127, v104, v105
    s_mov_b32 s73, 13824
    buffer_store_dwordx2 v[126:127], v7, s[32:35], s73 offen
    v_lshlrev_b32 v72, 16, v10
    v_lshlrev_b32 v73, 16, v14
    v_lshlrev_b32 v74, 16, v18
    v_lshlrev_b32 v75, 16, v22
    v_lshlrev_b32 v76, 16, v26
    v_lshlrev_b32 v77, 16, v30
    v_lshlrev_b32 v78, 16, v34
    v_lshlrev_b32 v100, 16, v38
    v_lshlrev_b32 v101, 16, v42
    v_lshlrev_b32 v102, 16, v46
    v_lshlrev_b32 v103, 16, v50
    v_lshlrev_b32 v116, 16, v60
    v_and_b32 v117, 0xffff0000, v60
    v_lshlrev_b32 v118, 16, v61
    v_and_b32 v119, 0xffff0000, v61
    v_mul_f32 v104, v119, v75
    v_mul_f32 v105, v119, v74
    v_cvt_pk_bf16_f32 v108, v104, v105
    v_lshlrev_b32 v104, 16, v108
    v_and_b32 v105, 0xffff0000, v108
    v_mul_f32 v106, v118, v76
    v_mul_f32 v107, v118, v75
    v_cvt_pk_bf16_f32 v108, v106, v107
    v_lshlrev_b32 v106, 16, v108
    v_and_b32 v107, 0xffff0000, v108
    v_add_f32 v104, v104, v106
    v_add_f32 v105, v105, v107
    v_cvt_pk_bf16_f32 v108, v104, v105
    v_lshlrev_b32 v104, 16, v108
    v_and_b32 v105, 0xffff0000, v108
    v_mul_f32 v106, v117, v77
    v_mul_f32 v107, v117, v76
    v_cvt_pk_bf16_f32 v108, v106, v107
    v_lshlrev_b32 v106, 16, v108
    v_and_b32 v107, 0xffff0000, v108
    v_add_f32 v104, v104, v106
    v_add_f32 v105, v105, v107
    v_cvt_pk_bf16_f32 v108, v104, v105
    v_lshlrev_b32 v104, 16, v108
    v_and_b32 v105, 0xffff0000, v108
    v_mul_f32 v106, v116, v78
    v_mul_f32 v107, v116, v77
    v_cvt_pk_bf16_f32 v108, v106, v107
    v_lshlrev_b32 v106, 16, v108
    v_and_b32 v107, 0xffff0000, v108
    v_add_f32 v104, v104, v106
    v_add_f32 v105, v105, v107
    v_cvt_pk_bf16_f32 v108, v104, v105
    v_lshlrev_b32 v104, 16, v108
    v_and_b32 v105, 0xffff0000, v108
    v_mul_f32 v104, v104, v103
    v_mul_f32 v105, v105, v102
    v_cvt_pk_bf16_f32 v124, v104, v105
    v_mul_f32 v104, v119, v73
    v_mul_f32 v105, v119, v72
    v_cvt_pk_bf16_f32 v108, v104, v105
    v_lshlrev_b32 v104, 16, v108
    v_and_b32 v105, 0xffff0000, v108
    v_mul_f32 v106, v118, v74
    v_mul_f32 v107, v118, v73
    v_cvt_pk_bf16_f32 v108, v106, v107
    v_lshlrev_b32 v106, 16, v108
    v_and_b32 v107, 0xffff0000, v108
    v_add_f32 v104, v104, v106
    v_add_f32 v105, v105, v107
    v_cvt_pk_bf16_f32 v108, v104, v105
    v_lshlrev_b32 v104, 16, v108
    v_and_b32 v105, 0xffff0000, v108
    v_mul_f32 v106, v117, v75
    v_mul_f32 v107, v117, v74
    v_cvt_pk_bf16_f32 v108, v106, v107
    v_lshlrev_b32 v106, 16, v108
    v_and_b32 v107, 0xffff0000, v108
    v_add_f32 v104, v104, v106
    v_add_f32 v105, v105, v107
    v_cvt_pk_bf16_f32 v108, v104, v105
    v_lshlrev_b32 v104, 16, v108
    v_and_b32 v105, 0xffff0000, v108
    v_mul_f32 v106, v116, v76
    v_mul_f32 v107, v116, v75
    v_cvt_pk_bf16_f32 v108, v106, v107
    v_lshlrev_b32 v106, 16, v108
    v_and_b32 v107, 0xffff0000, v108
    v_add_f32 v104, v104, v106
    v_add_f32 v105, v105, v107
    v_cvt_pk_bf16_f32 v108, v104, v105
    v_lshlrev_b32 v104, 16, v108
    v_and_b32 v105, 0xffff0000, v108
    v_mul_f32 v104, v104, v101
    v_mul_f32 v105, v105, v100
    v_cvt_pk_bf16_f32 v125, v104, v105
    s_mov_b32 s73, 18432
    buffer_store_dwordx2 v[124:125], v7, s[32:35], s73 offen
    v_and_b32 v72, 0xffff0000, v10
    v_and_b32 v73, 0xffff0000, v14
    v_and_b32 v74, 0xffff0000, v18
    v_and_b32 v75, 0xffff0000, v22
    v_and_b32 v76, 0xffff0000, v26
    v_and_b32 v77, 0xffff0000, v30
    v_and_b32 v78, 0xffff0000, v34
    v_and_b32 v100, 0xffff0000, v38
    v_and_b32 v101, 0xffff0000, v42
    v_and_b32 v102, 0xffff0000, v46
    v_and_b32 v103, 0xffff0000, v50
    v_lshlrev_b32 v116, 16, v62
    v_and_b32 v117, 0xffff0000, v62
    v_lshlrev_b32 v118, 16, v63
    v_and_b32 v119, 0xffff0000, v63
    v_mul_f32 v104, v119, v75
    v_mul_f32 v105, v119, v74
    v_cvt_pk_bf16_f32 v108, v104, v105
    v_lshlrev_b32 v104, 16, v108
    v_and_b32 v105, 0xffff0000, v108
    v_mul_f32 v106, v118, v76
    v_mul_f32 v107, v118, v75
    v_cvt_pk_bf16_f32 v108, v106, v107
    v_lshlrev_b32 v106, 16, v108
    v_and_b32 v107, 0xffff0000, v108
    v_add_f32 v104, v104, v106
    v_add_f32 v105, v105, v107
    v_cvt_pk_bf16_f32 v108, v104, v105
    v_lshlrev_b32 v104, 16, v108
    v_and_b32 v105, 0xffff0000, v108
    v_mul_f32 v106, v117, v77
    v_mul_f32 v107, v117, v76
    v_cvt_pk_bf16_f32 v108, v106, v107
    v_lshlrev_b32 v106, 16, v108
    v_and_b32 v107, 0xffff0000, v108
    v_add_f32 v104, v104, v106
    v_add_f32 v105, v105, v107
    v_cvt_pk_bf16_f32 v108, v104, v105
    v_lshlrev_b32 v104, 16, v108
    v_and_b32 v105, 0xffff0000, v108
    v_mul_f32 v106, v116, v78
    v_mul_f32 v107, v116, v77
    v_cvt_pk_bf16_f32 v108, v106, v107
    v_lshlrev_b32 v106, 16, v108
    v_and_b32 v107, 0xffff0000, v108
    v_add_f32 v104, v104, v106
    v_add_f32 v105, v105, v107
    v_cvt_pk_bf16_f32 v108, v104, v105
    v_lshlrev_b32 v104, 16, v108
    v_and_b32 v105, 0xffff0000, v108
    v_mul_f32 v104, v104, v103
    v_mul_f32 v105, v105, v102
    v_cvt_pk_bf16_f32 v126, v104, v105
    v_mul_f32 v104, v119, v73
    v_mul_f32 v105, v119, v72
    v_cvt_pk_bf16_f32 v108, v104, v105
    v_lshlrev_b32 v104, 16, v108
    v_and_b32 v105, 0xffff0000, v108
    v_mul_f32 v106, v118, v74
    v_mul_f32 v107, v118, v73
    v_cvt_pk_bf16_f32 v108, v106, v107
    v_lshlrev_b32 v106, 16, v108
    v_and_b32 v107, 0xffff0000, v108
    v_add_f32 v104, v104, v106
    v_add_f32 v105, v105, v107
    v_cvt_pk_bf16_f32 v108, v104, v105
    v_lshlrev_b32 v104, 16, v108
    v_and_b32 v105, 0xffff0000, v108
    v_mul_f32 v106, v117, v75
    v_mul_f32 v107, v117, v74
    v_cvt_pk_bf16_f32 v108, v106, v107
    v_lshlrev_b32 v106, 16, v108
    v_and_b32 v107, 0xffff0000, v108
    v_add_f32 v104, v104, v106
    v_add_f32 v105, v105, v107
    v_cvt_pk_bf16_f32 v108, v104, v105
    v_lshlrev_b32 v104, 16, v108
    v_and_b32 v105, 0xffff0000, v108
    v_mul_f32 v106, v116, v76
    v_mul_f32 v107, v116, v75
    v_cvt_pk_bf16_f32 v108, v106, v107
    v_lshlrev_b32 v106, 16, v108
    v_and_b32 v107, 0xffff0000, v108
    v_add_f32 v104, v104, v106
    v_add_f32 v105, v105, v107
    v_cvt_pk_bf16_f32 v108, v104, v105
    v_lshlrev_b32 v104, 16, v108
    v_and_b32 v105, 0xffff0000, v108
    v_mul_f32 v104, v104, v101
    v_mul_f32 v105, v105, v100
    v_cvt_pk_bf16_f32 v127, v104, v105
    s_mov_b32 s73, 23040
    buffer_store_dwordx2 v[126:127], v7, s[32:35], s73 offen
    v_lshlrev_b32 v72, 16, v11
    v_lshlrev_b32 v73, 16, v15
    v_lshlrev_b32 v74, 16, v19
    v_lshlrev_b32 v75, 16, v23
    v_lshlrev_b32 v76, 16, v27
    v_lshlrev_b32 v77, 16, v31
    v_lshlrev_b32 v78, 16, v35
    v_lshlrev_b32 v100, 16, v39
    v_lshlrev_b32 v101, 16, v43
    v_lshlrev_b32 v102, 16, v47
    v_lshlrev_b32 v103, 16, v51
    v_lshlrev_b32 v116, 16, v64
    v_and_b32 v117, 0xffff0000, v64
    v_lshlrev_b32 v118, 16, v65
    v_and_b32 v119, 0xffff0000, v65
    v_mul_f32 v104, v119, v75
    v_mul_f32 v105, v119, v74
    v_cvt_pk_bf16_f32 v108, v104, v105
    v_lshlrev_b32 v104, 16, v108
    v_and_b32 v105, 0xffff0000, v108
    v_mul_f32 v106, v118, v76
    v_mul_f32 v107, v118, v75
    v_cvt_pk_bf16_f32 v108, v106, v107
    v_lshlrev_b32 v106, 16, v108
    v_and_b32 v107, 0xffff0000, v108
    v_add_f32 v104, v104, v106
    v_add_f32 v105, v105, v107
    v_cvt_pk_bf16_f32 v108, v104, v105
    v_lshlrev_b32 v104, 16, v108
    v_and_b32 v105, 0xffff0000, v108
    v_mul_f32 v106, v117, v77
    v_mul_f32 v107, v117, v76
    v_cvt_pk_bf16_f32 v108, v106, v107
    v_lshlrev_b32 v106, 16, v108
    v_and_b32 v107, 0xffff0000, v108
    v_add_f32 v104, v104, v106
    v_add_f32 v105, v105, v107
    v_cvt_pk_bf16_f32 v108, v104, v105
    v_lshlrev_b32 v104, 16, v108
    v_and_b32 v105, 0xffff0000, v108
    v_mul_f32 v106, v116, v78
    v_mul_f32 v107, v116, v77
    v_cvt_pk_bf16_f32 v108, v106, v107
    v_lshlrev_b32 v106, 16, v108
    v_and_b32 v107, 0xffff0000, v108
    v_add_f32 v104, v104, v106
    v_add_f32 v105, v105, v107
    v_cvt_pk_bf16_f32 v108, v104, v105
    v_lshlrev_b32 v104, 16, v108
    v_and_b32 v105, 0xffff0000, v108
    v_mul_f32 v104, v104, v103
    v_mul_f32 v105, v105, v102
    v_cvt_pk_bf16_f32 v124, v104, v105
    v_mul_f32 v104, v119, v73
    v_mul_f32 v105, v119, v72
    v_cvt_pk_bf16_f32 v108, v104, v105
    v_lshlrev_b32 v104, 16, v108
    v_and_b32 v105, 0xffff0000, v108
    v_mul_f32 v106, v118, v74
    v_mul_f32 v107, v118, v73
    v_cvt_pk_bf16_f32 v108, v106, v107
    v_lshlrev_b32 v106, 16, v108
    v_and_b32 v107, 0xffff0000, v108
    v_add_f32 v104, v104, v106
    v_add_f32 v105, v105, v107
    v_cvt_pk_bf16_f32 v108, v104, v105
    v_lshlrev_b32 v104, 16, v108
    v_and_b32 v105, 0xffff0000, v108
    v_mul_f32 v106, v117, v75
    v_mul_f32 v107, v117, v74
    v_cvt_pk_bf16_f32 v108, v106, v107
    v_lshlrev_b32 v106, 16, v108
    v_and_b32 v107, 0xffff0000, v108
    v_add_f32 v104, v104, v106
    v_add_f32 v105, v105, v107
    v_cvt_pk_bf16_f32 v108, v104, v105
    v_lshlrev_b32 v104, 16, v108
    v_and_b32 v105, 0xffff0000, v108
    v_mul_f32 v106, v116, v76
    v_mul_f32 v107, v116, v75
    v_cvt_pk_bf16_f32 v108, v106, v107
    v_lshlrev_b32 v106, 16, v108
    v_and_b32 v107, 0xffff0000, v108
    v_add_f32 v104, v104, v106
    v_add_f32 v105, v105, v107
    v_cvt_pk_bf16_f32 v108, v104, v105
    v_lshlrev_b32 v104, 16, v108
    v_and_b32 v105, 0xffff0000, v108
    v_mul_f32 v104, v104, v101
    v_mul_f32 v105, v105, v100
    v_cvt_pk_bf16_f32 v125, v104, v105
    s_mov_b32 s73, 27648
    buffer_store_dwordx2 v[124:125], v7, s[32:35], s73 offen
    v_and_b32 v72, 0xffff0000, v11
    v_and_b32 v73, 0xffff0000, v15
    v_and_b32 v74, 0xffff0000, v19
    v_and_b32 v75, 0xffff0000, v23
    v_and_b32 v76, 0xffff0000, v27
    v_and_b32 v77, 0xffff0000, v31
    v_and_b32 v78, 0xffff0000, v35
    v_and_b32 v100, 0xffff0000, v39
    v_and_b32 v101, 0xffff0000, v43
    v_and_b32 v102, 0xffff0000, v47
    v_and_b32 v103, 0xffff0000, v51
    v_lshlrev_b32 v116, 16, v66
    v_and_b32 v117, 0xffff0000, v66
    v_lshlrev_b32 v118, 16, v67
    v_and_b32 v119, 0xffff0000, v67
    v_mul_f32 v104, v119, v75
    v_mul_f32 v105, v119, v74
    v_cvt_pk_bf16_f32 v108, v104, v105
    v_lshlrev_b32 v104, 16, v108
    v_and_b32 v105, 0xffff0000, v108
    v_mul_f32 v106, v118, v76
    v_mul_f32 v107, v118, v75
    v_cvt_pk_bf16_f32 v108, v106, v107
    v_lshlrev_b32 v106, 16, v108
    v_and_b32 v107, 0xffff0000, v108
    v_add_f32 v104, v104, v106
    v_add_f32 v105, v105, v107
    v_cvt_pk_bf16_f32 v108, v104, v105
    v_lshlrev_b32 v104, 16, v108
    v_and_b32 v105, 0xffff0000, v108
    v_mul_f32 v106, v117, v77
    v_mul_f32 v107, v117, v76
    v_cvt_pk_bf16_f32 v108, v106, v107
    v_lshlrev_b32 v106, 16, v108
    v_and_b32 v107, 0xffff0000, v108
    v_add_f32 v104, v104, v106
    v_add_f32 v105, v105, v107
    v_cvt_pk_bf16_f32 v108, v104, v105
    v_lshlrev_b32 v104, 16, v108
    v_and_b32 v105, 0xffff0000, v108
    v_mul_f32 v106, v116, v78
    v_mul_f32 v107, v116, v77
    v_cvt_pk_bf16_f32 v108, v106, v107
    v_lshlrev_b32 v106, 16, v108
    v_and_b32 v107, 0xffff0000, v108
    v_add_f32 v104, v104, v106
    v_add_f32 v105, v105, v107
    v_cvt_pk_bf16_f32 v108, v104, v105
    v_lshlrev_b32 v104, 16, v108
    v_and_b32 v105, 0xffff0000, v108
    v_mul_f32 v104, v104, v103
    v_mul_f32 v105, v105, v102
    v_cvt_pk_bf16_f32 v126, v104, v105
    v_mul_f32 v104, v119, v73
    v_mul_f32 v105, v119, v72
    v_cvt_pk_bf16_f32 v108, v104, v105
    v_lshlrev_b32 v104, 16, v108
    v_and_b32 v105, 0xffff0000, v108
    v_mul_f32 v106, v118, v74
    v_mul_f32 v107, v118, v73
    v_cvt_pk_bf16_f32 v108, v106, v107
    v_lshlrev_b32 v106, 16, v108
    v_and_b32 v107, 0xffff0000, v108
    v_add_f32 v104, v104, v106
    v_add_f32 v105, v105, v107
    v_cvt_pk_bf16_f32 v108, v104, v105
    v_lshlrev_b32 v104, 16, v108
    v_and_b32 v105, 0xffff0000, v108
    v_mul_f32 v106, v117, v75
    v_mul_f32 v107, v117, v74
    v_cvt_pk_bf16_f32 v108, v106, v107
    v_lshlrev_b32 v106, 16, v108
    v_and_b32 v107, 0xffff0000, v108
    v_add_f32 v104, v104, v106
    v_add_f32 v105, v105, v107
    v_cvt_pk_bf16_f32 v108, v104, v105
    v_lshlrev_b32 v104, 16, v108
    v_and_b32 v105, 0xffff0000, v108
    v_mul_f32 v106, v116, v76
    v_mul_f32 v107, v116, v75
    v_cvt_pk_bf16_f32 v108, v106, v107
    v_lshlrev_b32 v106, 16, v108
    v_and_b32 v107, 0xffff0000, v108
    v_add_f32 v104, v104, v106
    v_add_f32 v105, v105, v107
    v_cvt_pk_bf16_f32 v108, v104, v105
    v_lshlrev_b32 v104, 16, v108
    v_and_b32 v105, 0xffff0000, v108
    v_mul_f32 v104, v104, v101
    v_mul_f32 v105, v105, v100
    v_cvt_pk_bf16_f32 v127, v104, v105
    s_mov_b32 s73, 32256
    buffer_store_dwordx2 v[126:127], v7, s[32:35], s73 offen
    s_endpgm
L_prep_pf:
    s_load_dwordx4 s[40:43], s[0:1], 56
    s_load_dwordx2 s[44:45], s[0:1], 72
    s_sub_u32 s3, s2, 208
    s_and_b32 s70, s3, 7
    s_lshr_b32 s71, s3, 3
    s_waitcnt lgkmcnt(0)
    s_mov_b32 s20, s40
    s_mov_b32 s21, s41
    s_mov_b32 s22, 5308416
    s_mov_b32 s23, 0x00020000
    s_mov_b32 s24, s42
    s_mov_b32 s25, s43
    s_mov_b32 s26, 5308416
    s_mov_b32 s27, 0x00020000
    s_mov_b32 s28, s44
    s_mov_b32 s29, s45
    s_mov_b32 s30, 5308416
    s_mov_b32 s31, 0x00020000
    s_mul_i32 s72, s71, 165888
    s_mul_i32 s73, s70, 1152
    s_add_u32 s72, s72, s73
    s_mov_b32 s74, 0x38e38e4
    s_movk_i32 s75, 9216
    v_add_u32 v1, 0, v0
    v_mul_hi_u32 v2, v1, s74
    v_mul_u32_u24 v3, 72, v2
    v_sub_u32 v3, v1, v3
    v_mul_lo_u32 v2, v2, s75
    v_lshl_add_u32 v2, v3, 4, v2
    v_add_u32 v2, s72, v2
    buffer_load_dwordx4 v[8:11], v2, s[20:23], 0 offen
    buffer_load_dwordx4 v[12:15], v2, s[24:27], 0 offen
    v_add_u32 v1, 256, v0
    v_mul_hi_u32 v2, v1, s74
    v_mul_u32_u24 v3, 72, v2
    v_sub_u32 v3, v1, v3
    v_mul_lo_u32 v2, v2, s75
    v_lshl_add_u32 v2, v3, 4, v2
    v_add_u32 v2, s72, v2
    buffer_load_dwordx4 v[16:19], v2, s[20:23], 0 offen
    buffer_load_dwordx4 v[20:23], v2, s[24:27], 0 offen
    v_add_u32 v1, 512, v0
    v_mul_hi_u32 v2, v1, s74
    v_mul_u32_u24 v3, 72, v2
    v_sub_u32 v3, v1, v3
    v_mul_lo_u32 v2, v2, s75
    v_lshl_add_u32 v2, v3, 4, v2
    v_add_u32 v2, s72, v2
    buffer_load_dwordx4 v[24:27], v2, s[20:23], 0 offen
    buffer_load_dwordx4 v[28:31], v2, s[24:27], 0 offen
    v_add_u32 v1, 768, v0
    v_mul_hi_u32 v2, v1, s74
    v_mul_u32_u24 v3, 72, v2
    v_sub_u32 v3, v1, v3
    v_mul_lo_u32 v2, v2, s75
    v_lshl_add_u32 v2, v3, 4, v2
    v_add_u32 v2, s72, v2
    buffer_load_dwordx4 v[32:35], v2, s[20:23], 0 offen
    buffer_load_dwordx4 v[36:39], v2, s[24:27], 0 offen
    v_add_u32 v1, 1024, v0
    v_mul_hi_u32 v2, v1, s74
    v_mul_u32_u24 v3, 72, v2
    v_sub_u32 v3, v1, v3
    v_mul_lo_u32 v2, v2, s75
    v_lshl_add_u32 v2, v3, 4, v2
    v_add_u32 v2, s72, v2
    buffer_load_dwordx4 v[40:43], v2, s[20:23], 0 offen
    buffer_load_dwordx4 v[44:47], v2, s[24:27], 0 offen
    v_add_u32 v1, 1280, v0
    v_mul_hi_u32 v2, v1, s74
    v_mul_u32_u24 v3, 72, v2
    v_sub_u32 v3, v1, v3
    v_mul_lo_u32 v2, v2, s75
    v_lshl_add_u32 v2, v3, 4, v2
    v_add_u32 v2, s72, v2
    v_cmp_gt_u32 vcc, 16, v0
    s_and_saveexec_b64 s[76:77], vcc
    buffer_load_dwordx4 v[48:51], v2, s[20:23], 0 offen
    buffer_load_dwordx4 v[52:55], v2, s[24:27], 0 offen
    s_mov_b64 exec, s[76:77]
    s_getpc_b64 s[78:79]
L_pc_anchor:
    s_add_u32 s78, s78, gemm1_kernel-L_pc_anchor
    s_addc_u32 s79, s79, 0
    s_lshl_b32 s73, s71, 11
    v_lshlrev_b32 v1, 3, v0
    v_add_u32 v1, s73, v1
    s_mov_b32 s73, L_final_kernel_exit-gemm1_kernel
    v_cmp_gt_u32 vcc, s73, v1
    s_and_saveexec_b64 s[76:77], vcc
    s_cbranch_execz L_pc_skip
    global_load_dwordx2 v[60:61], v1, s[78:79]
L_pc_skip:
    s_mov_b64 exec, s[76:77]
    s_endpgm
L_prep_exit:
    s_endpgm
.globl gemm1_kernel
.p2align 8
.type gemm1_kernel,@function
gemm1_kernel:

    s_cmp_ge_u32 s2, 256
    s_cbranch_scc1 L_gemm1_kernel_exit
    s_load_dwordx4 s[4:7], s[0:1], 56
    s_load_dwordx2 s[8:9], s[0:1], 72
    s_load_dwordx2 s[10:11], s[0:1], 96
    s_and_b32 s12, s2, 7
    s_lshr_b32 s13, s2, 3
    s_and_b32 s14, s13, 3
    s_lshl_b32 s15, s12, 2
    s_add_u32 s14, s14, s15
    s_lshr_b32 s15, s13, 2
    v_lshrrev_b32 v1, 6, v0
    v_and_b32 v2, 63, v0
    v_readfirstlane_b32 s17, v1
    s_mul_i32 s18, s14, 288
    s_and_b32 s19, s17, 1
    s_mul_i32 s19, s19, 576
    s_movk_i32 s32, 3641
    s_movk_i32 s33, 18
    s_mov_b32 s34, 9216
    v_add_u32 v3, s19, v2
    v_mul_lo_u32 v4, v3, s32
    v_lshrrev_b32 v4, 16, v4
    v_mul_lo_u32 v5, v4, s33
    v_sub_u32 v5, v3, v5
    v_and_b32 v6, 0xe3, v4
    v_bfe_u32 v7, v4, 2, 2
    v_lshl_add_u32 v6, v7, 3, v6
    v_bfe_u32 v7, v4, 4, 1
    v_lshl_add_u32 v4, v7, 2, v6
    v_mul_lo_u32 v4, v4, s34
    v_lshl_add_u32 v4, v5, 4, v4
    v_add_u32 v8, s18, v4
    v_add_u32 v3, s19, v2
    v_add_u32 v3, 64, v3
    v_mul_lo_u32 v4, v3, s32
    v_lshrrev_b32 v4, 16, v4
    v_mul_lo_u32 v5, v4, s33
    v_sub_u32 v5, v3, v5
    v_and_b32 v6, 0xe3, v4
    v_bfe_u32 v7, v4, 2, 2
    v_lshl_add_u32 v6, v7, 3, v6
    v_bfe_u32 v7, v4, 4, 1
    v_lshl_add_u32 v4, v7, 2, v6
    v_mul_lo_u32 v4, v4, s34
    v_lshl_add_u32 v4, v5, 4, v4
    v_add_u32 v9, s18, v4
    v_add_u32 v3, s19, v2
    v_add_u32 v3, 128, v3
    v_mul_lo_u32 v4, v3, s32
    v_lshrrev_b32 v4, 16, v4
    v_mul_lo_u32 v5, v4, s33
    v_sub_u32 v5, v3, v5
    v_and_b32 v6, 0xe3, v4
    v_bfe_u32 v7, v4, 2, 2
    v_lshl_add_u32 v6, v7, 3, v6
    v_bfe_u32 v7, v4, 4, 1
    v_lshl_add_u32 v4, v7, 2, v6
    v_mul_lo_u32 v4, v4, s34
    v_lshl_add_u32 v4, v5, 4, v4
    v_add_u32 v10, s18, v4
    v_add_u32 v3, s19, v2
    v_add_u32 v3, 192, v3
    v_mul_lo_u32 v4, v3, s32
    v_lshrrev_b32 v4, 16, v4
    v_mul_lo_u32 v5, v4, s33
    v_sub_u32 v5, v3, v5
    v_and_b32 v6, 0xe3, v4
    v_bfe_u32 v7, v4, 2, 2
    v_lshl_add_u32 v6, v7, 3, v6
    v_bfe_u32 v7, v4, 4, 1
    v_lshl_add_u32 v4, v7, 2, v6
    v_mul_lo_u32 v4, v4, s34
    v_lshl_add_u32 v4, v5, 4, v4
    v_add_u32 v11, s18, v4
    v_add_u32 v3, s19, v2
    v_add_u32 v3, 256, v3
    v_mul_lo_u32 v4, v3, s32
    v_lshrrev_b32 v4, 16, v4
    v_mul_lo_u32 v5, v4, s33
    v_sub_u32 v5, v3, v5
    v_and_b32 v6, 0xe3, v4
    v_bfe_u32 v7, v4, 2, 2
    v_lshl_add_u32 v6, v7, 3, v6
    v_bfe_u32 v7, v4, 4, 1
    v_lshl_add_u32 v4, v7, 2, v6
    v_mul_lo_u32 v4, v4, s34
    v_lshl_add_u32 v4, v5, 4, v4
    v_add_u32 v12, s18, v4
    v_add_u32 v3, s19, v2
    v_add_u32 v3, 320, v3
    v_mul_lo_u32 v4, v3, s32
    v_lshrrev_b32 v4, 16, v4
    v_mul_lo_u32 v5, v4, s33
    v_sub_u32 v5, v3, v5
    v_and_b32 v6, 0xe3, v4
    v_bfe_u32 v7, v4, 2, 2
    v_lshl_add_u32 v6, v7, 3, v6
    v_bfe_u32 v7, v4, 4, 1
    v_lshl_add_u32 v4, v7, 2, v6
    v_mul_lo_u32 v4, v4, s34
    v_lshl_add_u32 v4, v5, 4, v4
    v_add_u32 v13, s18, v4
    v_add_u32 v3, s19, v2
    v_add_u32 v3, 384, v3
    v_mul_lo_u32 v4, v3, s32
    v_lshrrev_b32 v4, 16, v4
    v_mul_lo_u32 v5, v4, s33
    v_sub_u32 v5, v3, v5
    v_and_b32 v6, 0xe3, v4
    v_bfe_u32 v7, v4, 2, 2
    v_lshl_add_u32 v6, v7, 3, v6
    v_bfe_u32 v7, v4, 4, 1
    v_lshl_add_u32 v4, v7, 2, v6
    v_mul_lo_u32 v4, v4, s34
    v_lshl_add_u32 v4, v5, 4, v4
    v_add_u32 v14, s18, v4
    v_add_u32 v3, s19, v2
    v_add_u32 v3, 448, v3
    v_mul_lo_u32 v4, v3, s32
    v_lshrrev_b32 v4, 16, v4
    v_mul_lo_u32 v5, v4, s33
    v_sub_u32 v5, v3, v5
    v_and_b32 v6, 0xe3, v4
    v_bfe_u32 v7, v4, 2, 2
    v_lshl_add_u32 v6, v7, 3, v6
    v_bfe_u32 v7, v4, 4, 1
    v_lshl_add_u32 v4, v7, 2, v6
    v_mul_lo_u32 v4, v4, s34
    v_lshl_add_u32 v4, v5, 4, v4
    v_add_u32 v15, s18, v4
    v_add_u32 v3, s19, v2
    v_add_u32 v3, 512, v3
    v_mul_lo_u32 v4, v3, s32
    v_lshrrev_b32 v4, 16, v4
    v_mul_lo_u32 v5, v4, s33
    v_sub_u32 v5, v3, v5
    v_and_b32 v6, 0xe3, v4
    v_bfe_u32 v7, v4, 2, 2
    v_lshl_add_u32 v6, v7, 3, v6
    v_bfe_u32 v7, v4, 4, 1
    v_lshl_add_u32 v4, v7, 2, v6
    v_mul_lo_u32 v4, v4, s34
    v_lshl_add_u32 v4, v5, 4, v4
    v_add_u32 v16, s18, v4
    s_mul_i32 s35, s17, 9216
    s_lshl_b32 s36, s15, 4
    s_lshl_b32 s37, s17, 2
    s_add_u32 s36, s36, s37
    s_mul_i32 s36, s36, 18432
    v_lshlrev_b32 v3, 4, v2
    v_add_u32 v17, s36, v3
    v_add_u32 v18, 18432, v17
    v_add_u32 v19, 36864, v17
    v_add_u32 v20, 55296, v17
    v_lshrrev_b32 v3, 4, v2
    v_bfe_u32 v4, v2, 2, 2
    v_lshl_add_u32 v3, v3, 2, v4
    s_movk_i32 s37, 288
    v_mul_lo_u32 v3, v3, s37
    v_and_b32 v4, 3, v2
    v_lshl_add_u32 v21, v4, 3, v3
    v_add_u32 v22, 36864, v21
    v_add_u32 v23, 73728, v21
    v_add_u32 v24, 110592, v21
    s_waitcnt lgkmcnt(0)
    s_cmp_ge_u32 s17, 2
    s_cselect_b32 s20, s6, s4
    s_cselect_b32 s21, s7, s5
    s_mov_b32 s22, 5308416
    s_mov_b32 s23, 0x00020000
    s_mov_b32 s24, s10
    s_mov_b32 s25, s11
    s_mov_b32 s26, 2359296
    s_mov_b32 s27, 0x00020000
    s_add_u32 s28, s10, 7077888
    s_addc_u32 s29, s11, 0
    s_mov_b32 s30, 18874368
    s_mov_b32 s31, 0x00020000
    s_mov_b32 s88, s8
    s_mov_b32 s89, s9
    s_mov_b32 s90, 5308416
    s_mov_b32 s91, 0x00020000
    s_lshr_b32 s92, s12, 1
    s_mul_i32 s92, s92, 1327104
    s_mul_i32 s93, s13, 41472
    s_add_u32 s92, s92, s93
    s_mul_i32 s93, s17, 10368
    s_add_u32 s92, s92, s93
    v_lshlrev_b32 v25, 4, v2
    v_add_u32 v25, s92, v25
    s_add_u32 m0, s35, 0
    s_mov_b32 s38, 0
    buffer_load_dwordx4 v8, s[20:23], s38 offen lds
    s_add_u32 m0, s35, 1024
    s_mov_b32 s38, 0
    buffer_load_dwordx4 v9, s[20:23], s38 offen lds
    s_add_u32 m0, s35, 2048
    s_mov_b32 s38, 0
    buffer_load_dwordx4 v10, s[20:23], s38 offen lds
    s_add_u32 m0, s35, 3072
    s_mov_b32 s38, 0
    buffer_load_dwordx4 v11, s[20:23], s38 offen lds
    s_add_u32 m0, s35, 4096
    s_mov_b32 s38, 0
    buffer_load_dwordx4 v12, s[20:23], s38 offen lds
    s_add_u32 m0, s35, 5120
    s_mov_b32 s38, 0
    buffer_load_dwordx4 v13, s[20:23], s38 offen lds
    s_add_u32 m0, s35, 6144
    s_mov_b32 s38, 0
    buffer_load_dwordx4 v14, s[20:23], s38 offen lds
    s_add_u32 m0, s35, 7168
    s_mov_b32 s38, 0
    buffer_load_dwordx4 v15, s[20:23], s38 offen lds
    s_add_u32 m0, s35, 8192
    s_mov_b32 s38, 0
    buffer_load_dwordx4 v16, s[20:23], s38 offen lds
    s_mov_b32 s39, 0
    buffer_load_dwordx4 v[28:31], v17, s[24:27], s39 offen
    s_mov_b32 s39, 0
    buffer_load_dwordx4 v[32:35], v18, s[24:27], s39 offen
    s_mov_b32 s39, 0
    buffer_load_dwordx4 v[36:39], v19, s[24:27], s39 offen
    s_mov_b32 s39, 0
    buffer_load_dwordx4 v[40:43], v20, s[24:27], s39 offen
    s_waitcnt vmcnt(4)
    s_barrier
    ds_read_b64_tr_b16 v[92:93], v21 offset:0
    ds_read_b64_tr_b16 v[94:95], v21 offset:4608
    ds_read_b64_tr_b16 v[96:97], v21 offset:18432
    ds_read_b64_tr_b16 v[98:99], v21 offset:23040
    ds_read_b64_tr_b16 v[100:101], v21 offset:32
    ds_read_b64_tr_b16 v[102:103], v21 offset:4640
    ds_read_b64_tr_b16 v[104:105], v21 offset:18464
    ds_read_b64_tr_b16 v[106:107], v21 offset:23072
    s_waitcnt vmcnt(0)
    s_waitcnt lgkmcnt(4)
    v_mfma_f32_16x16x32_bf16 a[0:3], v[92:95], v[28:31], 0
    ds_read_b64_tr_b16 v[108:109], v21 offset:64
    v_mfma_f32_16x16x32_bf16 a[4:7], v[92:95], v[32:35], 0
    ds_read_b64_tr_b16 v[110:111], v21 offset:4672
    v_mfma_f32_16x16x32_bf16 a[8:11], v[92:95], v[36:39], 0
    ds_read_b64_tr_b16 v[112:113], v21 offset:18496
    v_mfma_f32_16x16x32_bf16 a[12:15], v[92:95], v[40:43], 0
    ds_read_b64_tr_b16 v[114:115], v21 offset:23104
    v_mfma_f32_16x16x32_bf16 a[16:19], v[96:99], v[28:31], 0
    s_mov_b32 s39, 1024
    buffer_load_dwordx4 v[44:47], v17, s[24:27], s39 offen
    v_mfma_f32_16x16x32_bf16 a[20:23], v[96:99], v[32:35], 0
    s_mov_b32 s39, 1024
    buffer_load_dwordx4 v[48:51], v18, s[24:27], s39 offen
    v_mfma_f32_16x16x32_bf16 a[24:27], v[96:99], v[36:39], 0
    s_mov_b32 s39, 1024
    buffer_load_dwordx4 v[52:55], v19, s[24:27], s39 offen
    v_mfma_f32_16x16x32_bf16 a[28:31], v[96:99], v[40:43], 0
    s_waitcnt lgkmcnt(4)
    v_mfma_f32_16x16x32_bf16 a[32:35], v[100:103], v[28:31], 0
    ds_read_b64_tr_b16 v[92:93], v21 offset:96
    v_mfma_f32_16x16x32_bf16 a[36:39], v[100:103], v[32:35], 0
    ds_read_b64_tr_b16 v[94:95], v21 offset:4704
    v_mfma_f32_16x16x32_bf16 a[40:43], v[100:103], v[36:39], 0
    ds_read_b64_tr_b16 v[96:97], v21 offset:18528
    v_mfma_f32_16x16x32_bf16 a[44:47], v[100:103], v[40:43], 0
    ds_read_b64_tr_b16 v[98:99], v21 offset:23136
    v_mfma_f32_16x16x32_bf16 a[48:51], v[104:107], v[28:31], 0
    s_mov_b32 s39, 1024
    buffer_load_dwordx4 v[56:59], v20, s[24:27], s39 offen
    v_mfma_f32_16x16x32_bf16 a[52:55], v[104:107], v[32:35], 0
    s_add_u32 m0, s35, 36864
    s_mov_b32 s38, 589824
    buffer_load_dwordx4 v8, s[20:23], s38 offen lds
    v_mfma_f32_16x16x32_bf16 a[56:59], v[104:107], v[36:39], 0
    s_add_u32 m0, s35, 37888
    s_mov_b32 s38, 589824
    buffer_load_dwordx4 v9, s[20:23], s38 offen lds
    v_mfma_f32_16x16x32_bf16 a[60:63], v[104:107], v[40:43], 0
    s_waitcnt lgkmcnt(4)
    v_mfma_f32_16x16x32_bf16 a[64:67], v[108:111], v[28:31], 0
    ds_read_b64_tr_b16 v[100:101], v21 offset:128
    v_mfma_f32_16x16x32_bf16 a[68:71], v[108:111], v[32:35], 0
    ds_read_b64_tr_b16 v[102:103], v21 offset:4736
    v_mfma_f32_16x16x32_bf16 a[72:75], v[108:111], v[36:39], 0
    ds_read_b64_tr_b16 v[104:105], v21 offset:18560
    v_mfma_f32_16x16x32_bf16 a[76:79], v[108:111], v[40:43], 0
    ds_read_b64_tr_b16 v[106:107], v21 offset:23168
    v_mfma_f32_16x16x32_bf16 a[80:83], v[112:115], v[28:31], 0
    s_add_u32 m0, s35, 38912
    s_mov_b32 s38, 589824
    buffer_load_dwordx4 v10, s[20:23], s38 offen lds
    v_mfma_f32_16x16x32_bf16 a[84:87], v[112:115], v[32:35], 0
    s_add_u32 m0, s35, 39936
    s_mov_b32 s38, 589824
    buffer_load_dwordx4 v11, s[20:23], s38 offen lds
    v_mfma_f32_16x16x32_bf16 a[88:91], v[112:115], v[36:39], 0
    s_add_u32 m0, s35, 40960
    s_mov_b32 s38, 589824
    buffer_load_dwordx4 v12, s[20:23], s38 offen lds
    v_mfma_f32_16x16x32_bf16 a[92:95], v[112:115], v[40:43], 0
    s_waitcnt lgkmcnt(4)
    v_mfma_f32_16x16x32_bf16 a[96:99], v[92:95], v[28:31], 0
    ds_read_b64_tr_b16 v[108:109], v21 offset:160
    v_mfma_f32_16x16x32_bf16 a[100:103], v[92:95], v[32:35], 0
    ds_read_b64_tr_b16 v[110:111], v21 offset:4768
    v_mfma_f32_16x16x32_bf16 a[104:107], v[92:95], v[36:39], 0
    ds_read_b64_tr_b16 v[112:113], v21 offset:18592
    v_mfma_f32_16x16x32_bf16 a[108:111], v[92:95], v[40:43], 0
    ds_read_b64_tr_b16 v[114:115], v21 offset:23200
    v_mfma_f32_16x16x32_bf16 a[112:115], v[96:99], v[28:31], 0
    s_add_u32 m0, s35, 41984
    s_mov_b32 s38, 589824
    buffer_load_dwordx4 v13, s[20:23], s38 offen lds
    v_mfma_f32_16x16x32_bf16 a[116:119], v[96:99], v[32:35], 0
    s_add_u32 m0, s35, 43008
    s_mov_b32 s38, 589824
    buffer_load_dwordx4 v14, s[20:23], s38 offen lds
    v_mfma_f32_16x16x32_bf16 a[120:123], v[96:99], v[36:39], 0
    s_add_u32 m0, s35, 44032
    s_mov_b32 s38, 589824
    buffer_load_dwordx4 v15, s[20:23], s38 offen lds
    v_mfma_f32_16x16x32_bf16 a[124:127], v[96:99], v[40:43], 0
    s_waitcnt lgkmcnt(4)
    v_mfma_f32_16x16x32_bf16 a[128:131], v[100:103], v[28:31], 0
    ds_read_b64_tr_b16 v[92:93], v21 offset:192
    v_mfma_f32_16x16x32_bf16 a[132:135], v[100:103], v[32:35], 0
    ds_read_b64_tr_b16 v[94:95], v21 offset:4800
    v_mfma_f32_16x16x32_bf16 a[136:139], v[100:103], v[36:39], 0
    ds_read_b64_tr_b16 v[96:97], v21 offset:18624
    v_mfma_f32_16x16x32_bf16 a[140:143], v[100:103], v[40:43], 0
    ds_read_b64_tr_b16 v[98:99], v21 offset:23232
    v_mfma_f32_16x16x32_bf16 a[144:147], v[104:107], v[28:31], 0
    s_add_u32 m0, s35, 45056
    s_mov_b32 s38, 589824
    buffer_load_dwordx4 v16, s[20:23], s38 offen lds
    v_mfma_f32_16x16x32_bf16 a[148:151], v[104:107], v[32:35], 0
    s_mov_b32 s39, 2048
    buffer_load_dwordx4 v[60:63], v17, s[24:27], s39 offen
    v_mfma_f32_16x16x32_bf16 a[152:155], v[104:107], v[36:39], 0
    s_mov_b32 s39, 2048
    buffer_load_dwordx4 v[64:67], v18, s[24:27], s39 offen
    v_mfma_f32_16x16x32_bf16 a[156:159], v[104:107], v[40:43], 0
    s_waitcnt lgkmcnt(4)
    v_mfma_f32_16x16x32_bf16 a[160:163], v[108:111], v[28:31], 0
    ds_read_b64_tr_b16 v[100:101], v21 offset:224
    v_mfma_f32_16x16x32_bf16 a[164:167], v[108:111], v[32:35], 0
    ds_read_b64_tr_b16 v[102:103], v21 offset:4832
    v_mfma_f32_16x16x32_bf16 a[168:171], v[108:111], v[36:39], 0
    ds_read_b64_tr_b16 v[104:105], v21 offset:18656
    v_mfma_f32_16x16x32_bf16 a[172:175], v[108:111], v[40:43], 0
    ds_read_b64_tr_b16 v[106:107], v21 offset:23264
    v_mfma_f32_16x16x32_bf16 a[176:179], v[112:115], v[28:31], 0
    s_mov_b32 s39, 2048
    buffer_load_dwordx4 v[68:71], v19, s[24:27], s39 offen
    v_mfma_f32_16x16x32_bf16 a[180:183], v[112:115], v[32:35], 0
    s_mov_b32 s39, 2048
    buffer_load_dwordx4 v[72:75], v20, s[24:27], s39 offen
    v_mfma_f32_16x16x32_bf16 a[184:187], v[112:115], v[36:39], 0
    s_add_u32 m0, s35, 73728
    s_mov_b32 s38, 1179648
    buffer_load_dwordx4 v8, s[20:23], s38 offen lds
    v_mfma_f32_16x16x32_bf16 a[188:191], v[112:115], v[40:43], 0
    s_waitcnt lgkmcnt(4)
    v_mfma_f32_16x16x32_bf16 a[192:195], v[92:95], v[28:31], 0
    ds_read_b64_tr_b16 v[108:109], v21 offset:256
    v_mfma_f32_16x16x32_bf16 a[196:199], v[92:95], v[32:35], 0
    ds_read_b64_tr_b16 v[110:111], v21 offset:4864
    v_mfma_f32_16x16x32_bf16 a[200:203], v[92:95], v[36:39], 0
    ds_read_b64_tr_b16 v[112:113], v21 offset:18688
    v_mfma_f32_16x16x32_bf16 a[204:207], v[92:95], v[40:43], 0
    ds_read_b64_tr_b16 v[114:115], v21 offset:23296
    v_mfma_f32_16x16x32_bf16 a[208:211], v[96:99], v[28:31], 0
    s_add_u32 m0, s35, 74752
    s_mov_b32 s38, 1179648
    buffer_load_dwordx4 v9, s[20:23], s38 offen lds
    v_mfma_f32_16x16x32_bf16 a[212:215], v[96:99], v[32:35], 0
    s_add_u32 m0, s35, 75776
    s_mov_b32 s38, 1179648
    buffer_load_dwordx4 v10, s[20:23], s38 offen lds
    v_mfma_f32_16x16x32_bf16 a[216:219], v[96:99], v[36:39], 0
    s_add_u32 m0, s35, 76800
    s_mov_b32 s38, 1179648
    buffer_load_dwordx4 v11, s[20:23], s38 offen lds
    v_mfma_f32_16x16x32_bf16 a[220:223], v[96:99], v[40:43], 0
    s_waitcnt lgkmcnt(4)
    v_mfma_f32_16x16x32_bf16 a[224:227], v[100:103], v[28:31], 0
    ds_read_b64_tr_b16 v[92:93], v21 offset:9216
    v_mfma_f32_16x16x32_bf16 a[228:231], v[100:103], v[32:35], 0
    ds_read_b64_tr_b16 v[94:95], v21 offset:13824
    v_mfma_f32_16x16x32_bf16 a[232:235], v[100:103], v[36:39], 0
    ds_read_b64_tr_b16 v[96:97], v21 offset:27648
    v_mfma_f32_16x16x32_bf16 a[236:239], v[100:103], v[40:43], 0
    ds_read_b64_tr_b16 v[98:99], v21 offset:32256
    v_mfma_f32_16x16x32_bf16 a[240:243], v[104:107], v[28:31], 0
    s_add_u32 m0, s35, 77824
    s_mov_b32 s38, 1179648
    buffer_load_dwordx4 v12, s[20:23], s38 offen lds
    v_mfma_f32_16x16x32_bf16 a[244:247], v[104:107], v[32:35], 0
    s_add_u32 m0, s35, 78848
    s_mov_b32 s38, 1179648
    buffer_load_dwordx4 v13, s[20:23], s38 offen lds
    v_mfma_f32_16x16x32_bf16 a[248:251], v[104:107], v[36:39], 0
    s_add_u32 m0, s35, 79872
    s_mov_b32 s38, 1179648
    buffer_load_dwordx4 v14, s[20:23], s38 offen lds
    v_mfma_f32_16x16x32_bf16 a[252:255], v[104:107], v[40:43], 0
    s_waitcnt lgkmcnt(4)
    v_mfma_f32_16x16x32_bf16 v[116:119], v[108:111], v[28:31], 0
    ds_read_b64_tr_b16 v[100:101], v21 offset:9248
    v_mfma_f32_16x16x32_bf16 v[120:123], v[108:111], v[32:35], 0
    ds_read_b64_tr_b16 v[102:103], v21 offset:13856
    v_mfma_f32_16x16x32_bf16 v[124:127], v[108:111], v[36:39], 0
    ds_read_b64_tr_b16 v[104:105], v21 offset:27680
    v_mfma_f32_16x16x32_bf16 v[128:131], v[108:111], v[40:43], 0
    ds_read_b64_tr_b16 v[106:107], v21 offset:32288
    v_mfma_f32_16x16x32_bf16 v[132:135], v[112:115], v[28:31], 0
    s_add_u32 m0, s35, 80896
    s_mov_b32 s38, 1179648
    buffer_load_dwordx4 v15, s[20:23], s38 offen lds
    v_mfma_f32_16x16x32_bf16 v[136:139], v[112:115], v[32:35], 0
    s_add_u32 m0, s35, 81920
    s_mov_b32 s38, 1179648
    buffer_load_dwordx4 v16, s[20:23], s38 offen lds
    v_mfma_f32_16x16x32_bf16 v[140:143], v[112:115], v[36:39], 0
    s_mov_b32 s39, 3072
    buffer_load_dwordx4 v[76:79], v17, s[24:27], s39 offen
    v_mfma_f32_16x16x32_bf16 v[144:147], v[112:115], v[40:43], 0
    s_waitcnt vmcnt(23)
    s_waitcnt lgkmcnt(4)
    v_mfma_f32_16x16x32_bf16 a[0:3], v[92:95], v[44:47], a[0:3]
    ds_read_b64_tr_b16 v[108:109], v21 offset:9280
    v_mfma_f32_16x16x32_bf16 a[4:7], v[92:95], v[48:51], a[4:7]
    ds_read_b64_tr_b16 v[110:111], v21 offset:13888
    v_mfma_f32_16x16x32_bf16 a[8:11], v[92:95], v[52:55], a[8:11]
    ds_read_b64_tr_b16 v[112:113], v21 offset:27712
    v_mfma_f32_16x16x32_bf16 a[12:15], v[92:95], v[56:59], a[12:15]
    ds_read_b64_tr_b16 v[114:115], v21 offset:32320
    v_mfma_f32_16x16x32_bf16 a[16:19], v[96:99], v[44:47], a[16:19]
    s_mov_b32 s39, 3072
    buffer_load_dwordx4 v[80:83], v18, s[24:27], s39 offen
    v_mfma_f32_16x16x32_bf16 a[20:23], v[96:99], v[48:51], a[20:23]
    s_mov_b32 s39, 3072
    buffer_load_dwordx4 v[84:87], v19, s[24:27], s39 offen
    v_mfma_f32_16x16x32_bf16 a[24:27], v[96:99], v[52:55], a[24:27]
    s_mov_b32 s39, 3072
    buffer_load_dwordx4 v[88:91], v20, s[24:27], s39 offen
    v_mfma_f32_16x16x32_bf16 a[28:31], v[96:99], v[56:59], a[28:31]
    s_waitcnt lgkmcnt(4)
    v_mfma_f32_16x16x32_bf16 a[32:35], v[100:103], v[44:47], a[32:35]
    ds_read_b64_tr_b16 v[92:93], v21 offset:9312
    v_mfma_f32_16x16x32_bf16 a[36:39], v[100:103], v[48:51], a[36:39]
    ds_read_b64_tr_b16 v[94:95], v21 offset:13920
    v_mfma_f32_16x16x32_bf16 a[40:43], v[100:103], v[52:55], a[40:43]
    ds_read_b64_tr_b16 v[96:97], v21 offset:27744
    v_mfma_f32_16x16x32_bf16 a[44:47], v[100:103], v[56:59], a[44:47]
    ds_read_b64_tr_b16 v[98:99], v21 offset:32352
    v_mfma_f32_16x16x32_bf16 a[48:51], v[104:107], v[44:47], a[48:51]
    s_mov_b32 s39, 4096
    buffer_load_dwordx4 v[28:31], v17, s[24:27], s39 offen
    v_mfma_f32_16x16x32_bf16 a[52:55], v[104:107], v[48:51], a[52:55]
    s_mov_b32 s39, 4096
    buffer_load_dwordx4 v[32:35], v18, s[24:27], s39 offen
    v_mfma_f32_16x16x32_bf16 a[56:59], v[104:107], v[52:55], a[56:59]
    s_mov_b32 s39, 4096
    buffer_load_dwordx4 v[36:39], v19, s[24:27], s39 offen
    v_mfma_f32_16x16x32_bf16 a[60:63], v[104:107], v[56:59], a[60:63]
    s_waitcnt lgkmcnt(4)
    v_mfma_f32_16x16x32_bf16 a[64:67], v[108:111], v[44:47], a[64:67]
    ds_read_b64_tr_b16 v[100:101], v21 offset:9344
    v_mfma_f32_16x16x32_bf16 a[68:71], v[108:111], v[48:51], a[68:71]
    ds_read_b64_tr_b16 v[102:103], v21 offset:13952
    v_mfma_f32_16x16x32_bf16 a[72:75], v[108:111], v[52:55], a[72:75]
    ds_read_b64_tr_b16 v[104:105], v21 offset:27776
    v_mfma_f32_16x16x32_bf16 a[76:79], v[108:111], v[56:59], a[76:79]
    ds_read_b64_tr_b16 v[106:107], v21 offset:32384
    v_mfma_f32_16x16x32_bf16 a[80:83], v[112:115], v[44:47], a[80:83]
    s_mov_b32 s39, 4096
    buffer_load_dwordx4 v[40:43], v20, s[24:27], s39 offen
    v_mfma_f32_16x16x32_bf16 a[84:87], v[112:115], v[48:51], a[84:87]
    v_mfma_f32_16x16x32_bf16 a[88:91], v[112:115], v[52:55], a[88:91]
    v_mfma_f32_16x16x32_bf16 a[92:95], v[112:115], v[56:59], a[92:95]
    s_waitcnt lgkmcnt(4)
    v_mfma_f32_16x16x32_bf16 a[96:99], v[92:95], v[44:47], a[96:99]
    ds_read_b64_tr_b16 v[108:109], v21 offset:9376
    v_mfma_f32_16x16x32_bf16 a[100:103], v[92:95], v[48:51], a[100:103]
    ds_read_b64_tr_b16 v[110:111], v21 offset:13984
    v_mfma_f32_16x16x32_bf16 a[104:107], v[92:95], v[52:55], a[104:107]
    ds_read_b64_tr_b16 v[112:113], v21 offset:27808
    v_mfma_f32_16x16x32_bf16 a[108:111], v[92:95], v[56:59], a[108:111]
    ds_read_b64_tr_b16 v[114:115], v21 offset:32416
    v_mfma_f32_16x16x32_bf16 a[112:115], v[96:99], v[44:47], a[112:115]
    v_mfma_f32_16x16x32_bf16 a[116:119], v[96:99], v[48:51], a[116:119]
    v_mfma_f32_16x16x32_bf16 a[120:123], v[96:99], v[52:55], a[120:123]
    v_mfma_f32_16x16x32_bf16 a[124:127], v[96:99], v[56:59], a[124:127]
    s_waitcnt lgkmcnt(4)
    v_mfma_f32_16x16x32_bf16 a[128:131], v[100:103], v[44:47], a[128:131]
    ds_read_b64_tr_b16 v[92:93], v21 offset:9408
    v_mfma_f32_16x16x32_bf16 a[132:135], v[100:103], v[48:51], a[132:135]
    ds_read_b64_tr_b16 v[94:95], v21 offset:14016
    v_mfma_f32_16x16x32_bf16 a[136:139], v[100:103], v[52:55], a[136:139]
    ds_read_b64_tr_b16 v[96:97], v21 offset:27840
    v_mfma_f32_16x16x32_bf16 a[140:143], v[100:103], v[56:59], a[140:143]
    ds_read_b64_tr_b16 v[98:99], v21 offset:32448
    v_mfma_f32_16x16x32_bf16 a[144:147], v[104:107], v[44:47], a[144:147]
    v_mfma_f32_16x16x32_bf16 a[148:151], v[104:107], v[48:51], a[148:151]
    v_mfma_f32_16x16x32_bf16 a[152:155], v[104:107], v[52:55], a[152:155]
    v_mfma_f32_16x16x32_bf16 a[156:159], v[104:107], v[56:59], a[156:159]
    s_waitcnt lgkmcnt(4)
    v_mfma_f32_16x16x32_bf16 a[160:163], v[108:111], v[44:47], a[160:163]
    ds_read_b64_tr_b16 v[100:101], v21 offset:9440
    v_mfma_f32_16x16x32_bf16 a[164:167], v[108:111], v[48:51], a[164:167]
    ds_read_b64_tr_b16 v[102:103], v21 offset:14048
    v_mfma_f32_16x16x32_bf16 a[168:171], v[108:111], v[52:55], a[168:171]
    ds_read_b64_tr_b16 v[104:105], v21 offset:27872
    v_mfma_f32_16x16x32_bf16 a[172:175], v[108:111], v[56:59], a[172:175]
    ds_read_b64_tr_b16 v[106:107], v21 offset:32480
    v_mfma_f32_16x16x32_bf16 a[176:179], v[112:115], v[44:47], a[176:179]
    v_mfma_f32_16x16x32_bf16 a[180:183], v[112:115], v[48:51], a[180:183]
    v_mfma_f32_16x16x32_bf16 a[184:187], v[112:115], v[52:55], a[184:187]
    v_mfma_f32_16x16x32_bf16 a[188:191], v[112:115], v[56:59], a[188:191]
    s_waitcnt vmcnt(21)
    s_barrier
    s_waitcnt lgkmcnt(4)
    v_mfma_f32_16x16x32_bf16 a[192:195], v[92:95], v[44:47], a[192:195]
    ds_read_b64_tr_b16 v[108:109], v21 offset:9472
    v_mfma_f32_16x16x32_bf16 a[196:199], v[92:95], v[48:51], a[196:199]
    ds_read_b64_tr_b16 v[110:111], v21 offset:14080
    v_mfma_f32_16x16x32_bf16 a[200:203], v[92:95], v[52:55], a[200:203]
    ds_read_b64_tr_b16 v[112:113], v21 offset:27904
    v_mfma_f32_16x16x32_bf16 a[204:207], v[92:95], v[56:59], a[204:207]
    ds_read_b64_tr_b16 v[114:115], v21 offset:32512
    v_mfma_f32_16x16x32_bf16 a[208:211], v[96:99], v[44:47], a[208:211]
    s_add_u32 m0, s35, 110592
    s_mov_b32 s38, 1769472
    buffer_load_dwordx4 v8, s[20:23], s38 offen lds
    v_mfma_f32_16x16x32_bf16 a[212:215], v[96:99], v[48:51], a[212:215]
    s_add_u32 m0, s35, 111616
    s_mov_b32 s38, 1769472
    buffer_load_dwordx4 v9, s[20:23], s38 offen lds
    v_mfma_f32_16x16x32_bf16 a[216:219], v[96:99], v[52:55], a[216:219]
    s_add_u32 m0, s35, 112640
    s_mov_b32 s38, 1769472
    buffer_load_dwordx4 v10, s[20:23], s38 offen lds
    v_mfma_f32_16x16x32_bf16 a[220:223], v[96:99], v[56:59], a[220:223]
    s_waitcnt lgkmcnt(4)
    v_mfma_f32_16x16x32_bf16 a[224:227], v[100:103], v[44:47], a[224:227]
    ds_read_b64_tr_b16 v[92:93], v22 offset:0
    v_mfma_f32_16x16x32_bf16 a[228:231], v[100:103], v[48:51], a[228:231]
    ds_read_b64_tr_b16 v[94:95], v22 offset:4608
    v_mfma_f32_16x16x32_bf16 a[232:235], v[100:103], v[52:55], a[232:235]
    ds_read_b64_tr_b16 v[96:97], v22 offset:18432
    v_mfma_f32_16x16x32_bf16 a[236:239], v[100:103], v[56:59], a[236:239]
    ds_read_b64_tr_b16 v[98:99], v22 offset:23040
    v_mfma_f32_16x16x32_bf16 a[240:243], v[104:107], v[44:47], a[240:243]
    s_add_u32 m0, s35, 113664
    s_mov_b32 s38, 1769472
    buffer_load_dwordx4 v11, s[20:23], s38 offen lds
    v_mfma_f32_16x16x32_bf16 a[244:247], v[104:107], v[48:51], a[244:247]
    s_add_u32 m0, s35, 114688
    s_mov_b32 s38, 1769472
    buffer_load_dwordx4 v12, s[20:23], s38 offen lds
    v_mfma_f32_16x16x32_bf16 a[248:251], v[104:107], v[52:55], a[248:251]
    s_add_u32 m0, s35, 115712
    s_mov_b32 s38, 1769472
    buffer_load_dwordx4 v13, s[20:23], s38 offen lds
    v_mfma_f32_16x16x32_bf16 a[252:255], v[104:107], v[56:59], a[252:255]
    s_waitcnt lgkmcnt(4)
    v_mfma_f32_16x16x32_bf16 v[116:119], v[108:111], v[44:47], v[116:119]
    ds_read_b64_tr_b16 v[100:101], v22 offset:32
    v_mfma_f32_16x16x32_bf16 v[120:123], v[108:111], v[48:51], v[120:123]
    ds_read_b64_tr_b16 v[102:103], v22 offset:4640
    v_mfma_f32_16x16x32_bf16 v[124:127], v[108:111], v[52:55], v[124:127]
    ds_read_b64_tr_b16 v[104:105], v22 offset:18464
    v_mfma_f32_16x16x32_bf16 v[128:131], v[108:111], v[56:59], v[128:131]
    ds_read_b64_tr_b16 v[106:107], v22 offset:23072
    v_mfma_f32_16x16x32_bf16 v[132:135], v[112:115], v[44:47], v[132:135]
    s_add_u32 m0, s35, 116736
    s_mov_b32 s38, 1769472
    buffer_load_dwordx4 v14, s[20:23], s38 offen lds
    v_mfma_f32_16x16x32_bf16 v[136:139], v[112:115], v[48:51], v[136:139]
    s_add_u32 m0, s35, 117760
    s_mov_b32 s38, 1769472
    buffer_load_dwordx4 v15, s[20:23], s38 offen lds
    v_mfma_f32_16x16x32_bf16 v[140:143], v[112:115], v[52:55], v[140:143]
    s_add_u32 m0, s35, 118784
    s_mov_b32 s38, 1769472
    buffer_load_dwordx4 v16, s[20:23], s38 offen lds
    v_mfma_f32_16x16x32_bf16 v[144:147], v[112:115], v[56:59], v[144:147]
    s_waitcnt vmcnt(26)
    s_waitcnt lgkmcnt(4)
    v_mfma_f32_16x16x32_bf16 a[0:3], v[92:95], v[60:63], a[0:3]
    ds_read_b64_tr_b16 v[108:109], v22 offset:64
    v_mfma_f32_16x16x32_bf16 a[4:7], v[92:95], v[64:67], a[4:7]
    ds_read_b64_tr_b16 v[110:111], v22 offset:4672
    v_mfma_f32_16x16x32_bf16 a[8:11], v[92:95], v[68:71], a[8:11]
    ds_read_b64_tr_b16 v[112:113], v22 offset:18496
    v_mfma_f32_16x16x32_bf16 a[12:15], v[92:95], v[72:75], a[12:15]
    ds_read_b64_tr_b16 v[114:115], v22 offset:23104
    v_mfma_f32_16x16x32_bf16 a[16:19], v[96:99], v[60:63], a[16:19]
    s_movk_i32 s93, 0
    buffer_load_dwordx4 v[168:171], v25, s[88:91], s93 offen
    v_mfma_f32_16x16x32_bf16 a[20:23], v[96:99], v[64:67], a[20:23]
    s_movk_i32 s93, 1024
    buffer_load_dwordx4 v[168:171], v25, s[88:91], s93 offen
    v_mfma_f32_16x16x32_bf16 a[24:27], v[96:99], v[68:71], a[24:27]
    s_mov_b32 s39, 5120
    buffer_load_dwordx4 v[44:47], v17, s[24:27], s39 offen
    v_mfma_f32_16x16x32_bf16 a[28:31], v[96:99], v[72:75], a[28:31]
    s_waitcnt lgkmcnt(4)
    v_mfma_f32_16x16x32_bf16 a[32:35], v[100:103], v[60:63], a[32:35]
    ds_read_b64_tr_b16 v[92:93], v22 offset:96
    v_mfma_f32_16x16x32_bf16 a[36:39], v[100:103], v[64:67], a[36:39]
    ds_read_b64_tr_b16 v[94:95], v22 offset:4704
    v_mfma_f32_16x16x32_bf16 a[40:43], v[100:103], v[68:71], a[40:43]
    ds_read_b64_tr_b16 v[96:97], v22 offset:18528
    v_mfma_f32_16x16x32_bf16 a[44:47], v[100:103], v[72:75], a[44:47]
    ds_read_b64_tr_b16 v[98:99], v22 offset:23136
    v_mfma_f32_16x16x32_bf16 a[48:51], v[104:107], v[60:63], a[48:51]
    s_mov_b32 s39, 5120
    buffer_load_dwordx4 v[48:51], v18, s[24:27], s39 offen
    v_mfma_f32_16x16x32_bf16 a[52:55], v[104:107], v[64:67], a[52:55]
    s_mov_b32 s39, 5120
    buffer_load_dwordx4 v[52:55], v19, s[24:27], s39 offen
    v_mfma_f32_16x16x32_bf16 a[56:59], v[104:107], v[68:71], a[56:59]
    s_mov_b32 s39, 5120
    buffer_load_dwordx4 v[56:59], v20, s[24:27], s39 offen
    v_mfma_f32_16x16x32_bf16 a[60:63], v[104:107], v[72:75], a[60:63]
    s_waitcnt lgkmcnt(4)
    v_mfma_f32_16x16x32_bf16 a[64:67], v[108:111], v[60:63], a[64:67]
    ds_read_b64_tr_b16 v[100:101], v22 offset:128
    v_mfma_f32_16x16x32_bf16 a[68:71], v[108:111], v[64:67], a[68:71]
    ds_read_b64_tr_b16 v[102:103], v22 offset:4736
    v_mfma_f32_16x16x32_bf16 a[72:75], v[108:111], v[68:71], a[72:75]
    ds_read_b64_tr_b16 v[104:105], v22 offset:18560
    v_mfma_f32_16x16x32_bf16 a[76:79], v[108:111], v[72:75], a[76:79]
    ds_read_b64_tr_b16 v[106:107], v22 offset:23168
    v_mfma_f32_16x16x32_bf16 a[80:83], v[112:115], v[60:63], a[80:83]
    v_mfma_f32_16x16x32_bf16 a[84:87], v[112:115], v[64:67], a[84:87]
    v_mfma_f32_16x16x32_bf16 a[88:91], v[112:115], v[68:71], a[88:91]
    v_mfma_f32_16x16x32_bf16 a[92:95], v[112:115], v[72:75], a[92:95]
    s_waitcnt lgkmcnt(4)
    v_mfma_f32_16x16x32_bf16 a[96:99], v[92:95], v[60:63], a[96:99]
    ds_read_b64_tr_b16 v[108:109], v22 offset:160
    v_mfma_f32_16x16x32_bf16 a[100:103], v[92:95], v[64:67], a[100:103]
    ds_read_b64_tr_b16 v[110:111], v22 offset:4768
    v_mfma_f32_16x16x32_bf16 a[104:107], v[92:95], v[68:71], a[104:107]
    ds_read_b64_tr_b16 v[112:113], v22 offset:18592
    v_mfma_f32_16x16x32_bf16 a[108:111], v[92:95], v[72:75], a[108:111]
    ds_read_b64_tr_b16 v[114:115], v22 offset:23200
    v_mfma_f32_16x16x32_bf16 a[112:115], v[96:99], v[60:63], a[112:115]
    v_mfma_f32_16x16x32_bf16 a[116:119], v[96:99], v[64:67], a[116:119]
    v_mfma_f32_16x16x32_bf16 a[120:123], v[96:99], v[68:71], a[120:123]
    v_mfma_f32_16x16x32_bf16 a[124:127], v[96:99], v[72:75], a[124:127]
    s_waitcnt lgkmcnt(4)
    v_mfma_f32_16x16x32_bf16 a[128:131], v[100:103], v[60:63], a[128:131]
    ds_read_b64_tr_b16 v[92:93], v22 offset:192
    v_mfma_f32_16x16x32_bf16 a[132:135], v[100:103], v[64:67], a[132:135]
    ds_read_b64_tr_b16 v[94:95], v22 offset:4800
    v_mfma_f32_16x16x32_bf16 a[136:139], v[100:103], v[68:71], a[136:139]
    ds_read_b64_tr_b16 v[96:97], v22 offset:18624
    v_mfma_f32_16x16x32_bf16 a[140:143], v[100:103], v[72:75], a[140:143]
    ds_read_b64_tr_b16 v[98:99], v22 offset:23232
    v_mfma_f32_16x16x32_bf16 a[144:147], v[104:107], v[60:63], a[144:147]
    v_mfma_f32_16x16x32_bf16 a[148:151], v[104:107], v[64:67], a[148:151]
    v_mfma_f32_16x16x32_bf16 a[152:155], v[104:107], v[68:71], a[152:155]
    v_mfma_f32_16x16x32_bf16 a[156:159], v[104:107], v[72:75], a[156:159]
    s_waitcnt lgkmcnt(4)
    v_mfma_f32_16x16x32_bf16 a[160:163], v[108:111], v[60:63], a[160:163]
    ds_read_b64_tr_b16 v[100:101], v22 offset:224
    v_mfma_f32_16x16x32_bf16 a[164:167], v[108:111], v[64:67], a[164:167]
    ds_read_b64_tr_b16 v[102:103], v22 offset:4832
    v_mfma_f32_16x16x32_bf16 a[168:171], v[108:111], v[68:71], a[168:171]
    ds_read_b64_tr_b16 v[104:105], v22 offset:18656
    v_mfma_f32_16x16x32_bf16 a[172:175], v[108:111], v[72:75], a[172:175]
    ds_read_b64_tr_b16 v[106:107], v22 offset:23264
    v_mfma_f32_16x16x32_bf16 a[176:179], v[112:115], v[60:63], a[176:179]
    v_mfma_f32_16x16x32_bf16 a[180:183], v[112:115], v[64:67], a[180:183]
    v_mfma_f32_16x16x32_bf16 a[184:187], v[112:115], v[68:71], a[184:187]
    v_mfma_f32_16x16x32_bf16 a[188:191], v[112:115], v[72:75], a[188:191]
    s_waitcnt lgkmcnt(4)
    v_mfma_f32_16x16x32_bf16 a[192:195], v[92:95], v[60:63], a[192:195]
    ds_read_b64_tr_b16 v[108:109], v22 offset:256
    v_mfma_f32_16x16x32_bf16 a[196:199], v[92:95], v[64:67], a[196:199]
    ds_read_b64_tr_b16 v[110:111], v22 offset:4864
    v_mfma_f32_16x16x32_bf16 a[200:203], v[92:95], v[68:71], a[200:203]
    ds_read_b64_tr_b16 v[112:113], v22 offset:18688
    v_mfma_f32_16x16x32_bf16 a[204:207], v[92:95], v[72:75], a[204:207]
    ds_read_b64_tr_b16 v[114:115], v22 offset:23296
    v_mfma_f32_16x16x32_bf16 a[208:211], v[96:99], v[60:63], a[208:211]
    v_mfma_f32_16x16x32_bf16 a[212:215], v[96:99], v[64:67], a[212:215]
    v_mfma_f32_16x16x32_bf16 a[216:219], v[96:99], v[68:71], a[216:219]
    v_mfma_f32_16x16x32_bf16 a[220:223], v[96:99], v[72:75], a[220:223]
    s_waitcnt lgkmcnt(4)
    v_mfma_f32_16x16x32_bf16 a[224:227], v[100:103], v[60:63], a[224:227]
    ds_read_b64_tr_b16 v[92:93], v22 offset:9216
    v_mfma_f32_16x16x32_bf16 a[228:231], v[100:103], v[64:67], a[228:231]
    ds_read_b64_tr_b16 v[94:95], v22 offset:13824
    v_mfma_f32_16x16x32_bf16 a[232:235], v[100:103], v[68:71], a[232:235]
    ds_read_b64_tr_b16 v[96:97], v22 offset:27648
    v_mfma_f32_16x16x32_bf16 a[236:239], v[100:103], v[72:75], a[236:239]
    ds_read_b64_tr_b16 v[98:99], v22 offset:32256
    v_mfma_f32_16x16x32_bf16 a[240:243], v[104:107], v[60:63], a[240:243]
    v_mfma_f32_16x16x32_bf16 a[244:247], v[104:107], v[64:67], a[244:247]
    v_mfma_f32_16x16x32_bf16 a[248:251], v[104:107], v[68:71], a[248:251]
    v_mfma_f32_16x16x32_bf16 a[252:255], v[104:107], v[72:75], a[252:255]
    s_waitcnt lgkmcnt(4)
    v_mfma_f32_16x16x32_bf16 v[116:119], v[108:111], v[60:63], v[116:119]
    ds_read_b64_tr_b16 v[100:101], v22 offset:9248
    v_mfma_f32_16x16x32_bf16 v[120:123], v[108:111], v[64:67], v[120:123]
    ds_read_b64_tr_b16 v[102:103], v22 offset:13856
    v_mfma_f32_16x16x32_bf16 v[124:127], v[108:111], v[68:71], v[124:127]
    ds_read_b64_tr_b16 v[104:105], v22 offset:27680
    v_mfma_f32_16x16x32_bf16 v[128:131], v[108:111], v[72:75], v[128:131]
    ds_read_b64_tr_b16 v[106:107], v22 offset:32288
    v_mfma_f32_16x16x32_bf16 v[132:135], v[112:115], v[60:63], v[132:135]
    v_mfma_f32_16x16x32_bf16 v[136:139], v[112:115], v[64:67], v[136:139]
    v_mfma_f32_16x16x32_bf16 v[140:143], v[112:115], v[68:71], v[140:143]
    v_mfma_f32_16x16x32_bf16 v[144:147], v[112:115], v[72:75], v[144:147]
    s_waitcnt vmcnt(19)
    s_waitcnt lgkmcnt(4)
    v_mfma_f32_16x16x32_bf16 a[0:3], v[92:95], v[76:79], a[0:3]
    ds_read_b64_tr_b16 v[108:109], v22 offset:9280
    v_mfma_f32_16x16x32_bf16 a[4:7], v[92:95], v[80:83], a[4:7]
    ds_read_b64_tr_b16 v[110:111], v22 offset:13888
    v_mfma_f32_16x16x32_bf16 a[8:11], v[92:95], v[84:87], a[8:11]
    ds_read_b64_tr_b16 v[112:113], v22 offset:27712
    v_mfma_f32_16x16x32_bf16 a[12:15], v[92:95], v[88:91], a[12:15]
    ds_read_b64_tr_b16 v[114:115], v22 offset:32320
    v_mfma_f32_16x16x32_bf16 a[16:19], v[96:99], v[76:79], a[16:19]
    s_mov_b32 s39, 6144
    buffer_load_dwordx4 v[60:63], v17, s[24:27], s39 offen
    v_mfma_f32_16x16x32_bf16 a[20:23], v[96:99], v[80:83], a[20:23]
    s_mov_b32 s39, 6144
    buffer_load_dwordx4 v[64:67], v18, s[24:27], s39 offen
    v_mfma_f32_16x16x32_bf16 a[24:27], v[96:99], v[84:87], a[24:27]
    s_mov_b32 s39, 6144
    buffer_load_dwordx4 v[68:71], v19, s[24:27], s39 offen
    v_mfma_f32_16x16x32_bf16 a[28:31], v[96:99], v[88:91], a[28:31]
    s_waitcnt lgkmcnt(4)
    v_mfma_f32_16x16x32_bf16 a[32:35], v[100:103], v[76:79], a[32:35]
    ds_read_b64_tr_b16 v[92:93], v22 offset:9312
    v_mfma_f32_16x16x32_bf16 a[36:39], v[100:103], v[80:83], a[36:39]
    ds_read_b64_tr_b16 v[94:95], v22 offset:13920
    v_mfma_f32_16x16x32_bf16 a[40:43], v[100:103], v[84:87], a[40:43]
    ds_read_b64_tr_b16 v[96:97], v22 offset:27744
    v_mfma_f32_16x16x32_bf16 a[44:47], v[100:103], v[88:91], a[44:47]
    ds_read_b64_tr_b16 v[98:99], v22 offset:32352
    v_mfma_f32_16x16x32_bf16 a[48:51], v[104:107], v[76:79], a[48:51]
    s_mov_b32 s39, 6144
    buffer_load_dwordx4 v[72:75], v20, s[24:27], s39 offen
    v_mfma_f32_16x16x32_bf16 a[52:55], v[104:107], v[80:83], a[52:55]
    v_mfma_f32_16x16x32_bf16 a[56:59], v[104:107], v[84:87], a[56:59]
    v_mfma_f32_16x16x32_bf16 a[60:63], v[104:107], v[88:91], a[60:63]
    s_waitcnt lgkmcnt(4)
    v_mfma_f32_16x16x32_bf16 a[64:67], v[108:111], v[76:79], a[64:67]
    ds_read_b64_tr_b16 v[100:101], v22 offset:9344
    v_mfma_f32_16x16x32_bf16 a[68:71], v[108:111], v[80:83], a[68:71]
    ds_read_b64_tr_b16 v[102:103], v22 offset:13952
    v_mfma_f32_16x16x32_bf16 a[72:75], v[108:111], v[84:87], a[72:75]
    ds_read_b64_tr_b16 v[104:105], v22 offset:27776
    v_mfma_f32_16x16x32_bf16 a[76:79], v[108:111], v[88:91], a[76:79]
    ds_read_b64_tr_b16 v[106:107], v22 offset:32384
    v_mfma_f32_16x16x32_bf16 a[80:83], v[112:115], v[76:79], a[80:83]
    v_mfma_f32_16x16x32_bf16 a[84:87], v[112:115], v[80:83], a[84:87]
    v_mfma_f32_16x16x32_bf16 a[88:91], v[112:115], v[84:87], a[88:91]
    v_mfma_f32_16x16x32_bf16 a[92:95], v[112:115], v[88:91], a[92:95]
    s_waitcnt lgkmcnt(4)
    v_mfma_f32_16x16x32_bf16 a[96:99], v[92:95], v[76:79], a[96:99]
    ds_read_b64_tr_b16 v[108:109], v22 offset:9376
    v_mfma_f32_16x16x32_bf16 a[100:103], v[92:95], v[80:83], a[100:103]
    ds_read_b64_tr_b16 v[110:111], v22 offset:13984
    v_mfma_f32_16x16x32_bf16 a[104:107], v[92:95], v[84:87], a[104:107]
    ds_read_b64_tr_b16 v[112:113], v22 offset:27808
    v_mfma_f32_16x16x32_bf16 a[108:111], v[92:95], v[88:91], a[108:111]
    ds_read_b64_tr_b16 v[114:115], v22 offset:32416
    v_mfma_f32_16x16x32_bf16 a[112:115], v[96:99], v[76:79], a[112:115]
    v_mfma_f32_16x16x32_bf16 a[116:119], v[96:99], v[80:83], a[116:119]
    v_mfma_f32_16x16x32_bf16 a[120:123], v[96:99], v[84:87], a[120:123]
    v_mfma_f32_16x16x32_bf16 a[124:127], v[96:99], v[88:91], a[124:127]
    s_waitcnt lgkmcnt(4)
    v_mfma_f32_16x16x32_bf16 a[128:131], v[100:103], v[76:79], a[128:131]
    ds_read_b64_tr_b16 v[92:93], v22 offset:9408
    v_mfma_f32_16x16x32_bf16 a[132:135], v[100:103], v[80:83], a[132:135]
    ds_read_b64_tr_b16 v[94:95], v22 offset:14016
    v_mfma_f32_16x16x32_bf16 a[136:139], v[100:103], v[84:87], a[136:139]
    ds_read_b64_tr_b16 v[96:97], v22 offset:27840
    v_mfma_f32_16x16x32_bf16 a[140:143], v[100:103], v[88:91], a[140:143]
    ds_read_b64_tr_b16 v[98:99], v22 offset:32448
    v_mfma_f32_16x16x32_bf16 a[144:147], v[104:107], v[76:79], a[144:147]
    v_mfma_f32_16x16x32_bf16 a[148:151], v[104:107], v[80:83], a[148:151]
    v_mfma_f32_16x16x32_bf16 a[152:155], v[104:107], v[84:87], a[152:155]
    v_mfma_f32_16x16x32_bf16 a[156:159], v[104:107], v[88:91], a[156:159]
    s_waitcnt lgkmcnt(4)
    v_mfma_f32_16x16x32_bf16 a[160:163], v[108:111], v[76:79], a[160:163]
    ds_read_b64_tr_b16 v[100:101], v22 offset:9440
    v_mfma_f32_16x16x32_bf16 a[164:167], v[108:111], v[80:83], a[164:167]
    ds_read_b64_tr_b16 v[102:103], v22 offset:14048
    v_mfma_f32_16x16x32_bf16 a[168:171], v[108:111], v[84:87], a[168:171]
    ds_read_b64_tr_b16 v[104:105], v22 offset:27872
    v_mfma_f32_16x16x32_bf16 a[172:175], v[108:111], v[88:91], a[172:175]
    ds_read_b64_tr_b16 v[106:107], v22 offset:32480
    v_mfma_f32_16x16x32_bf16 a[176:179], v[112:115], v[76:79], a[176:179]
    v_mfma_f32_16x16x32_bf16 a[180:183], v[112:115], v[80:83], a[180:183]
    v_mfma_f32_16x16x32_bf16 a[184:187], v[112:115], v[84:87], a[184:187]
    v_mfma_f32_16x16x32_bf16 a[188:191], v[112:115], v[88:91], a[188:191]
    s_barrier
    s_waitcnt lgkmcnt(4)
    v_mfma_f32_16x16x32_bf16 a[192:195], v[92:95], v[76:79], a[192:195]
    ds_read_b64_tr_b16 v[108:109], v22 offset:9472
    v_mfma_f32_16x16x32_bf16 a[196:199], v[92:95], v[80:83], a[196:199]
    ds_read_b64_tr_b16 v[110:111], v22 offset:14080
    v_mfma_f32_16x16x32_bf16 a[200:203], v[92:95], v[84:87], a[200:203]
    ds_read_b64_tr_b16 v[112:113], v22 offset:27904
    v_mfma_f32_16x16x32_bf16 a[204:207], v[92:95], v[88:91], a[204:207]
    ds_read_b64_tr_b16 v[114:115], v22 offset:32512
    v_mfma_f32_16x16x32_bf16 a[208:211], v[96:99], v[76:79], a[208:211]
    s_add_u32 m0, s35, 0
    s_mov_b32 s38, 2359296
    buffer_load_dwordx4 v8, s[20:23], s38 offen lds
    v_mfma_f32_16x16x32_bf16 a[212:215], v[96:99], v[80:83], a[212:215]
    s_add_u32 m0, s35, 1024
    s_mov_b32 s38, 2359296
    buffer_load_dwordx4 v9, s[20:23], s38 offen lds
    v_mfma_f32_16x16x32_bf16 a[216:219], v[96:99], v[84:87], a[216:219]
    s_add_u32 m0, s35, 2048
    s_mov_b32 s38, 2359296
    buffer_load_dwordx4 v10, s[20:23], s38 offen lds
    v_mfma_f32_16x16x32_bf16 a[220:223], v[96:99], v[88:91], a[220:223]
    s_waitcnt lgkmcnt(4)
    v_mfma_f32_16x16x32_bf16 a[224:227], v[100:103], v[76:79], a[224:227]
    ds_read_b64_tr_b16 v[92:93], v23 offset:0
    v_mfma_f32_16x16x32_bf16 a[228:231], v[100:103], v[80:83], a[228:231]
    ds_read_b64_tr_b16 v[94:95], v23 offset:4608
    v_mfma_f32_16x16x32_bf16 a[232:235], v[100:103], v[84:87], a[232:235]
    ds_read_b64_tr_b16 v[96:97], v23 offset:18432
    v_mfma_f32_16x16x32_bf16 a[236:239], v[100:103], v[88:91], a[236:239]
    ds_read_b64_tr_b16 v[98:99], v23 offset:23040
    v_mfma_f32_16x16x32_bf16 a[240:243], v[104:107], v[76:79], a[240:243]
    s_add_u32 m0, s35, 3072
    s_mov_b32 s38, 2359296
    buffer_load_dwordx4 v11, s[20:23], s38 offen lds
    v_mfma_f32_16x16x32_bf16 a[244:247], v[104:107], v[80:83], a[244:247]
    s_add_u32 m0, s35, 4096
    s_mov_b32 s38, 2359296
    buffer_load_dwordx4 v12, s[20:23], s38 offen lds
    v_mfma_f32_16x16x32_bf16 a[248:251], v[104:107], v[84:87], a[248:251]
    s_add_u32 m0, s35, 5120
    s_mov_b32 s38, 2359296
    buffer_load_dwordx4 v13, s[20:23], s38 offen lds
    v_mfma_f32_16x16x32_bf16 a[252:255], v[104:107], v[88:91], a[252:255]
    s_waitcnt lgkmcnt(4)
    v_mfma_f32_16x16x32_bf16 v[116:119], v[108:111], v[76:79], v[116:119]
    ds_read_b64_tr_b16 v[100:101], v23 offset:32
    v_mfma_f32_16x16x32_bf16 v[120:123], v[108:111], v[80:83], v[120:123]
    ds_read_b64_tr_b16 v[102:103], v23 offset:4640
    v_mfma_f32_16x16x32_bf16 v[124:127], v[108:111], v[84:87], v[124:127]
    ds_read_b64_tr_b16 v[104:105], v23 offset:18464
    v_mfma_f32_16x16x32_bf16 v[128:131], v[108:111], v[88:91], v[128:131]
    ds_read_b64_tr_b16 v[106:107], v23 offset:23072
    v_mfma_f32_16x16x32_bf16 v[132:135], v[112:115], v[76:79], v[132:135]
    s_add_u32 m0, s35, 6144
    s_mov_b32 s38, 2359296
    buffer_load_dwordx4 v14, s[20:23], s38 offen lds
    v_mfma_f32_16x16x32_bf16 v[136:139], v[112:115], v[80:83], v[136:139]
    s_add_u32 m0, s35, 7168
    s_mov_b32 s38, 2359296
    buffer_load_dwordx4 v15, s[20:23], s38 offen lds
    v_mfma_f32_16x16x32_bf16 v[140:143], v[112:115], v[84:87], v[140:143]
    s_add_u32 m0, s35, 8192
    s_mov_b32 s38, 2359296
    buffer_load_dwordx4 v16, s[20:23], s38 offen lds
    v_mfma_f32_16x16x32_bf16 v[144:147], v[112:115], v[88:91], v[144:147]
    s_waitcnt vmcnt(28)
    s_waitcnt lgkmcnt(4)
    v_mfma_f32_16x16x32_bf16 a[0:3], v[92:95], v[28:31], a[0:3]
    ds_read_b64_tr_b16 v[108:109], v23 offset:64
    v_mfma_f32_16x16x32_bf16 a[4:7], v[92:95], v[32:35], a[4:7]
    ds_read_b64_tr_b16 v[110:111], v23 offset:4672
    v_mfma_f32_16x16x32_bf16 a[8:11], v[92:95], v[36:39], a[8:11]
    ds_read_b64_tr_b16 v[112:113], v23 offset:18496
    v_mfma_f32_16x16x32_bf16 a[12:15], v[92:95], v[40:43], a[12:15]
    ds_read_b64_tr_b16 v[114:115], v23 offset:23104
    v_mfma_f32_16x16x32_bf16 a[16:19], v[96:99], v[28:31], a[16:19]
    s_movk_i32 s93, 2048
    buffer_load_dwordx4 v[168:171], v25, s[88:91], s93 offen
    v_mfma_f32_16x16x32_bf16 a[20:23], v[96:99], v[32:35], a[20:23]
    s_movk_i32 s93, 3072
    buffer_load_dwordx4 v[168:171], v25, s[88:91], s93 offen
    v_mfma_f32_16x16x32_bf16 a[24:27], v[96:99], v[36:39], a[24:27]
    s_mov_b32 s39, 7168
    buffer_load_dwordx4 v[76:79], v17, s[24:27], s39 offen
    v_mfma_f32_16x16x32_bf16 a[28:31], v[96:99], v[40:43], a[28:31]
    s_waitcnt lgkmcnt(4)
    v_mfma_f32_16x16x32_bf16 a[32:35], v[100:103], v[28:31], a[32:35]
    ds_read_b64_tr_b16 v[92:93], v23 offset:96
    v_mfma_f32_16x16x32_bf16 a[36:39], v[100:103], v[32:35], a[36:39]
    ds_read_b64_tr_b16 v[94:95], v23 offset:4704
    v_mfma_f32_16x16x32_bf16 a[40:43], v[100:103], v[36:39], a[40:43]
    ds_read_b64_tr_b16 v[96:97], v23 offset:18528
    v_mfma_f32_16x16x32_bf16 a[44:47], v[100:103], v[40:43], a[44:47]
    ds_read_b64_tr_b16 v[98:99], v23 offset:23136
    v_mfma_f32_16x16x32_bf16 a[48:51], v[104:107], v[28:31], a[48:51]
    s_mov_b32 s39, 7168
    buffer_load_dwordx4 v[80:83], v18, s[24:27], s39 offen
    v_mfma_f32_16x16x32_bf16 a[52:55], v[104:107], v[32:35], a[52:55]
    s_mov_b32 s39, 7168
    buffer_load_dwordx4 v[84:87], v19, s[24:27], s39 offen
    v_mfma_f32_16x16x32_bf16 a[56:59], v[104:107], v[36:39], a[56:59]
    s_mov_b32 s39, 7168
    buffer_load_dwordx4 v[88:91], v20, s[24:27], s39 offen
    v_mfma_f32_16x16x32_bf16 a[60:63], v[104:107], v[40:43], a[60:63]
    s_waitcnt lgkmcnt(4)
    v_mfma_f32_16x16x32_bf16 a[64:67], v[108:111], v[28:31], a[64:67]
    ds_read_b64_tr_b16 v[100:101], v23 offset:128
    v_mfma_f32_16x16x32_bf16 a[68:71], v[108:111], v[32:35], a[68:71]
    ds_read_b64_tr_b16 v[102:103], v23 offset:4736
    v_mfma_f32_16x16x32_bf16 a[72:75], v[108:111], v[36:39], a[72:75]
    ds_read_b64_tr_b16 v[104:105], v23 offset:18560
    v_mfma_f32_16x16x32_bf16 a[76:79], v[108:111], v[40:43], a[76:79]
    ds_read_b64_tr_b16 v[106:107], v23 offset:23168
    v_mfma_f32_16x16x32_bf16 a[80:83], v[112:115], v[28:31], a[80:83]
    v_mfma_f32_16x16x32_bf16 a[84:87], v[112:115], v[32:35], a[84:87]
    v_mfma_f32_16x16x32_bf16 a[88:91], v[112:115], v[36:39], a[88:91]
    v_mfma_f32_16x16x32_bf16 a[92:95], v[112:115], v[40:43], a[92:95]
    s_waitcnt lgkmcnt(4)
    v_mfma_f32_16x16x32_bf16 a[96:99], v[92:95], v[28:31], a[96:99]
    ds_read_b64_tr_b16 v[108:109], v23 offset:160
    v_mfma_f32_16x16x32_bf16 a[100:103], v[92:95], v[32:35], a[100:103]
    ds_read_b64_tr_b16 v[110:111], v23 offset:4768
    v_mfma_f32_16x16x32_bf16 a[104:107], v[92:95], v[36:39], a[104:107]
    ds_read_b64_tr_b16 v[112:113], v23 offset:18592
    v_mfma_f32_16x16x32_bf16 a[108:111], v[92:95], v[40:43], a[108:111]
    ds_read_b64_tr_b16 v[114:115], v23 offset:23200
    v_mfma_f32_16x16x32_bf16 a[112:115], v[96:99], v[28:31], a[112:115]
    v_mfma_f32_16x16x32_bf16 a[116:119], v[96:99], v[32:35], a[116:119]
    v_mfma_f32_16x16x32_bf16 a[120:123], v[96:99], v[36:39], a[120:123]
    v_mfma_f32_16x16x32_bf16 a[124:127], v[96:99], v[40:43], a[124:127]
    s_waitcnt lgkmcnt(4)
    v_mfma_f32_16x16x32_bf16 a[128:131], v[100:103], v[28:31], a[128:131]
    ds_read_b64_tr_b16 v[92:93], v23 offset:192
    v_mfma_f32_16x16x32_bf16 a[132:135], v[100:103], v[32:35], a[132:135]
    ds_read_b64_tr_b16 v[94:95], v23 offset:4800
    v_mfma_f32_16x16x32_bf16 a[136:139], v[100:103], v[36:39], a[136:139]
    ds_read_b64_tr_b16 v[96:97], v23 offset:18624
    v_mfma_f32_16x16x32_bf16 a[140:143], v[100:103], v[40:43], a[140:143]
    ds_read_b64_tr_b16 v[98:99], v23 offset:23232
    v_mfma_f32_16x16x32_bf16 a[144:147], v[104:107], v[28:31], a[144:147]
    v_mfma_f32_16x16x32_bf16 a[148:151], v[104:107], v[32:35], a[148:151]
    v_mfma_f32_16x16x32_bf16 a[152:155], v[104:107], v[36:39], a[152:155]
    v_mfma_f32_16x16x32_bf16 a[156:159], v[104:107], v[40:43], a[156:159]
    s_waitcnt lgkmcnt(4)
    v_mfma_f32_16x16x32_bf16 a[160:163], v[108:111], v[28:31], a[160:163]
    ds_read_b64_tr_b16 v[100:101], v23 offset:224
    v_mfma_f32_16x16x32_bf16 a[164:167], v[108:111], v[32:35], a[164:167]
    ds_read_b64_tr_b16 v[102:103], v23 offset:4832
    v_mfma_f32_16x16x32_bf16 a[168:171], v[108:111], v[36:39], a[168:171]
    ds_read_b64_tr_b16 v[104:105], v23 offset:18656
    v_mfma_f32_16x16x32_bf16 a[172:175], v[108:111], v[40:43], a[172:175]
    ds_read_b64_tr_b16 v[106:107], v23 offset:23264
    v_mfma_f32_16x16x32_bf16 a[176:179], v[112:115], v[28:31], a[176:179]
    v_mfma_f32_16x16x32_bf16 a[180:183], v[112:115], v[32:35], a[180:183]
    v_mfma_f32_16x16x32_bf16 a[184:187], v[112:115], v[36:39], a[184:187]
    v_mfma_f32_16x16x32_bf16 a[188:191], v[112:115], v[40:43], a[188:191]
    s_waitcnt lgkmcnt(4)
    v_mfma_f32_16x16x32_bf16 a[192:195], v[92:95], v[28:31], a[192:195]
    ds_read_b64_tr_b16 v[108:109], v23 offset:256
    v_mfma_f32_16x16x32_bf16 a[196:199], v[92:95], v[32:35], a[196:199]
    ds_read_b64_tr_b16 v[110:111], v23 offset:4864
    v_mfma_f32_16x16x32_bf16 a[200:203], v[92:95], v[36:39], a[200:203]
    ds_read_b64_tr_b16 v[112:113], v23 offset:18688
    v_mfma_f32_16x16x32_bf16 a[204:207], v[92:95], v[40:43], a[204:207]
    ds_read_b64_tr_b16 v[114:115], v23 offset:23296
    v_mfma_f32_16x16x32_bf16 a[208:211], v[96:99], v[28:31], a[208:211]
    v_mfma_f32_16x16x32_bf16 a[212:215], v[96:99], v[32:35], a[212:215]
    v_mfma_f32_16x16x32_bf16 a[216:219], v[96:99], v[36:39], a[216:219]
    v_mfma_f32_16x16x32_bf16 a[220:223], v[96:99], v[40:43], a[220:223]
    s_waitcnt lgkmcnt(4)
    v_mfma_f32_16x16x32_bf16 a[224:227], v[100:103], v[28:31], a[224:227]
    ds_read_b64_tr_b16 v[92:93], v23 offset:9216
    v_mfma_f32_16x16x32_bf16 a[228:231], v[100:103], v[32:35], a[228:231]
    ds_read_b64_tr_b16 v[94:95], v23 offset:13824
    v_mfma_f32_16x16x32_bf16 a[232:235], v[100:103], v[36:39], a[232:235]
    ds_read_b64_tr_b16 v[96:97], v23 offset:27648
    v_mfma_f32_16x16x32_bf16 a[236:239], v[100:103], v[40:43], a[236:239]
    ds_read_b64_tr_b16 v[98:99], v23 offset:32256
    v_mfma_f32_16x16x32_bf16 a[240:243], v[104:107], v[28:31], a[240:243]
    v_mfma_f32_16x16x32_bf16 a[244:247], v[104:107], v[32:35], a[244:247]
    v_mfma_f32_16x16x32_bf16 a[248:251], v[104:107], v[36:39], a[248:251]
    v_mfma_f32_16x16x32_bf16 a[252:255], v[104:107], v[40:43], a[252:255]
    s_waitcnt lgkmcnt(4)
    v_mfma_f32_16x16x32_bf16 v[116:119], v[108:111], v[28:31], v[116:119]
    ds_read_b64_tr_b16 v[100:101], v23 offset:9248
    v_mfma_f32_16x16x32_bf16 v[120:123], v[108:111], v[32:35], v[120:123]
    ds_read_b64_tr_b16 v[102:103], v23 offset:13856
    v_mfma_f32_16x16x32_bf16 v[124:127], v[108:111], v[36:39], v[124:127]
    ds_read_b64_tr_b16 v[104:105], v23 offset:27680
    v_mfma_f32_16x16x32_bf16 v[128:131], v[108:111], v[40:43], v[128:131]
    ds_read_b64_tr_b16 v[106:107], v23 offset:32288
    v_mfma_f32_16x16x32_bf16 v[132:135], v[112:115], v[28:31], v[132:135]
    v_mfma_f32_16x16x32_bf16 v[136:139], v[112:115], v[32:35], v[136:139]
    v_mfma_f32_16x16x32_bf16 v[140:143], v[112:115], v[36:39], v[140:143]
    v_mfma_f32_16x16x32_bf16 v[144:147], v[112:115], v[40:43], v[144:147]
    s_waitcnt vmcnt(19)
    s_waitcnt lgkmcnt(4)
    v_mfma_f32_16x16x32_bf16 a[0:3], v[92:95], v[44:47], a[0:3]
    ds_read_b64_tr_b16 v[108:109], v23 offset:9280
    v_mfma_f32_16x16x32_bf16 a[4:7], v[92:95], v[48:51], a[4:7]
    ds_read_b64_tr_b16 v[110:111], v23 offset:13888
    v_mfma_f32_16x16x32_bf16 a[8:11], v[92:95], v[52:55], a[8:11]
    ds_read_b64_tr_b16 v[112:113], v23 offset:27712
    v_mfma_f32_16x16x32_bf16 a[12:15], v[92:95], v[56:59], a[12:15]
    ds_read_b64_tr_b16 v[114:115], v23 offset:32320
    v_mfma_f32_16x16x32_bf16 a[16:19], v[96:99], v[44:47], a[16:19]
    s_mov_b32 s39, 8192
    buffer_load_dwordx4 v[28:31], v17, s[24:27], s39 offen
    v_mfma_f32_16x16x32_bf16 a[20:23], v[96:99], v[48:51], a[20:23]
    s_mov_b32 s39, 8192
    buffer_load_dwordx4 v[32:35], v18, s[24:27], s39 offen
    v_mfma_f32_16x16x32_bf16 a[24:27], v[96:99], v[52:55], a[24:27]
    s_mov_b32 s39, 8192
    buffer_load_dwordx4 v[36:39], v19, s[24:27], s39 offen
    v_mfma_f32_16x16x32_bf16 a[28:31], v[96:99], v[56:59], a[28:31]
    s_waitcnt lgkmcnt(4)
    v_mfma_f32_16x16x32_bf16 a[32:35], v[100:103], v[44:47], a[32:35]
    ds_read_b64_tr_b16 v[92:93], v23 offset:9312
    v_mfma_f32_16x16x32_bf16 a[36:39], v[100:103], v[48:51], a[36:39]
    ds_read_b64_tr_b16 v[94:95], v23 offset:13920
    v_mfma_f32_16x16x32_bf16 a[40:43], v[100:103], v[52:55], a[40:43]
    ds_read_b64_tr_b16 v[96:97], v23 offset:27744
    v_mfma_f32_16x16x32_bf16 a[44:47], v[100:103], v[56:59], a[44:47]
    ds_read_b64_tr_b16 v[98:99], v23 offset:32352
    v_mfma_f32_16x16x32_bf16 a[48:51], v[104:107], v[44:47], a[48:51]
    s_mov_b32 s39, 8192
    buffer_load_dwordx4 v[40:43], v20, s[24:27], s39 offen
    v_mfma_f32_16x16x32_bf16 a[52:55], v[104:107], v[48:51], a[52:55]
    v_mfma_f32_16x16x32_bf16 a[56:59], v[104:107], v[52:55], a[56:59]
    v_mfma_f32_16x16x32_bf16 a[60:63], v[104:107], v[56:59], a[60:63]
    s_waitcnt lgkmcnt(4)
    v_mfma_f32_16x16x32_bf16 a[64:67], v[108:111], v[44:47], a[64:67]
    ds_read_b64_tr_b16 v[100:101], v23 offset:9344
    v_mfma_f32_16x16x32_bf16 a[68:71], v[108:111], v[48:51], a[68:71]
    ds_read_b64_tr_b16 v[102:103], v23 offset:13952
    v_mfma_f32_16x16x32_bf16 a[72:75], v[108:111], v[52:55], a[72:75]
    ds_read_b64_tr_b16 v[104:105], v23 offset:27776
    v_mfma_f32_16x16x32_bf16 a[76:79], v[108:111], v[56:59], a[76:79]
    ds_read_b64_tr_b16 v[106:107], v23 offset:32384
    v_mfma_f32_16x16x32_bf16 a[80:83], v[112:115], v[44:47], a[80:83]
    v_mfma_f32_16x16x32_bf16 a[84:87], v[112:115], v[48:51], a[84:87]
    v_mfma_f32_16x16x32_bf16 a[88:91], v[112:115], v[52:55], a[88:91]
    v_mfma_f32_16x16x32_bf16 a[92:95], v[112:115], v[56:59], a[92:95]
    s_waitcnt lgkmcnt(4)
    v_mfma_f32_16x16x32_bf16 a[96:99], v[92:95], v[44:47], a[96:99]
    ds_read_b64_tr_b16 v[108:109], v23 offset:9376
    v_mfma_f32_16x16x32_bf16 a[100:103], v[92:95], v[48:51], a[100:103]
    ds_read_b64_tr_b16 v[110:111], v23 offset:13984
    v_mfma_f32_16x16x32_bf16 a[104:107], v[92:95], v[52:55], a[104:107]
    ds_read_b64_tr_b16 v[112:113], v23 offset:27808
    v_mfma_f32_16x16x32_bf16 a[108:111], v[92:95], v[56:59], a[108:111]
    ds_read_b64_tr_b16 v[114:115], v23 offset:32416
    v_mfma_f32_16x16x32_bf16 a[112:115], v[96:99], v[44:47], a[112:115]
    v_mfma_f32_16x16x32_bf16 a[116:119], v[96:99], v[48:51], a[116:119]
    v_mfma_f32_16x16x32_bf16 a[120:123], v[96:99], v[52:55], a[120:123]
    v_mfma_f32_16x16x32_bf16 a[124:127], v[96:99], v[56:59], a[124:127]
    s_waitcnt lgkmcnt(4)
    v_mfma_f32_16x16x32_bf16 a[128:131], v[100:103], v[44:47], a[128:131]
    ds_read_b64_tr_b16 v[92:93], v23 offset:9408
    v_mfma_f32_16x16x32_bf16 a[132:135], v[100:103], v[48:51], a[132:135]
    ds_read_b64_tr_b16 v[94:95], v23 offset:14016
    v_mfma_f32_16x16x32_bf16 a[136:139], v[100:103], v[52:55], a[136:139]
    ds_read_b64_tr_b16 v[96:97], v23 offset:27840
    v_mfma_f32_16x16x32_bf16 a[140:143], v[100:103], v[56:59], a[140:143]
    ds_read_b64_tr_b16 v[98:99], v23 offset:32448
    v_mfma_f32_16x16x32_bf16 a[144:147], v[104:107], v[44:47], a[144:147]
    v_mfma_f32_16x16x32_bf16 a[148:151], v[104:107], v[48:51], a[148:151]
    v_mfma_f32_16x16x32_bf16 a[152:155], v[104:107], v[52:55], a[152:155]
    v_mfma_f32_16x16x32_bf16 a[156:159], v[104:107], v[56:59], a[156:159]
    s_waitcnt lgkmcnt(4)
    v_mfma_f32_16x16x32_bf16 a[160:163], v[108:111], v[44:47], a[160:163]
    ds_read_b64_tr_b16 v[100:101], v23 offset:9440
    v_mfma_f32_16x16x32_bf16 a[164:167], v[108:111], v[48:51], a[164:167]
    ds_read_b64_tr_b16 v[102:103], v23 offset:14048
    v_mfma_f32_16x16x32_bf16 a[168:171], v[108:111], v[52:55], a[168:171]
    ds_read_b64_tr_b16 v[104:105], v23 offset:27872
    v_mfma_f32_16x16x32_bf16 a[172:175], v[108:111], v[56:59], a[172:175]
    ds_read_b64_tr_b16 v[106:107], v23 offset:32480
    v_mfma_f32_16x16x32_bf16 a[176:179], v[112:115], v[44:47], a[176:179]
    v_mfma_f32_16x16x32_bf16 a[180:183], v[112:115], v[48:51], a[180:183]
    v_mfma_f32_16x16x32_bf16 a[184:187], v[112:115], v[52:55], a[184:187]
    v_mfma_f32_16x16x32_bf16 a[188:191], v[112:115], v[56:59], a[188:191]
    s_barrier
    s_waitcnt lgkmcnt(4)
    v_mfma_f32_16x16x32_bf16 a[192:195], v[92:95], v[44:47], a[192:195]
    ds_read_b64_tr_b16 v[108:109], v23 offset:9472
    v_mfma_f32_16x16x32_bf16 a[196:199], v[92:95], v[48:51], a[196:199]
    ds_read_b64_tr_b16 v[110:111], v23 offset:14080
    v_mfma_f32_16x16x32_bf16 a[200:203], v[92:95], v[52:55], a[200:203]
    ds_read_b64_tr_b16 v[112:113], v23 offset:27904
    v_mfma_f32_16x16x32_bf16 a[204:207], v[92:95], v[56:59], a[204:207]
    ds_read_b64_tr_b16 v[114:115], v23 offset:32512
    v_mfma_f32_16x16x32_bf16 a[208:211], v[96:99], v[44:47], a[208:211]
    s_add_u32 m0, s35, 36864
    s_mov_b32 s38, 2949120
    buffer_load_dwordx4 v8, s[20:23], s38 offen lds
    v_mfma_f32_16x16x32_bf16 a[212:215], v[96:99], v[48:51], a[212:215]
    s_add_u32 m0, s35, 37888
    s_mov_b32 s38, 2949120
    buffer_load_dwordx4 v9, s[20:23], s38 offen lds
    v_mfma_f32_16x16x32_bf16 a[216:219], v[96:99], v[52:55], a[216:219]
    s_add_u32 m0, s35, 38912
    s_mov_b32 s38, 2949120
    buffer_load_dwordx4 v10, s[20:23], s38 offen lds
    v_mfma_f32_16x16x32_bf16 a[220:223], v[96:99], v[56:59], a[220:223]
    s_waitcnt lgkmcnt(4)
    v_mfma_f32_16x16x32_bf16 a[224:227], v[100:103], v[44:47], a[224:227]
    ds_read_b64_tr_b16 v[92:93], v24 offset:0
    v_mfma_f32_16x16x32_bf16 a[228:231], v[100:103], v[48:51], a[228:231]
    ds_read_b64_tr_b16 v[94:95], v24 offset:4608
    v_mfma_f32_16x16x32_bf16 a[232:235], v[100:103], v[52:55], a[232:235]
    ds_read_b64_tr_b16 v[96:97], v24 offset:18432
    v_mfma_f32_16x16x32_bf16 a[236:239], v[100:103], v[56:59], a[236:239]
    ds_read_b64_tr_b16 v[98:99], v24 offset:23040
    v_mfma_f32_16x16x32_bf16 a[240:243], v[104:107], v[44:47], a[240:243]
    s_add_u32 m0, s35, 39936
    s_mov_b32 s38, 2949120
    buffer_load_dwordx4 v11, s[20:23], s38 offen lds
    v_mfma_f32_16x16x32_bf16 a[244:247], v[104:107], v[48:51], a[244:247]
    s_add_u32 m0, s35, 40960
    s_mov_b32 s38, 2949120
    buffer_load_dwordx4 v12, s[20:23], s38 offen lds
    v_mfma_f32_16x16x32_bf16 a[248:251], v[104:107], v[52:55], a[248:251]
    s_add_u32 m0, s35, 41984
    s_mov_b32 s38, 2949120
    buffer_load_dwordx4 v13, s[20:23], s38 offen lds
    v_mfma_f32_16x16x32_bf16 a[252:255], v[104:107], v[56:59], a[252:255]
    s_waitcnt lgkmcnt(4)
    v_mfma_f32_16x16x32_bf16 v[116:119], v[108:111], v[44:47], v[116:119]
    ds_read_b64_tr_b16 v[100:101], v24 offset:32
    v_mfma_f32_16x16x32_bf16 v[120:123], v[108:111], v[48:51], v[120:123]
    ds_read_b64_tr_b16 v[102:103], v24 offset:4640
    v_mfma_f32_16x16x32_bf16 v[124:127], v[108:111], v[52:55], v[124:127]
    ds_read_b64_tr_b16 v[104:105], v24 offset:18464
    v_mfma_f32_16x16x32_bf16 v[128:131], v[108:111], v[56:59], v[128:131]
    ds_read_b64_tr_b16 v[106:107], v24 offset:23072
    v_mfma_f32_16x16x32_bf16 v[132:135], v[112:115], v[44:47], v[132:135]
    s_add_u32 m0, s35, 43008
    s_mov_b32 s38, 2949120
    buffer_load_dwordx4 v14, s[20:23], s38 offen lds
    v_mfma_f32_16x16x32_bf16 v[136:139], v[112:115], v[48:51], v[136:139]
    s_add_u32 m0, s35, 44032
    s_mov_b32 s38, 2949120
    buffer_load_dwordx4 v15, s[20:23], s38 offen lds
    v_mfma_f32_16x16x32_bf16 v[140:143], v[112:115], v[52:55], v[140:143]
    s_add_u32 m0, s35, 45056
    s_mov_b32 s38, 2949120
    buffer_load_dwordx4 v16, s[20:23], s38 offen lds
    v_mfma_f32_16x16x32_bf16 v[144:147], v[112:115], v[56:59], v[144:147]
    s_waitcnt vmcnt(28)
    s_waitcnt lgkmcnt(4)
    v_mfma_f32_16x16x32_bf16 a[0:3], v[92:95], v[60:63], a[0:3]
    ds_read_b64_tr_b16 v[108:109], v24 offset:64
    v_mfma_f32_16x16x32_bf16 a[4:7], v[92:95], v[64:67], a[4:7]
    ds_read_b64_tr_b16 v[110:111], v24 offset:4672
    v_mfma_f32_16x16x32_bf16 a[8:11], v[92:95], v[68:71], a[8:11]
    ds_read_b64_tr_b16 v[112:113], v24 offset:18496
    v_mfma_f32_16x16x32_bf16 a[12:15], v[92:95], v[72:75], a[12:15]
    ds_read_b64_tr_b16 v[114:115], v24 offset:23104
    v_mfma_f32_16x16x32_bf16 a[16:19], v[96:99], v[60:63], a[16:19]
    s_movk_i32 s93, 4096
    buffer_load_dwordx4 v[168:171], v25, s[88:91], s93 offen
    v_mfma_f32_16x16x32_bf16 a[20:23], v[96:99], v[64:67], a[20:23]
    s_movk_i32 s93, 5120
    buffer_load_dwordx4 v[168:171], v25, s[88:91], s93 offen
    v_mfma_f32_16x16x32_bf16 a[24:27], v[96:99], v[68:71], a[24:27]
    s_mov_b32 s39, 9216
    buffer_load_dwordx4 v[44:47], v17, s[24:27], s39 offen
    v_mfma_f32_16x16x32_bf16 a[28:31], v[96:99], v[72:75], a[28:31]
    s_waitcnt lgkmcnt(4)
    v_mfma_f32_16x16x32_bf16 a[32:35], v[100:103], v[60:63], a[32:35]
    ds_read_b64_tr_b16 v[92:93], v24 offset:96
    v_mfma_f32_16x16x32_bf16 a[36:39], v[100:103], v[64:67], a[36:39]
    ds_read_b64_tr_b16 v[94:95], v24 offset:4704
    v_mfma_f32_16x16x32_bf16 a[40:43], v[100:103], v[68:71], a[40:43]
    ds_read_b64_tr_b16 v[96:97], v24 offset:18528
    v_mfma_f32_16x16x32_bf16 a[44:47], v[100:103], v[72:75], a[44:47]
    ds_read_b64_tr_b16 v[98:99], v24 offset:23136
    v_mfma_f32_16x16x32_bf16 a[48:51], v[104:107], v[60:63], a[48:51]
    s_mov_b32 s39, 9216
    buffer_load_dwordx4 v[48:51], v18, s[24:27], s39 offen
    v_mfma_f32_16x16x32_bf16 a[52:55], v[104:107], v[64:67], a[52:55]
    s_mov_b32 s39, 9216
    buffer_load_dwordx4 v[52:55], v19, s[24:27], s39 offen
    v_mfma_f32_16x16x32_bf16 a[56:59], v[104:107], v[68:71], a[56:59]
    s_mov_b32 s39, 9216
    buffer_load_dwordx4 v[56:59], v20, s[24:27], s39 offen
    v_mfma_f32_16x16x32_bf16 a[60:63], v[104:107], v[72:75], a[60:63]
    s_waitcnt lgkmcnt(4)
    v_mfma_f32_16x16x32_bf16 a[64:67], v[108:111], v[60:63], a[64:67]
    ds_read_b64_tr_b16 v[100:101], v24 offset:128
    v_mfma_f32_16x16x32_bf16 a[68:71], v[108:111], v[64:67], a[68:71]
    ds_read_b64_tr_b16 v[102:103], v24 offset:4736
    v_mfma_f32_16x16x32_bf16 a[72:75], v[108:111], v[68:71], a[72:75]
    ds_read_b64_tr_b16 v[104:105], v24 offset:18560
    v_mfma_f32_16x16x32_bf16 a[76:79], v[108:111], v[72:75], a[76:79]
    ds_read_b64_tr_b16 v[106:107], v24 offset:23168
    v_mfma_f32_16x16x32_bf16 a[80:83], v[112:115], v[60:63], a[80:83]
    v_mfma_f32_16x16x32_bf16 a[84:87], v[112:115], v[64:67], a[84:87]
    v_mfma_f32_16x16x32_bf16 a[88:91], v[112:115], v[68:71], a[88:91]
    v_mfma_f32_16x16x32_bf16 a[92:95], v[112:115], v[72:75], a[92:95]
    s_waitcnt lgkmcnt(4)
    v_mfma_f32_16x16x32_bf16 a[96:99], v[92:95], v[60:63], a[96:99]
    ds_read_b64_tr_b16 v[108:109], v24 offset:160
    v_mfma_f32_16x16x32_bf16 a[100:103], v[92:95], v[64:67], a[100:103]
    ds_read_b64_tr_b16 v[110:111], v24 offset:4768
    v_mfma_f32_16x16x32_bf16 a[104:107], v[92:95], v[68:71], a[104:107]
    ds_read_b64_tr_b16 v[112:113], v24 offset:18592
    v_mfma_f32_16x16x32_bf16 a[108:111], v[92:95], v[72:75], a[108:111]
    ds_read_b64_tr_b16 v[114:115], v24 offset:23200
    v_mfma_f32_16x16x32_bf16 a[112:115], v[96:99], v[60:63], a[112:115]
    v_mfma_f32_16x16x32_bf16 a[116:119], v[96:99], v[64:67], a[116:119]
    v_mfma_f32_16x16x32_bf16 a[120:123], v[96:99], v[68:71], a[120:123]
    v_mfma_f32_16x16x32_bf16 a[124:127], v[96:99], v[72:75], a[124:127]
    s_waitcnt lgkmcnt(4)
    v_mfma_f32_16x16x32_bf16 a[128:131], v[100:103], v[60:63], a[128:131]
    ds_read_b64_tr_b16 v[92:93], v24 offset:192
    v_mfma_f32_16x16x32_bf16 a[132:135], v[100:103], v[64:67], a[132:135]
    ds_read_b64_tr_b16 v[94:95], v24 offset:4800
    v_mfma_f32_16x16x32_bf16 a[136:139], v[100:103], v[68:71], a[136:139]
    ds_read_b64_tr_b16 v[96:97], v24 offset:18624
    v_mfma_f32_16x16x32_bf16 a[140:143], v[100:103], v[72:75], a[140:143]
    ds_read_b64_tr_b16 v[98:99], v24 offset:23232
    v_mfma_f32_16x16x32_bf16 a[144:147], v[104:107], v[60:63], a[144:147]
    v_mfma_f32_16x16x32_bf16 a[148:151], v[104:107], v[64:67], a[148:151]
    v_mfma_f32_16x16x32_bf16 a[152:155], v[104:107], v[68:71], a[152:155]
    v_mfma_f32_16x16x32_bf16 a[156:159], v[104:107], v[72:75], a[156:159]
    s_waitcnt lgkmcnt(4)
    v_mfma_f32_16x16x32_bf16 a[160:163], v[108:111], v[60:63], a[160:163]
    ds_read_b64_tr_b16 v[100:101], v24 offset:224
    v_mfma_f32_16x16x32_bf16 a[164:167], v[108:111], v[64:67], a[164:167]
    ds_read_b64_tr_b16 v[102:103], v24 offset:4832
    v_mfma_f32_16x16x32_bf16 a[168:171], v[108:111], v[68:71], a[168:171]
    ds_read_b64_tr_b16 v[104:105], v24 offset:18656
    v_mfma_f32_16x16x32_bf16 a[172:175], v[108:111], v[72:75], a[172:175]
    ds_read_b64_tr_b16 v[106:107], v24 offset:23264
    v_mfma_f32_16x16x32_bf16 a[176:179], v[112:115], v[60:63], a[176:179]
    v_mfma_f32_16x16x32_bf16 a[180:183], v[112:115], v[64:67], a[180:183]
    v_mfma_f32_16x16x32_bf16 a[184:187], v[112:115], v[68:71], a[184:187]
    v_mfma_f32_16x16x32_bf16 a[188:191], v[112:115], v[72:75], a[188:191]
    s_waitcnt lgkmcnt(4)
    v_mfma_f32_16x16x32_bf16 a[192:195], v[92:95], v[60:63], a[192:195]
    ds_read_b64_tr_b16 v[108:109], v24 offset:256
    v_mfma_f32_16x16x32_bf16 a[196:199], v[92:95], v[64:67], a[196:199]
    ds_read_b64_tr_b16 v[110:111], v24 offset:4864
    v_mfma_f32_16x16x32_bf16 a[200:203], v[92:95], v[68:71], a[200:203]
    ds_read_b64_tr_b16 v[112:113], v24 offset:18688
    v_mfma_f32_16x16x32_bf16 a[204:207], v[92:95], v[72:75], a[204:207]
    ds_read_b64_tr_b16 v[114:115], v24 offset:23296
    v_mfma_f32_16x16x32_bf16 a[208:211], v[96:99], v[60:63], a[208:211]
    v_mfma_f32_16x16x32_bf16 a[212:215], v[96:99], v[64:67], a[212:215]
    v_mfma_f32_16x16x32_bf16 a[216:219], v[96:99], v[68:71], a[216:219]
    v_mfma_f32_16x16x32_bf16 a[220:223], v[96:99], v[72:75], a[220:223]
    s_waitcnt lgkmcnt(4)
    v_mfma_f32_16x16x32_bf16 a[224:227], v[100:103], v[60:63], a[224:227]
    ds_read_b64_tr_b16 v[92:93], v24 offset:9216
    v_mfma_f32_16x16x32_bf16 a[228:231], v[100:103], v[64:67], a[228:231]
    ds_read_b64_tr_b16 v[94:95], v24 offset:13824
    v_mfma_f32_16x16x32_bf16 a[232:235], v[100:103], v[68:71], a[232:235]
    ds_read_b64_tr_b16 v[96:97], v24 offset:27648
    v_mfma_f32_16x16x32_bf16 a[236:239], v[100:103], v[72:75], a[236:239]
    ds_read_b64_tr_b16 v[98:99], v24 offset:32256
    v_mfma_f32_16x16x32_bf16 a[240:243], v[104:107], v[60:63], a[240:243]
    v_mfma_f32_16x16x32_bf16 a[244:247], v[104:107], v[64:67], a[244:247]
    v_mfma_f32_16x16x32_bf16 a[248:251], v[104:107], v[68:71], a[248:251]
    v_mfma_f32_16x16x32_bf16 a[252:255], v[104:107], v[72:75], a[252:255]
    s_waitcnt lgkmcnt(4)
    v_mfma_f32_16x16x32_bf16 v[116:119], v[108:111], v[60:63], v[116:119]
    ds_read_b64_tr_b16 v[100:101], v24 offset:9248
    v_mfma_f32_16x16x32_bf16 v[120:123], v[108:111], v[64:67], v[120:123]
    ds_read_b64_tr_b16 v[102:103], v24 offset:13856
    v_mfma_f32_16x16x32_bf16 v[124:127], v[108:111], v[68:71], v[124:127]
    ds_read_b64_tr_b16 v[104:105], v24 offset:27680
    v_mfma_f32_16x16x32_bf16 v[128:131], v[108:111], v[72:75], v[128:131]
    ds_read_b64_tr_b16 v[106:107], v24 offset:32288
    v_mfma_f32_16x16x32_bf16 v[132:135], v[112:115], v[60:63], v[132:135]
    v_mfma_f32_16x16x32_bf16 v[136:139], v[112:115], v[64:67], v[136:139]
    v_mfma_f32_16x16x32_bf16 v[140:143], v[112:115], v[68:71], v[140:143]
    v_mfma_f32_16x16x32_bf16 v[144:147], v[112:115], v[72:75], v[144:147]
    s_waitcnt vmcnt(19)
    s_waitcnt lgkmcnt(4)
    v_mfma_f32_16x16x32_bf16 a[0:3], v[92:95], v[76:79], a[0:3]
    ds_read_b64_tr_b16 v[108:109], v24 offset:9280
    v_mfma_f32_16x16x32_bf16 a[4:7], v[92:95], v[80:83], a[4:7]
    ds_read_b64_tr_b16 v[110:111], v24 offset:13888
    v_mfma_f32_16x16x32_bf16 a[8:11], v[92:95], v[84:87], a[8:11]
    ds_read_b64_tr_b16 v[112:113], v24 offset:27712
    v_mfma_f32_16x16x32_bf16 a[12:15], v[92:95], v[88:91], a[12:15]
    ds_read_b64_tr_b16 v[114:115], v24 offset:32320
    v_mfma_f32_16x16x32_bf16 a[16:19], v[96:99], v[76:79], a[16:19]
    s_mov_b32 s39, 10240
    buffer_load_dwordx4 v[60:63], v17, s[24:27], s39 offen
    v_mfma_f32_16x16x32_bf16 a[20:23], v[96:99], v[80:83], a[20:23]
    s_mov_b32 s39, 10240
    buffer_load_dwordx4 v[64:67], v18, s[24:27], s39 offen
    v_mfma_f32_16x16x32_bf16 a[24:27], v[96:99], v[84:87], a[24:27]
    s_mov_b32 s39, 10240
    buffer_load_dwordx4 v[68:71], v19, s[24:27], s39 offen
    v_mfma_f32_16x16x32_bf16 a[28:31], v[96:99], v[88:91], a[28:31]
    s_waitcnt lgkmcnt(4)
    v_mfma_f32_16x16x32_bf16 a[32:35], v[100:103], v[76:79], a[32:35]
    ds_read_b64_tr_b16 v[92:93], v24 offset:9312
    v_mfma_f32_16x16x32_bf16 a[36:39], v[100:103], v[80:83], a[36:39]
    ds_read_b64_tr_b16 v[94:95], v24 offset:13920
    v_mfma_f32_16x16x32_bf16 a[40:43], v[100:103], v[84:87], a[40:43]
    ds_read_b64_tr_b16 v[96:97], v24 offset:27744
    v_mfma_f32_16x16x32_bf16 a[44:47], v[100:103], v[88:91], a[44:47]
    ds_read_b64_tr_b16 v[98:99], v24 offset:32352
    v_mfma_f32_16x16x32_bf16 a[48:51], v[104:107], v[76:79], a[48:51]
    s_mov_b32 s39, 10240
    buffer_load_dwordx4 v[72:75], v20, s[24:27], s39 offen
    v_mfma_f32_16x16x32_bf16 a[52:55], v[104:107], v[80:83], a[52:55]
    v_mfma_f32_16x16x32_bf16 a[56:59], v[104:107], v[84:87], a[56:59]
    v_mfma_f32_16x16x32_bf16 a[60:63], v[104:107], v[88:91], a[60:63]
    s_waitcnt lgkmcnt(4)
    v_mfma_f32_16x16x32_bf16 a[64:67], v[108:111], v[76:79], a[64:67]
    ds_read_b64_tr_b16 v[100:101], v24 offset:9344
    v_mfma_f32_16x16x32_bf16 a[68:71], v[108:111], v[80:83], a[68:71]
    ds_read_b64_tr_b16 v[102:103], v24 offset:13952
    v_mfma_f32_16x16x32_bf16 a[72:75], v[108:111], v[84:87], a[72:75]
    ds_read_b64_tr_b16 v[104:105], v24 offset:27776
    v_mfma_f32_16x16x32_bf16 a[76:79], v[108:111], v[88:91], a[76:79]
    ds_read_b64_tr_b16 v[106:107], v24 offset:32384
    v_mfma_f32_16x16x32_bf16 a[80:83], v[112:115], v[76:79], a[80:83]
    v_mfma_f32_16x16x32_bf16 a[84:87], v[112:115], v[80:83], a[84:87]
    v_mfma_f32_16x16x32_bf16 a[88:91], v[112:115], v[84:87], a[88:91]
    v_mfma_f32_16x16x32_bf16 a[92:95], v[112:115], v[88:91], a[92:95]
    s_waitcnt lgkmcnt(4)
    v_mfma_f32_16x16x32_bf16 a[96:99], v[92:95], v[76:79], a[96:99]
    ds_read_b64_tr_b16 v[108:109], v24 offset:9376
    v_mfma_f32_16x16x32_bf16 a[100:103], v[92:95], v[80:83], a[100:103]
    ds_read_b64_tr_b16 v[110:111], v24 offset:13984
    v_mfma_f32_16x16x32_bf16 a[104:107], v[92:95], v[84:87], a[104:107]
    ds_read_b64_tr_b16 v[112:113], v24 offset:27808
    v_mfma_f32_16x16x32_bf16 a[108:111], v[92:95], v[88:91], a[108:111]
    ds_read_b64_tr_b16 v[114:115], v24 offset:32416
    v_mfma_f32_16x16x32_bf16 a[112:115], v[96:99], v[76:79], a[112:115]
    v_mfma_f32_16x16x32_bf16 a[116:119], v[96:99], v[80:83], a[116:119]
    v_mfma_f32_16x16x32_bf16 a[120:123], v[96:99], v[84:87], a[120:123]
    v_mfma_f32_16x16x32_bf16 a[124:127], v[96:99], v[88:91], a[124:127]
    s_waitcnt lgkmcnt(4)
    v_mfma_f32_16x16x32_bf16 a[128:131], v[100:103], v[76:79], a[128:131]
    ds_read_b64_tr_b16 v[92:93], v24 offset:9408
    v_mfma_f32_16x16x32_bf16 a[132:135], v[100:103], v[80:83], a[132:135]
    ds_read_b64_tr_b16 v[94:95], v24 offset:14016
    v_mfma_f32_16x16x32_bf16 a[136:139], v[100:103], v[84:87], a[136:139]
    ds_read_b64_tr_b16 v[96:97], v24 offset:27840
    v_mfma_f32_16x16x32_bf16 a[140:143], v[100:103], v[88:91], a[140:143]
    ds_read_b64_tr_b16 v[98:99], v24 offset:32448
    v_mfma_f32_16x16x32_bf16 a[144:147], v[104:107], v[76:79], a[144:147]
    v_mfma_f32_16x16x32_bf16 a[148:151], v[104:107], v[80:83], a[148:151]
    v_mfma_f32_16x16x32_bf16 a[152:155], v[104:107], v[84:87], a[152:155]
    v_mfma_f32_16x16x32_bf16 a[156:159], v[104:107], v[88:91], a[156:159]
    s_waitcnt lgkmcnt(4)
    v_mfma_f32_16x16x32_bf16 a[160:163], v[108:111], v[76:79], a[160:163]
    ds_read_b64_tr_b16 v[100:101], v24 offset:9440
    v_mfma_f32_16x16x32_bf16 a[164:167], v[108:111], v[80:83], a[164:167]
    ds_read_b64_tr_b16 v[102:103], v24 offset:14048
    v_mfma_f32_16x16x32_bf16 a[168:171], v[108:111], v[84:87], a[168:171]
    ds_read_b64_tr_b16 v[104:105], v24 offset:27872
    v_mfma_f32_16x16x32_bf16 a[172:175], v[108:111], v[88:91], a[172:175]
    ds_read_b64_tr_b16 v[106:107], v24 offset:32480
    v_mfma_f32_16x16x32_bf16 a[176:179], v[112:115], v[76:79], a[176:179]
    v_mfma_f32_16x16x32_bf16 a[180:183], v[112:115], v[80:83], a[180:183]
    v_mfma_f32_16x16x32_bf16 a[184:187], v[112:115], v[84:87], a[184:187]
    v_mfma_f32_16x16x32_bf16 a[188:191], v[112:115], v[88:91], a[188:191]
    s_barrier
    s_waitcnt lgkmcnt(4)
    v_mfma_f32_16x16x32_bf16 a[192:195], v[92:95], v[76:79], a[192:195]
    ds_read_b64_tr_b16 v[108:109], v24 offset:9472
    v_mfma_f32_16x16x32_bf16 a[196:199], v[92:95], v[80:83], a[196:199]
    ds_read_b64_tr_b16 v[110:111], v24 offset:14080
    v_mfma_f32_16x16x32_bf16 a[200:203], v[92:95], v[84:87], a[200:203]
    ds_read_b64_tr_b16 v[112:113], v24 offset:27904
    v_mfma_f32_16x16x32_bf16 a[204:207], v[92:95], v[88:91], a[204:207]
    ds_read_b64_tr_b16 v[114:115], v24 offset:32512
    v_mfma_f32_16x16x32_bf16 a[208:211], v[96:99], v[76:79], a[208:211]
    s_add_u32 m0, s35, 73728
    s_mov_b32 s38, 3538944
    buffer_load_dwordx4 v8, s[20:23], s38 offen lds
    v_mfma_f32_16x16x32_bf16 a[212:215], v[96:99], v[80:83], a[212:215]
    s_add_u32 m0, s35, 74752
    s_mov_b32 s38, 3538944
    buffer_load_dwordx4 v9, s[20:23], s38 offen lds
    v_mfma_f32_16x16x32_bf16 a[216:219], v[96:99], v[84:87], a[216:219]
    s_add_u32 m0, s35, 75776
    s_mov_b32 s38, 3538944
    buffer_load_dwordx4 v10, s[20:23], s38 offen lds
    v_mfma_f32_16x16x32_bf16 a[220:223], v[96:99], v[88:91], a[220:223]
    s_waitcnt lgkmcnt(4)
    v_mfma_f32_16x16x32_bf16 a[224:227], v[100:103], v[76:79], a[224:227]
    ds_read_b64_tr_b16 v[92:93], v21 offset:0
    v_mfma_f32_16x16x32_bf16 a[228:231], v[100:103], v[80:83], a[228:231]
    ds_read_b64_tr_b16 v[94:95], v21 offset:4608
    v_mfma_f32_16x16x32_bf16 a[232:235], v[100:103], v[84:87], a[232:235]
    ds_read_b64_tr_b16 v[96:97], v21 offset:18432
    v_mfma_f32_16x16x32_bf16 a[236:239], v[100:103], v[88:91], a[236:239]
    ds_read_b64_tr_b16 v[98:99], v21 offset:23040
    v_mfma_f32_16x16x32_bf16 a[240:243], v[104:107], v[76:79], a[240:243]
    s_add_u32 m0, s35, 76800
    s_mov_b32 s38, 3538944
    buffer_load_dwordx4 v11, s[20:23], s38 offen lds
    v_mfma_f32_16x16x32_bf16 a[244:247], v[104:107], v[80:83], a[244:247]
    s_add_u32 m0, s35, 77824
    s_mov_b32 s38, 3538944
    buffer_load_dwordx4 v12, s[20:23], s38 offen lds
    v_mfma_f32_16x16x32_bf16 a[248:251], v[104:107], v[84:87], a[248:251]
    s_add_u32 m0, s35, 78848
    s_mov_b32 s38, 3538944
    buffer_load_dwordx4 v13, s[20:23], s38 offen lds
    v_mfma_f32_16x16x32_bf16 a[252:255], v[104:107], v[88:91], a[252:255]
    s_waitcnt lgkmcnt(4)
    v_mfma_f32_16x16x32_bf16 v[116:119], v[108:111], v[76:79], v[116:119]
    ds_read_b64_tr_b16 v[100:101], v21 offset:32
    v_mfma_f32_16x16x32_bf16 v[120:123], v[108:111], v[80:83], v[120:123]
    ds_read_b64_tr_b16 v[102:103], v21 offset:4640
    v_mfma_f32_16x16x32_bf16 v[124:127], v[108:111], v[84:87], v[124:127]
    ds_read_b64_tr_b16 v[104:105], v21 offset:18464
    v_mfma_f32_16x16x32_bf16 v[128:131], v[108:111], v[88:91], v[128:131]
    ds_read_b64_tr_b16 v[106:107], v21 offset:23072
    v_mfma_f32_16x16x32_bf16 v[132:135], v[112:115], v[76:79], v[132:135]
    s_add_u32 m0, s35, 79872
    s_mov_b32 s38, 3538944
    buffer_load_dwordx4 v14, s[20:23], s38 offen lds
    v_mfma_f32_16x16x32_bf16 v[136:139], v[112:115], v[80:83], v[136:139]
    s_add_u32 m0, s35, 80896
    s_mov_b32 s38, 3538944
    buffer_load_dwordx4 v15, s[20:23], s38 offen lds
    v_mfma_f32_16x16x32_bf16 v[140:143], v[112:115], v[84:87], v[140:143]
    s_add_u32 m0, s35, 81920
    s_mov_b32 s38, 3538944
    buffer_load_dwordx4 v16, s[20:23], s38 offen lds
    v_mfma_f32_16x16x32_bf16 v[144:147], v[112:115], v[88:91], v[144:147]
    s_waitcnt vmcnt(28)
    s_waitcnt lgkmcnt(4)
    v_mfma_f32_16x16x32_bf16 a[0:3], v[92:95], v[28:31], a[0:3]
    ds_read_b64_tr_b16 v[108:109], v21 offset:64
    v_mfma_f32_16x16x32_bf16 a[4:7], v[92:95], v[32:35], a[4:7]
    ds_read_b64_tr_b16 v[110:111], v21 offset:4672
    v_mfma_f32_16x16x32_bf16 a[8:11], v[92:95], v[36:39], a[8:11]
    ds_read_b64_tr_b16 v[112:113], v21 offset:18496
    v_mfma_f32_16x16x32_bf16 a[12:15], v[92:95], v[40:43], a[12:15]
    ds_read_b64_tr_b16 v[114:115], v21 offset:23104
    v_mfma_f32_16x16x32_bf16 a[16:19], v[96:99], v[28:31], a[16:19]
    s_movk_i32 s93, 6144
    buffer_load_dwordx4 v[168:171], v25, s[88:91], s93 offen
    v_mfma_f32_16x16x32_bf16 a[20:23], v[96:99], v[32:35], a[20:23]
    s_movk_i32 s93, 7168
    buffer_load_dwordx4 v[168:171], v25, s[88:91], s93 offen
    v_mfma_f32_16x16x32_bf16 a[24:27], v[96:99], v[36:39], a[24:27]
    s_mov_b32 s39, 11264
    buffer_load_dwordx4 v[76:79], v17, s[24:27], s39 offen
    v_mfma_f32_16x16x32_bf16 a[28:31], v[96:99], v[40:43], a[28:31]
    s_waitcnt lgkmcnt(4)
    v_mfma_f32_16x16x32_bf16 a[32:35], v[100:103], v[28:31], a[32:35]
    ds_read_b64_tr_b16 v[92:93], v21 offset:96
    v_mfma_f32_16x16x32_bf16 a[36:39], v[100:103], v[32:35], a[36:39]
    ds_read_b64_tr_b16 v[94:95], v21 offset:4704
    v_mfma_f32_16x16x32_bf16 a[40:43], v[100:103], v[36:39], a[40:43]
    ds_read_b64_tr_b16 v[96:97], v21 offset:18528
    v_mfma_f32_16x16x32_bf16 a[44:47], v[100:103], v[40:43], a[44:47]
    ds_read_b64_tr_b16 v[98:99], v21 offset:23136
    v_mfma_f32_16x16x32_bf16 a[48:51], v[104:107], v[28:31], a[48:51]
    s_mov_b32 s39, 11264
    buffer_load_dwordx4 v[80:83], v18, s[24:27], s39 offen
    v_mfma_f32_16x16x32_bf16 a[52:55], v[104:107], v[32:35], a[52:55]
    s_mov_b32 s39, 11264
    buffer_load_dwordx4 v[84:87], v19, s[24:27], s39 offen
    v_mfma_f32_16x16x32_bf16 a[56:59], v[104:107], v[36:39], a[56:59]
    s_mov_b32 s39, 11264
    buffer_load_dwordx4 v[88:91], v20, s[24:27], s39 offen
    v_mfma_f32_16x16x32_bf16 a[60:63], v[104:107], v[40:43], a[60:63]
    s_waitcnt lgkmcnt(4)
    v_mfma_f32_16x16x32_bf16 a[64:67], v[108:111], v[28:31], a[64:67]
    ds_read_b64_tr_b16 v[100:101], v21 offset:128
    v_mfma_f32_16x16x32_bf16 a[68:71], v[108:111], v[32:35], a[68:71]
    ds_read_b64_tr_b16 v[102:103], v21 offset:4736
    v_mfma_f32_16x16x32_bf16 a[72:75], v[108:111], v[36:39], a[72:75]
    ds_read_b64_tr_b16 v[104:105], v21 offset:18560
    v_mfma_f32_16x16x32_bf16 a[76:79], v[108:111], v[40:43], a[76:79]
    ds_read_b64_tr_b16 v[106:107], v21 offset:23168
    v_mfma_f32_16x16x32_bf16 a[80:83], v[112:115], v[28:31], a[80:83]
    v_mfma_f32_16x16x32_bf16 a[84:87], v[112:115], v[32:35], a[84:87]
    v_mfma_f32_16x16x32_bf16 a[88:91], v[112:115], v[36:39], a[88:91]
    v_mfma_f32_16x16x32_bf16 a[92:95], v[112:115], v[40:43], a[92:95]
    s_waitcnt lgkmcnt(4)
    v_mfma_f32_16x16x32_bf16 a[96:99], v[92:95], v[28:31], a[96:99]
    ds_read_b64_tr_b16 v[108:109], v21 offset:160
    v_mfma_f32_16x16x32_bf16 a[100:103], v[92:95], v[32:35], a[100:103]
    ds_read_b64_tr_b16 v[110:111], v21 offset:4768
    v_mfma_f32_16x16x32_bf16 a[104:107], v[92:95], v[36:39], a[104:107]
    ds_read_b64_tr_b16 v[112:113], v21 offset:18592
    v_mfma_f32_16x16x32_bf16 a[108:111], v[92:95], v[40:43], a[108:111]
    ds_read_b64_tr_b16 v[114:115], v21 offset:23200
    v_mfma_f32_16x16x32_bf16 a[112:115], v[96:99], v[28:31], a[112:115]
    v_mfma_f32_16x16x32_bf16 a[116:119], v[96:99], v[32:35], a[116:119]
    v_mfma_f32_16x16x32_bf16 a[120:123], v[96:99], v[36:39], a[120:123]
    v_mfma_f32_16x16x32_bf16 a[124:127], v[96:99], v[40:43], a[124:127]
    s_waitcnt lgkmcnt(4)
    v_mfma_f32_16x16x32_bf16 a[128:131], v[100:103], v[28:31], a[128:131]
    ds_read_b64_tr_b16 v[92:93], v21 offset:192
    v_mfma_f32_16x16x32_bf16 a[132:135], v[100:103], v[32:35], a[132:135]
    ds_read_b64_tr_b16 v[94:95], v21 offset:4800
    v_mfma_f32_16x16x32_bf16 a[136:139], v[100:103], v[36:39], a[136:139]
    ds_read_b64_tr_b16 v[96:97], v21 offset:18624
    v_mfma_f32_16x16x32_bf16 a[140:143], v[100:103], v[40:43], a[140:143]
    ds_read_b64_tr_b16 v[98:99], v21 offset:23232
    v_mfma_f32_16x16x32_bf16 a[144:147], v[104:107], v[28:31], a[144:147]
    v_mfma_f32_16x16x32_bf16 a[148:151], v[104:107], v[32:35], a[148:151]
    v_mfma_f32_16x16x32_bf16 a[152:155], v[104:107], v[36:39], a[152:155]
    v_mfma_f32_16x16x32_bf16 a[156:159], v[104:107], v[40:43], a[156:159]
    s_waitcnt lgkmcnt(4)
    v_mfma_f32_16x16x32_bf16 a[160:163], v[108:111], v[28:31], a[160:163]
    ds_read_b64_tr_b16 v[100:101], v21 offset:224
    v_mfma_f32_16x16x32_bf16 a[164:167], v[108:111], v[32:35], a[164:167]
    ds_read_b64_tr_b16 v[102:103], v21 offset:4832
    v_mfma_f32_16x16x32_bf16 a[168:171], v[108:111], v[36:39], a[168:171]
    ds_read_b64_tr_b16 v[104:105], v21 offset:18656
    v_mfma_f32_16x16x32_bf16 a[172:175], v[108:111], v[40:43], a[172:175]
    ds_read_b64_tr_b16 v[106:107], v21 offset:23264
    v_mfma_f32_16x16x32_bf16 a[176:179], v[112:115], v[28:31], a[176:179]
    v_mfma_f32_16x16x32_bf16 a[180:183], v[112:115], v[32:35], a[180:183]
    v_mfma_f32_16x16x32_bf16 a[184:187], v[112:115], v[36:39], a[184:187]
    v_mfma_f32_16x16x32_bf16 a[188:191], v[112:115], v[40:43], a[188:191]
    s_waitcnt lgkmcnt(4)
    v_mfma_f32_16x16x32_bf16 a[192:195], v[92:95], v[28:31], a[192:195]
    ds_read_b64_tr_b16 v[108:109], v21 offset:256
    v_mfma_f32_16x16x32_bf16 a[196:199], v[92:95], v[32:35], a[196:199]
    ds_read_b64_tr_b16 v[110:111], v21 offset:4864
    v_mfma_f32_16x16x32_bf16 a[200:203], v[92:95], v[36:39], a[200:203]
    ds_read_b64_tr_b16 v[112:113], v21 offset:18688
    v_mfma_f32_16x16x32_bf16 a[204:207], v[92:95], v[40:43], a[204:207]
    ds_read_b64_tr_b16 v[114:115], v21 offset:23296
    v_mfma_f32_16x16x32_bf16 a[208:211], v[96:99], v[28:31], a[208:211]
    v_mfma_f32_16x16x32_bf16 a[212:215], v[96:99], v[32:35], a[212:215]
    v_mfma_f32_16x16x32_bf16 a[216:219], v[96:99], v[36:39], a[216:219]
    v_mfma_f32_16x16x32_bf16 a[220:223], v[96:99], v[40:43], a[220:223]
    s_waitcnt lgkmcnt(4)
    v_mfma_f32_16x16x32_bf16 a[224:227], v[100:103], v[28:31], a[224:227]
    ds_read_b64_tr_b16 v[92:93], v21 offset:9216
    v_mfma_f32_16x16x32_bf16 a[228:231], v[100:103], v[32:35], a[228:231]
    ds_read_b64_tr_b16 v[94:95], v21 offset:13824
    v_mfma_f32_16x16x32_bf16 a[232:235], v[100:103], v[36:39], a[232:235]
    ds_read_b64_tr_b16 v[96:97], v21 offset:27648
    v_mfma_f32_16x16x32_bf16 a[236:239], v[100:103], v[40:43], a[236:239]
    ds_read_b64_tr_b16 v[98:99], v21 offset:32256
    v_mfma_f32_16x16x32_bf16 a[240:243], v[104:107], v[28:31], a[240:243]
    v_mfma_f32_16x16x32_bf16 a[244:247], v[104:107], v[32:35], a[244:247]
    v_mfma_f32_16x16x32_bf16 a[248:251], v[104:107], v[36:39], a[248:251]
    v_mfma_f32_16x16x32_bf16 a[252:255], v[104:107], v[40:43], a[252:255]
    s_waitcnt lgkmcnt(4)
    v_mfma_f32_16x16x32_bf16 v[116:119], v[108:111], v[28:31], v[116:119]
    ds_read_b64_tr_b16 v[100:101], v21 offset:9248
    v_mfma_f32_16x16x32_bf16 v[120:123], v[108:111], v[32:35], v[120:123]
    ds_read_b64_tr_b16 v[102:103], v21 offset:13856
    v_mfma_f32_16x16x32_bf16 v[124:127], v[108:111], v[36:39], v[124:127]
    ds_read_b64_tr_b16 v[104:105], v21 offset:27680
    v_mfma_f32_16x16x32_bf16 v[128:131], v[108:111], v[40:43], v[128:131]
    ds_read_b64_tr_b16 v[106:107], v21 offset:32288
    v_mfma_f32_16x16x32_bf16 v[132:135], v[112:115], v[28:31], v[132:135]
    v_mfma_f32_16x16x32_bf16 v[136:139], v[112:115], v[32:35], v[136:139]
    v_mfma_f32_16x16x32_bf16 v[140:143], v[112:115], v[36:39], v[140:143]
    v_mfma_f32_16x16x32_bf16 v[144:147], v[112:115], v[40:43], v[144:147]
    s_waitcnt vmcnt(19)
    s_waitcnt lgkmcnt(4)
    v_mfma_f32_16x16x32_bf16 a[0:3], v[92:95], v[44:47], a[0:3]
    ds_read_b64_tr_b16 v[108:109], v21 offset:9280
    v_mfma_f32_16x16x32_bf16 a[4:7], v[92:95], v[48:51], a[4:7]
    ds_read_b64_tr_b16 v[110:111], v21 offset:13888
    v_mfma_f32_16x16x32_bf16 a[8:11], v[92:95], v[52:55], a[8:11]
    ds_read_b64_tr_b16 v[112:113], v21 offset:27712
    v_mfma_f32_16x16x32_bf16 a[12:15], v[92:95], v[56:59], a[12:15]
    ds_read_b64_tr_b16 v[114:115], v21 offset:32320
    v_mfma_f32_16x16x32_bf16 a[16:19], v[96:99], v[44:47], a[16:19]
    s_mov_b32 s39, 12288
    buffer_load_dwordx4 v[28:31], v17, s[24:27], s39 offen
    v_mfma_f32_16x16x32_bf16 a[20:23], v[96:99], v[48:51], a[20:23]
    s_mov_b32 s39, 12288
    buffer_load_dwordx4 v[32:35], v18, s[24:27], s39 offen
    v_mfma_f32_16x16x32_bf16 a[24:27], v[96:99], v[52:55], a[24:27]
    s_mov_b32 s39, 12288
    buffer_load_dwordx4 v[36:39], v19, s[24:27], s39 offen
    v_mfma_f32_16x16x32_bf16 a[28:31], v[96:99], v[56:59], a[28:31]
    s_waitcnt lgkmcnt(4)
    v_mfma_f32_16x16x32_bf16 a[32:35], v[100:103], v[44:47], a[32:35]
    ds_read_b64_tr_b16 v[92:93], v21 offset:9312
    v_mfma_f32_16x16x32_bf16 a[36:39], v[100:103], v[48:51], a[36:39]
    ds_read_b64_tr_b16 v[94:95], v21 offset:13920
    v_mfma_f32_16x16x32_bf16 a[40:43], v[100:103], v[52:55], a[40:43]
    ds_read_b64_tr_b16 v[96:97], v21 offset:27744
    v_mfma_f32_16x16x32_bf16 a[44:47], v[100:103], v[56:59], a[44:47]
    ds_read_b64_tr_b16 v[98:99], v21 offset:32352
    v_mfma_f32_16x16x32_bf16 a[48:51], v[104:107], v[44:47], a[48:51]
    s_mov_b32 s39, 12288
    buffer_load_dwordx4 v[40:43], v20, s[24:27], s39 offen
    v_mfma_f32_16x16x32_bf16 a[52:55], v[104:107], v[48:51], a[52:55]
    v_mfma_f32_16x16x32_bf16 a[56:59], v[104:107], v[52:55], a[56:59]
    v_mfma_f32_16x16x32_bf16 a[60:63], v[104:107], v[56:59], a[60:63]
    s_waitcnt lgkmcnt(4)
    v_mfma_f32_16x16x32_bf16 a[64:67], v[108:111], v[44:47], a[64:67]
    ds_read_b64_tr_b16 v[100:101], v21 offset:9344
    v_mfma_f32_16x16x32_bf16 a[68:71], v[108:111], v[48:51], a[68:71]
    ds_read_b64_tr_b16 v[102:103], v21 offset:13952
    v_mfma_f32_16x16x32_bf16 a[72:75], v[108:111], v[52:55], a[72:75]
    ds_read_b64_tr_b16 v[104:105], v21 offset:27776
    v_mfma_f32_16x16x32_bf16 a[76:79], v[108:111], v[56:59], a[76:79]
    ds_read_b64_tr_b16 v[106:107], v21 offset:32384
    v_mfma_f32_16x16x32_bf16 a[80:83], v[112:115], v[44:47], a[80:83]
    v_mfma_f32_16x16x32_bf16 a[84:87], v[112:115], v[48:51], a[84:87]
    v_mfma_f32_16x16x32_bf16 a[88:91], v[112:115], v[52:55], a[88:91]
    v_mfma_f32_16x16x32_bf16 a[92:95], v[112:115], v[56:59], a[92:95]
    s_waitcnt lgkmcnt(4)
    v_mfma_f32_16x16x32_bf16 a[96:99], v[92:95], v[44:47], a[96:99]
    ds_read_b64_tr_b16 v[108:109], v21 offset:9376
    v_mfma_f32_16x16x32_bf16 a[100:103], v[92:95], v[48:51], a[100:103]
    ds_read_b64_tr_b16 v[110:111], v21 offset:13984
    v_mfma_f32_16x16x32_bf16 a[104:107], v[92:95], v[52:55], a[104:107]
    ds_read_b64_tr_b16 v[112:113], v21 offset:27808
    v_mfma_f32_16x16x32_bf16 a[108:111], v[92:95], v[56:59], a[108:111]
    ds_read_b64_tr_b16 v[114:115], v21 offset:32416
    v_mfma_f32_16x16x32_bf16 a[112:115], v[96:99], v[44:47], a[112:115]
    v_mfma_f32_16x16x32_bf16 a[116:119], v[96:99], v[48:51], a[116:119]
    v_mfma_f32_16x16x32_bf16 a[120:123], v[96:99], v[52:55], a[120:123]
    v_mfma_f32_16x16x32_bf16 a[124:127], v[96:99], v[56:59], a[124:127]
    s_waitcnt lgkmcnt(4)
    v_mfma_f32_16x16x32_bf16 a[128:131], v[100:103], v[44:47], a[128:131]
    ds_read_b64_tr_b16 v[92:93], v21 offset:9408
    v_mfma_f32_16x16x32_bf16 a[132:135], v[100:103], v[48:51], a[132:135]
    ds_read_b64_tr_b16 v[94:95], v21 offset:14016
    v_mfma_f32_16x16x32_bf16 a[136:139], v[100:103], v[52:55], a[136:139]
    ds_read_b64_tr_b16 v[96:97], v21 offset:27840
    v_mfma_f32_16x16x32_bf16 a[140:143], v[100:103], v[56:59], a[140:143]
    ds_read_b64_tr_b16 v[98:99], v21 offset:32448
    v_mfma_f32_16x16x32_bf16 a[144:147], v[104:107], v[44:47], a[144:147]
    v_mfma_f32_16x16x32_bf16 a[148:151], v[104:107], v[48:51], a[148:151]
    v_mfma_f32_16x16x32_bf16 a[152:155], v[104:107], v[52:55], a[152:155]
    v_mfma_f32_16x16x32_bf16 a[156:159], v[104:107], v[56:59], a[156:159]
    s_waitcnt lgkmcnt(4)
    v_mfma_f32_16x16x32_bf16 a[160:163], v[108:111], v[44:47], a[160:163]
    ds_read_b64_tr_b16 v[100:101], v21 offset:9440
    v_mfma_f32_16x16x32_bf16 a[164:167], v[108:111], v[48:51], a[164:167]
    ds_read_b64_tr_b16 v[102:103], v21 offset:14048
    v_mfma_f32_16x16x32_bf16 a[168:171], v[108:111], v[52:55], a[168:171]
    ds_read_b64_tr_b16 v[104:105], v21 offset:27872
    v_mfma_f32_16x16x32_bf16 a[172:175], v[108:111], v[56:59], a[172:175]
    ds_read_b64_tr_b16 v[106:107], v21 offset:32480
    v_mfma_f32_16x16x32_bf16 a[176:179], v[112:115], v[44:47], a[176:179]
    v_mfma_f32_16x16x32_bf16 a[180:183], v[112:115], v[48:51], a[180:183]
    v_mfma_f32_16x16x32_bf16 a[184:187], v[112:115], v[52:55], a[184:187]
    v_mfma_f32_16x16x32_bf16 a[188:191], v[112:115], v[56:59], a[188:191]
    s_barrier
    s_waitcnt lgkmcnt(4)
    v_mfma_f32_16x16x32_bf16 a[192:195], v[92:95], v[44:47], a[192:195]
    ds_read_b64_tr_b16 v[108:109], v21 offset:9472
    v_mfma_f32_16x16x32_bf16 a[196:199], v[92:95], v[48:51], a[196:199]
    ds_read_b64_tr_b16 v[110:111], v21 offset:14080
    v_mfma_f32_16x16x32_bf16 a[200:203], v[92:95], v[52:55], a[200:203]
    ds_read_b64_tr_b16 v[112:113], v21 offset:27904
    v_mfma_f32_16x16x32_bf16 a[204:207], v[92:95], v[56:59], a[204:207]
    ds_read_b64_tr_b16 v[114:115], v21 offset:32512
    v_mfma_f32_16x16x32_bf16 a[208:211], v[96:99], v[44:47], a[208:211]
    s_add_u32 m0, s35, 110592
    s_mov_b32 s38, 4128768
    buffer_load_dwordx4 v8, s[20:23], s38 offen lds
    v_mfma_f32_16x16x32_bf16 a[212:215], v[96:99], v[48:51], a[212:215]
    s_add_u32 m0, s35, 111616
    s_mov_b32 s38, 4128768
    buffer_load_dwordx4 v9, s[20:23], s38 offen lds
    v_mfma_f32_16x16x32_bf16 a[216:219], v[96:99], v[52:55], a[216:219]
    s_add_u32 m0, s35, 112640
    s_mov_b32 s38, 4128768
    buffer_load_dwordx4 v10, s[20:23], s38 offen lds
    v_mfma_f32_16x16x32_bf16 a[220:223], v[96:99], v[56:59], a[220:223]
    s_waitcnt lgkmcnt(4)
    v_mfma_f32_16x16x32_bf16 a[224:227], v[100:103], v[44:47], a[224:227]
    ds_read_b64_tr_b16 v[92:93], v22 offset:0
    v_mfma_f32_16x16x32_bf16 a[228:231], v[100:103], v[48:51], a[228:231]
    ds_read_b64_tr_b16 v[94:95], v22 offset:4608
    v_mfma_f32_16x16x32_bf16 a[232:235], v[100:103], v[52:55], a[232:235]
    ds_read_b64_tr_b16 v[96:97], v22 offset:18432
    v_mfma_f32_16x16x32_bf16 a[236:239], v[100:103], v[56:59], a[236:239]
    ds_read_b64_tr_b16 v[98:99], v22 offset:23040
    v_mfma_f32_16x16x32_bf16 a[240:243], v[104:107], v[44:47], a[240:243]
    s_add_u32 m0, s35, 113664
    s_mov_b32 s38, 4128768
    buffer_load_dwordx4 v11, s[20:23], s38 offen lds
    v_mfma_f32_16x16x32_bf16 a[244:247], v[104:107], v[48:51], a[244:247]
    s_add_u32 m0, s35, 114688
    s_mov_b32 s38, 4128768
    buffer_load_dwordx4 v12, s[20:23], s38 offen lds
    v_mfma_f32_16x16x32_bf16 a[248:251], v[104:107], v[52:55], a[248:251]
    s_add_u32 m0, s35, 115712
    s_mov_b32 s38, 4128768
    buffer_load_dwordx4 v13, s[20:23], s38 offen lds
    v_mfma_f32_16x16x32_bf16 a[252:255], v[104:107], v[56:59], a[252:255]
    s_waitcnt lgkmcnt(4)
    v_mfma_f32_16x16x32_bf16 v[116:119], v[108:111], v[44:47], v[116:119]
    ds_read_b64_tr_b16 v[100:101], v22 offset:32
    v_mfma_f32_16x16x32_bf16 v[120:123], v[108:111], v[48:51], v[120:123]
    ds_read_b64_tr_b16 v[102:103], v22 offset:4640
    v_mfma_f32_16x16x32_bf16 v[124:127], v[108:111], v[52:55], v[124:127]
    ds_read_b64_tr_b16 v[104:105], v22 offset:18464
    v_mfma_f32_16x16x32_bf16 v[128:131], v[108:111], v[56:59], v[128:131]
    ds_read_b64_tr_b16 v[106:107], v22 offset:23072
    v_mfma_f32_16x16x32_bf16 v[132:135], v[112:115], v[44:47], v[132:135]
    s_add_u32 m0, s35, 116736
    s_mov_b32 s38, 4128768
    buffer_load_dwordx4 v14, s[20:23], s38 offen lds
    v_mfma_f32_16x16x32_bf16 v[136:139], v[112:115], v[48:51], v[136:139]
    s_add_u32 m0, s35, 117760
    s_mov_b32 s38, 4128768
    buffer_load_dwordx4 v15, s[20:23], s38 offen lds
    v_mfma_f32_16x16x32_bf16 v[140:143], v[112:115], v[52:55], v[140:143]
    s_add_u32 m0, s35, 118784
    s_mov_b32 s38, 4128768
    buffer_load_dwordx4 v16, s[20:23], s38 offen lds
    v_mfma_f32_16x16x32_bf16 v[144:147], v[112:115], v[56:59], v[144:147]
    s_waitcnt vmcnt(28)
    s_waitcnt lgkmcnt(4)
    v_mfma_f32_16x16x32_bf16 a[0:3], v[92:95], v[60:63], a[0:3]
    ds_read_b64_tr_b16 v[108:109], v22 offset:64
    v_mfma_f32_16x16x32_bf16 a[4:7], v[92:95], v[64:67], a[4:7]
    ds_read_b64_tr_b16 v[110:111], v22 offset:4672
    v_mfma_f32_16x16x32_bf16 a[8:11], v[92:95], v[68:71], a[8:11]
    ds_read_b64_tr_b16 v[112:113], v22 offset:18496
    v_mfma_f32_16x16x32_bf16 a[12:15], v[92:95], v[72:75], a[12:15]
    ds_read_b64_tr_b16 v[114:115], v22 offset:23104
    v_mfma_f32_16x16x32_bf16 a[16:19], v[96:99], v[60:63], a[16:19]
    s_movk_i32 s93, 8192
    buffer_load_dwordx4 v[168:171], v25, s[88:91], s93 offen
    v_mfma_f32_16x16x32_bf16 a[20:23], v[96:99], v[64:67], a[20:23]
    s_movk_i32 s93, 9216
    buffer_load_dwordx4 v[168:171], v25, s[88:91], s93 offen
    v_mfma_f32_16x16x32_bf16 a[24:27], v[96:99], v[68:71], a[24:27]
    s_mov_b32 s39, 13312
    buffer_load_dwordx4 v[44:47], v17, s[24:27], s39 offen
    v_mfma_f32_16x16x32_bf16 a[28:31], v[96:99], v[72:75], a[28:31]
    s_waitcnt lgkmcnt(4)
    v_mfma_f32_16x16x32_bf16 a[32:35], v[100:103], v[60:63], a[32:35]
    ds_read_b64_tr_b16 v[92:93], v22 offset:96
    v_mfma_f32_16x16x32_bf16 a[36:39], v[100:103], v[64:67], a[36:39]
    ds_read_b64_tr_b16 v[94:95], v22 offset:4704
    v_mfma_f32_16x16x32_bf16 a[40:43], v[100:103], v[68:71], a[40:43]
    ds_read_b64_tr_b16 v[96:97], v22 offset:18528
    v_mfma_f32_16x16x32_bf16 a[44:47], v[100:103], v[72:75], a[44:47]
    ds_read_b64_tr_b16 v[98:99], v22 offset:23136
    v_mfma_f32_16x16x32_bf16 a[48:51], v[104:107], v[60:63], a[48:51]
    s_mov_b32 s39, 13312
    buffer_load_dwordx4 v[48:51], v18, s[24:27], s39 offen
    v_mfma_f32_16x16x32_bf16 a[52:55], v[104:107], v[64:67], a[52:55]
    s_mov_b32 s39, 13312
    buffer_load_dwordx4 v[52:55], v19, s[24:27], s39 offen
    v_mfma_f32_16x16x32_bf16 a[56:59], v[104:107], v[68:71], a[56:59]
    s_mov_b32 s39, 13312
    buffer_load_dwordx4 v[56:59], v20, s[24:27], s39 offen
    v_mfma_f32_16x16x32_bf16 a[60:63], v[104:107], v[72:75], a[60:63]
    s_waitcnt lgkmcnt(4)
    v_mfma_f32_16x16x32_bf16 a[64:67], v[108:111], v[60:63], a[64:67]
    ds_read_b64_tr_b16 v[100:101], v22 offset:128
    v_mfma_f32_16x16x32_bf16 a[68:71], v[108:111], v[64:67], a[68:71]
    ds_read_b64_tr_b16 v[102:103], v22 offset:4736
    v_mfma_f32_16x16x32_bf16 a[72:75], v[108:111], v[68:71], a[72:75]
    ds_read_b64_tr_b16 v[104:105], v22 offset:18560
    v_mfma_f32_16x16x32_bf16 a[76:79], v[108:111], v[72:75], a[76:79]
    ds_read_b64_tr_b16 v[106:107], v22 offset:23168
    v_mfma_f32_16x16x32_bf16 a[80:83], v[112:115], v[60:63], a[80:83]
    v_mfma_f32_16x16x32_bf16 a[84:87], v[112:115], v[64:67], a[84:87]
    v_mfma_f32_16x16x32_bf16 a[88:91], v[112:115], v[68:71], a[88:91]
    v_mfma_f32_16x16x32_bf16 a[92:95], v[112:115], v[72:75], a[92:95]
    s_waitcnt lgkmcnt(4)
    v_mfma_f32_16x16x32_bf16 a[96:99], v[92:95], v[60:63], a[96:99]
    ds_read_b64_tr_b16 v[108:109], v22 offset:160
    v_mfma_f32_16x16x32_bf16 a[100:103], v[92:95], v[64:67], a[100:103]
    ds_read_b64_tr_b16 v[110:111], v22 offset:4768
    v_mfma_f32_16x16x32_bf16 a[104:107], v[92:95], v[68:71], a[104:107]
    ds_read_b64_tr_b16 v[112:113], v22 offset:18592
    v_mfma_f32_16x16x32_bf16 a[108:111], v[92:95], v[72:75], a[108:111]
    ds_read_b64_tr_b16 v[114:115], v22 offset:23200
    v_mfma_f32_16x16x32_bf16 a[112:115], v[96:99], v[60:63], a[112:115]
    v_mfma_f32_16x16x32_bf16 a[116:119], v[96:99], v[64:67], a[116:119]
    v_mfma_f32_16x16x32_bf16 a[120:123], v[96:99], v[68:71], a[120:123]
    v_mfma_f32_16x16x32_bf16 a[124:127], v[96:99], v[72:75], a[124:127]
    s_waitcnt lgkmcnt(4)
    v_mfma_f32_16x16x32_bf16 a[128:131], v[100:103], v[60:63], a[128:131]
    ds_read_b64_tr_b16 v[92:93], v22 offset:192
    v_mfma_f32_16x16x32_bf16 a[132:135], v[100:103], v[64:67], a[132:135]
    ds_read_b64_tr_b16 v[94:95], v22 offset:4800
    v_mfma_f32_16x16x32_bf16 a[136:139], v[100:103], v[68:71], a[136:139]
    ds_read_b64_tr_b16 v[96:97], v22 offset:18624
    v_mfma_f32_16x16x32_bf16 a[140:143], v[100:103], v[72:75], a[140:143]
    ds_read_b64_tr_b16 v[98:99], v22 offset:23232
    v_mfma_f32_16x16x32_bf16 a[144:147], v[104:107], v[60:63], a[144:147]
    v_mfma_f32_16x16x32_bf16 a[148:151], v[104:107], v[64:67], a[148:151]
    v_mfma_f32_16x16x32_bf16 a[152:155], v[104:107], v[68:71], a[152:155]
    v_mfma_f32_16x16x32_bf16 a[156:159], v[104:107], v[72:75], a[156:159]
    s_waitcnt lgkmcnt(4)
    v_mfma_f32_16x16x32_bf16 a[160:163], v[108:111], v[60:63], a[160:163]
    ds_read_b64_tr_b16 v[100:101], v22 offset:224
    v_mfma_f32_16x16x32_bf16 a[164:167], v[108:111], v[64:67], a[164:167]
    ds_read_b64_tr_b16 v[102:103], v22 offset:4832
    v_mfma_f32_16x16x32_bf16 a[168:171], v[108:111], v[68:71], a[168:171]
    ds_read_b64_tr_b16 v[104:105], v22 offset:18656
    v_mfma_f32_16x16x32_bf16 a[172:175], v[108:111], v[72:75], a[172:175]
    ds_read_b64_tr_b16 v[106:107], v22 offset:23264
    v_mfma_f32_16x16x32_bf16 a[176:179], v[112:115], v[60:63], a[176:179]
    v_mfma_f32_16x16x32_bf16 a[180:183], v[112:115], v[64:67], a[180:183]
    v_mfma_f32_16x16x32_bf16 a[184:187], v[112:115], v[68:71], a[184:187]
    v_mfma_f32_16x16x32_bf16 a[188:191], v[112:115], v[72:75], a[188:191]
    s_waitcnt lgkmcnt(4)
    v_mfma_f32_16x16x32_bf16 a[192:195], v[92:95], v[60:63], a[192:195]
    ds_read_b64_tr_b16 v[108:109], v22 offset:256
    v_mfma_f32_16x16x32_bf16 a[196:199], v[92:95], v[64:67], a[196:199]
    ds_read_b64_tr_b16 v[110:111], v22 offset:4864
    v_mfma_f32_16x16x32_bf16 a[200:203], v[92:95], v[68:71], a[200:203]
    ds_read_b64_tr_b16 v[112:113], v22 offset:18688
    v_mfma_f32_16x16x32_bf16 a[204:207], v[92:95], v[72:75], a[204:207]
    ds_read_b64_tr_b16 v[114:115], v22 offset:23296
    v_mfma_f32_16x16x32_bf16 a[208:211], v[96:99], v[60:63], a[208:211]
    v_mfma_f32_16x16x32_bf16 a[212:215], v[96:99], v[64:67], a[212:215]
    v_mfma_f32_16x16x32_bf16 a[216:219], v[96:99], v[68:71], a[216:219]
    v_mfma_f32_16x16x32_bf16 a[220:223], v[96:99], v[72:75], a[220:223]
    s_waitcnt lgkmcnt(4)
    v_mfma_f32_16x16x32_bf16 a[224:227], v[100:103], v[60:63], a[224:227]
    ds_read_b64_tr_b16 v[92:93], v22 offset:9216
    v_mfma_f32_16x16x32_bf16 a[228:231], v[100:103], v[64:67], a[228:231]
    ds_read_b64_tr_b16 v[94:95], v22 offset:13824
    v_mfma_f32_16x16x32_bf16 a[232:235], v[100:103], v[68:71], a[232:235]
    ds_read_b64_tr_b16 v[96:97], v22 offset:27648
    v_mfma_f32_16x16x32_bf16 a[236:239], v[100:103], v[72:75], a[236:239]
    ds_read_b64_tr_b16 v[98:99], v22 offset:32256
    v_mfma_f32_16x16x32_bf16 a[240:243], v[104:107], v[60:63], a[240:243]
    v_mfma_f32_16x16x32_bf16 a[244:247], v[104:107], v[64:67], a[244:247]
    v_mfma_f32_16x16x32_bf16 a[248:251], v[104:107], v[68:71], a[248:251]
    v_mfma_f32_16x16x32_bf16 a[252:255], v[104:107], v[72:75], a[252:255]
    s_waitcnt lgkmcnt(4)
    v_mfma_f32_16x16x32_bf16 v[116:119], v[108:111], v[60:63], v[116:119]
    ds_read_b64_tr_b16 v[100:101], v22 offset:9248
    v_mfma_f32_16x16x32_bf16 v[120:123], v[108:111], v[64:67], v[120:123]
    ds_read_b64_tr_b16 v[102:103], v22 offset:13856
    v_mfma_f32_16x16x32_bf16 v[124:127], v[108:111], v[68:71], v[124:127]
    ds_read_b64_tr_b16 v[104:105], v22 offset:27680
    v_mfma_f32_16x16x32_bf16 v[128:131], v[108:111], v[72:75], v[128:131]
    ds_read_b64_tr_b16 v[106:107], v22 offset:32288
    v_mfma_f32_16x16x32_bf16 v[132:135], v[112:115], v[60:63], v[132:135]
    v_mfma_f32_16x16x32_bf16 v[136:139], v[112:115], v[64:67], v[136:139]
    v_mfma_f32_16x16x32_bf16 v[140:143], v[112:115], v[68:71], v[140:143]
    v_mfma_f32_16x16x32_bf16 v[144:147], v[112:115], v[72:75], v[144:147]
    s_waitcnt vmcnt(19)
    s_waitcnt lgkmcnt(4)
    v_mfma_f32_16x16x32_bf16 a[0:3], v[92:95], v[76:79], a[0:3]
    ds_read_b64_tr_b16 v[108:109], v22 offset:9280
    v_mfma_f32_16x16x32_bf16 a[4:7], v[92:95], v[80:83], a[4:7]
    ds_read_b64_tr_b16 v[110:111], v22 offset:13888
    v_mfma_f32_16x16x32_bf16 a[8:11], v[92:95], v[84:87], a[8:11]
    ds_read_b64_tr_b16 v[112:113], v22 offset:27712
    v_mfma_f32_16x16x32_bf16 a[12:15], v[92:95], v[88:91], a[12:15]
    ds_read_b64_tr_b16 v[114:115], v22 offset:32320
    v_mfma_f32_16x16x32_bf16 a[16:19], v[96:99], v[76:79], a[16:19]
    s_mov_b32 s39, 14336
    buffer_load_dwordx4 v[60:63], v17, s[24:27], s39 offen
    v_mfma_f32_16x16x32_bf16 a[20:23], v[96:99], v[80:83], a[20:23]
    s_mov_b32 s39, 14336
    buffer_load_dwordx4 v[64:67], v18, s[24:27], s39 offen
    v_mfma_f32_16x16x32_bf16 a[24:27], v[96:99], v[84:87], a[24:27]
    s_mov_b32 s39, 14336
    buffer_load_dwordx4 v[68:71], v19, s[24:27], s39 offen
    v_mfma_f32_16x16x32_bf16 a[28:31], v[96:99], v[88:91], a[28:31]
    s_waitcnt lgkmcnt(4)
    v_mfma_f32_16x16x32_bf16 a[32:35], v[100:103], v[76:79], a[32:35]
    ds_read_b64_tr_b16 v[92:93], v22 offset:9312
    v_mfma_f32_16x16x32_bf16 a[36:39], v[100:103], v[80:83], a[36:39]
    ds_read_b64_tr_b16 v[94:95], v22 offset:13920
    v_mfma_f32_16x16x32_bf16 a[40:43], v[100:103], v[84:87], a[40:43]
    ds_read_b64_tr_b16 v[96:97], v22 offset:27744
    v_mfma_f32_16x16x32_bf16 a[44:47], v[100:103], v[88:91], a[44:47]
    ds_read_b64_tr_b16 v[98:99], v22 offset:32352
    v_mfma_f32_16x16x32_bf16 a[48:51], v[104:107], v[76:79], a[48:51]
    s_mov_b32 s39, 14336
    buffer_load_dwordx4 v[72:75], v20, s[24:27], s39 offen
    v_mfma_f32_16x16x32_bf16 a[52:55], v[104:107], v[80:83], a[52:55]
    v_mfma_f32_16x16x32_bf16 a[56:59], v[104:107], v[84:87], a[56:59]
    v_mfma_f32_16x16x32_bf16 a[60:63], v[104:107], v[88:91], a[60:63]
    s_waitcnt lgkmcnt(4)
    v_mfma_f32_16x16x32_bf16 a[64:67], v[108:111], v[76:79], a[64:67]
    ds_read_b64_tr_b16 v[100:101], v22 offset:9344
    v_mfma_f32_16x16x32_bf16 a[68:71], v[108:111], v[80:83], a[68:71]
    ds_read_b64_tr_b16 v[102:103], v22 offset:13952
    v_mfma_f32_16x16x32_bf16 a[72:75], v[108:111], v[84:87], a[72:75]
    ds_read_b64_tr_b16 v[104:105], v22 offset:27776
    v_mfma_f32_16x16x32_bf16 a[76:79], v[108:111], v[88:91], a[76:79]
    ds_read_b64_tr_b16 v[106:107], v22 offset:32384
    v_mfma_f32_16x16x32_bf16 a[80:83], v[112:115], v[76:79], a[80:83]
    v_mfma_f32_16x16x32_bf16 a[84:87], v[112:115], v[80:83], a[84:87]
    v_mfma_f32_16x16x32_bf16 a[88:91], v[112:115], v[84:87], a[88:91]
    v_mfma_f32_16x16x32_bf16 a[92:95], v[112:115], v[88:91], a[92:95]
    s_waitcnt lgkmcnt(4)
    v_mfma_f32_16x16x32_bf16 a[96:99], v[92:95], v[76:79], a[96:99]
    ds_read_b64_tr_b16 v[108:109], v22 offset:9376
    v_mfma_f32_16x16x32_bf16 a[100:103], v[92:95], v[80:83], a[100:103]
    ds_read_b64_tr_b16 v[110:111], v22 offset:13984
    v_mfma_f32_16x16x32_bf16 a[104:107], v[92:95], v[84:87], a[104:107]
    ds_read_b64_tr_b16 v[112:113], v22 offset:27808
    v_mfma_f32_16x16x32_bf16 a[108:111], v[92:95], v[88:91], a[108:111]
    ds_read_b64_tr_b16 v[114:115], v22 offset:32416
    v_mfma_f32_16x16x32_bf16 a[112:115], v[96:99], v[76:79], a[112:115]
    v_mfma_f32_16x16x32_bf16 a[116:119], v[96:99], v[80:83], a[116:119]
    v_mfma_f32_16x16x32_bf16 a[120:123], v[96:99], v[84:87], a[120:123]
    v_mfma_f32_16x16x32_bf16 a[124:127], v[96:99], v[88:91], a[124:127]
    s_waitcnt lgkmcnt(4)
    v_mfma_f32_16x16x32_bf16 a[128:131], v[100:103], v[76:79], a[128:131]
    ds_read_b64_tr_b16 v[92:93], v22 offset:9408
    v_mfma_f32_16x16x32_bf16 a[132:135], v[100:103], v[80:83], a[132:135]
    ds_read_b64_tr_b16 v[94:95], v22 offset:14016
    v_mfma_f32_16x16x32_bf16 a[136:139], v[100:103], v[84:87], a[136:139]
    ds_read_b64_tr_b16 v[96:97], v22 offset:27840
    v_mfma_f32_16x16x32_bf16 a[140:143], v[100:103], v[88:91], a[140:143]
    ds_read_b64_tr_b16 v[98:99], v22 offset:32448
    v_mfma_f32_16x16x32_bf16 a[144:147], v[104:107], v[76:79], a[144:147]
    v_mfma_f32_16x16x32_bf16 a[148:151], v[104:107], v[80:83], a[148:151]
    v_mfma_f32_16x16x32_bf16 a[152:155], v[104:107], v[84:87], a[152:155]
    v_mfma_f32_16x16x32_bf16 a[156:159], v[104:107], v[88:91], a[156:159]
    s_waitcnt lgkmcnt(4)
    v_mfma_f32_16x16x32_bf16 a[160:163], v[108:111], v[76:79], a[160:163]
    ds_read_b64_tr_b16 v[100:101], v22 offset:9440
    v_mfma_f32_16x16x32_bf16 a[164:167], v[108:111], v[80:83], a[164:167]
    ds_read_b64_tr_b16 v[102:103], v22 offset:14048
    v_mfma_f32_16x16x32_bf16 a[168:171], v[108:111], v[84:87], a[168:171]
    ds_read_b64_tr_b16 v[104:105], v22 offset:27872
    v_mfma_f32_16x16x32_bf16 a[172:175], v[108:111], v[88:91], a[172:175]
    ds_read_b64_tr_b16 v[106:107], v22 offset:32480
    v_mfma_f32_16x16x32_bf16 a[176:179], v[112:115], v[76:79], a[176:179]
    v_mfma_f32_16x16x32_bf16 a[180:183], v[112:115], v[80:83], a[180:183]
    v_mfma_f32_16x16x32_bf16 a[184:187], v[112:115], v[84:87], a[184:187]
    v_mfma_f32_16x16x32_bf16 a[188:191], v[112:115], v[88:91], a[188:191]
    s_barrier
    s_waitcnt lgkmcnt(4)
    v_mfma_f32_16x16x32_bf16 a[192:195], v[92:95], v[76:79], a[192:195]
    ds_read_b64_tr_b16 v[108:109], v22 offset:9472
    v_mfma_f32_16x16x32_bf16 a[196:199], v[92:95], v[80:83], a[196:199]
    ds_read_b64_tr_b16 v[110:111], v22 offset:14080
    v_mfma_f32_16x16x32_bf16 a[200:203], v[92:95], v[84:87], a[200:203]
    ds_read_b64_tr_b16 v[112:113], v22 offset:27904
    v_mfma_f32_16x16x32_bf16 a[204:207], v[92:95], v[88:91], a[204:207]
    ds_read_b64_tr_b16 v[114:115], v22 offset:32512
    v_mfma_f32_16x16x32_bf16 a[208:211], v[96:99], v[76:79], a[208:211]
    s_add_u32 m0, s35, 0
    s_mov_b32 s38, 4718592
    buffer_load_dwordx4 v8, s[20:23], s38 offen lds
    v_mfma_f32_16x16x32_bf16 a[212:215], v[96:99], v[80:83], a[212:215]
    s_add_u32 m0, s35, 1024
    s_mov_b32 s38, 4718592
    buffer_load_dwordx4 v9, s[20:23], s38 offen lds
    v_mfma_f32_16x16x32_bf16 a[216:219], v[96:99], v[84:87], a[216:219]
    s_add_u32 m0, s35, 2048
    s_mov_b32 s38, 4718592
    buffer_load_dwordx4 v10, s[20:23], s38 offen lds
    v_mfma_f32_16x16x32_bf16 a[220:223], v[96:99], v[88:91], a[220:223]
    s_waitcnt lgkmcnt(4)
    v_mfma_f32_16x16x32_bf16 a[224:227], v[100:103], v[76:79], a[224:227]
    ds_read_b64_tr_b16 v[92:93], v23 offset:0
    v_mfma_f32_16x16x32_bf16 a[228:231], v[100:103], v[80:83], a[228:231]
    ds_read_b64_tr_b16 v[94:95], v23 offset:4608
    v_mfma_f32_16x16x32_bf16 a[232:235], v[100:103], v[84:87], a[232:235]
    ds_read_b64_tr_b16 v[96:97], v23 offset:18432
    v_mfma_f32_16x16x32_bf16 a[236:239], v[100:103], v[88:91], a[236:239]
    ds_read_b64_tr_b16 v[98:99], v23 offset:23040
    v_mfma_f32_16x16x32_bf16 a[240:243], v[104:107], v[76:79], a[240:243]
    s_add_u32 m0, s35, 3072
    s_mov_b32 s38, 4718592
    buffer_load_dwordx4 v11, s[20:23], s38 offen lds
    v_mfma_f32_16x16x32_bf16 a[244:247], v[104:107], v[80:83], a[244:247]
    s_add_u32 m0, s35, 4096
    s_mov_b32 s38, 4718592
    buffer_load_dwordx4 v12, s[20:23], s38 offen lds
    v_mfma_f32_16x16x32_bf16 a[248:251], v[104:107], v[84:87], a[248:251]
    s_add_u32 m0, s35, 5120
    s_mov_b32 s38, 4718592
    buffer_load_dwordx4 v13, s[20:23], s38 offen lds
    v_mfma_f32_16x16x32_bf16 a[252:255], v[104:107], v[88:91], a[252:255]
    s_waitcnt lgkmcnt(4)
    v_mfma_f32_16x16x32_bf16 v[116:119], v[108:111], v[76:79], v[116:119]
    ds_read_b64_tr_b16 v[100:101], v23 offset:32
    v_mfma_f32_16x16x32_bf16 v[120:123], v[108:111], v[80:83], v[120:123]
    ds_read_b64_tr_b16 v[102:103], v23 offset:4640
    v_mfma_f32_16x16x32_bf16 v[124:127], v[108:111], v[84:87], v[124:127]
    ds_read_b64_tr_b16 v[104:105], v23 offset:18464
    v_mfma_f32_16x16x32_bf16 v[128:131], v[108:111], v[88:91], v[128:131]
    ds_read_b64_tr_b16 v[106:107], v23 offset:23072
    v_mfma_f32_16x16x32_bf16 v[132:135], v[112:115], v[76:79], v[132:135]
    s_add_u32 m0, s35, 6144
    s_mov_b32 s38, 4718592
    buffer_load_dwordx4 v14, s[20:23], s38 offen lds
    v_mfma_f32_16x16x32_bf16 v[136:139], v[112:115], v[80:83], v[136:139]
    s_add_u32 m0, s35, 7168
    s_mov_b32 s38, 4718592
    buffer_load_dwordx4 v15, s[20:23], s38 offen lds
    v_mfma_f32_16x16x32_bf16 v[140:143], v[112:115], v[84:87], v[140:143]
    s_add_u32 m0, s35, 8192
    s_mov_b32 s38, 4718592
    buffer_load_dwordx4 v16, s[20:23], s38 offen lds
    v_mfma_f32_16x16x32_bf16 v[144:147], v[112:115], v[88:91], v[144:147]
    s_waitcnt vmcnt(28)
    s_waitcnt lgkmcnt(4)
    v_mfma_f32_16x16x32_bf16 a[0:3], v[92:95], v[28:31], a[0:3]
    ds_read_b64_tr_b16 v[108:109], v23 offset:64
    v_mfma_f32_16x16x32_bf16 a[4:7], v[92:95], v[32:35], a[4:7]
    ds_read_b64_tr_b16 v[110:111], v23 offset:4672
    v_mfma_f32_16x16x32_bf16 a[8:11], v[92:95], v[36:39], a[8:11]
    ds_read_b64_tr_b16 v[112:113], v23 offset:18496
    v_mfma_f32_16x16x32_bf16 a[12:15], v[92:95], v[40:43], a[12:15]
    ds_read_b64_tr_b16 v[114:115], v23 offset:23104
    v_mfma_f32_16x16x32_bf16 a[16:19], v[96:99], v[28:31], a[16:19]
    s_movk_i32 s93, 10240
    buffer_load_dwordx4 v[168:171], v25, s[88:91], s93 offen
    v_mfma_f32_16x16x32_bf16 a[20:23], v[96:99], v[32:35], a[20:23]
    s_mov_b32 s39, 15360
    buffer_load_dwordx4 v[76:79], v17, s[24:27], s39 offen
    v_mfma_f32_16x16x32_bf16 a[24:27], v[96:99], v[36:39], a[24:27]
    s_mov_b32 s39, 15360
    buffer_load_dwordx4 v[80:83], v18, s[24:27], s39 offen
    v_mfma_f32_16x16x32_bf16 a[28:31], v[96:99], v[40:43], a[28:31]
    s_waitcnt lgkmcnt(4)
    v_mfma_f32_16x16x32_bf16 a[32:35], v[100:103], v[28:31], a[32:35]
    ds_read_b64_tr_b16 v[92:93], v23 offset:96
    v_mfma_f32_16x16x32_bf16 a[36:39], v[100:103], v[32:35], a[36:39]
    ds_read_b64_tr_b16 v[94:95], v23 offset:4704
    v_mfma_f32_16x16x32_bf16 a[40:43], v[100:103], v[36:39], a[40:43]
    ds_read_b64_tr_b16 v[96:97], v23 offset:18528
    v_mfma_f32_16x16x32_bf16 a[44:47], v[100:103], v[40:43], a[44:47]
    ds_read_b64_tr_b16 v[98:99], v23 offset:23136
    v_mfma_f32_16x16x32_bf16 a[48:51], v[104:107], v[28:31], a[48:51]
    s_mov_b32 s39, 15360
    buffer_load_dwordx4 v[84:87], v19, s[24:27], s39 offen
    v_mfma_f32_16x16x32_bf16 a[52:55], v[104:107], v[32:35], a[52:55]
    s_mov_b32 s39, 15360
    buffer_load_dwordx4 v[88:91], v20, s[24:27], s39 offen
    v_mfma_f32_16x16x32_bf16 a[56:59], v[104:107], v[36:39], a[56:59]
    v_mfma_f32_16x16x32_bf16 a[60:63], v[104:107], v[40:43], a[60:63]
    s_waitcnt lgkmcnt(4)
    v_mfma_f32_16x16x32_bf16 a[64:67], v[108:111], v[28:31], a[64:67]
    ds_read_b64_tr_b16 v[100:101], v23 offset:128
    v_mfma_f32_16x16x32_bf16 a[68:71], v[108:111], v[32:35], a[68:71]
    ds_read_b64_tr_b16 v[102:103], v23 offset:4736
    v_mfma_f32_16x16x32_bf16 a[72:75], v[108:111], v[36:39], a[72:75]
    ds_read_b64_tr_b16 v[104:105], v23 offset:18560
    v_mfma_f32_16x16x32_bf16 a[76:79], v[108:111], v[40:43], a[76:79]
    ds_read_b64_tr_b16 v[106:107], v23 offset:23168
    v_mfma_f32_16x16x32_bf16 a[80:83], v[112:115], v[28:31], a[80:83]
    v_mfma_f32_16x16x32_bf16 a[84:87], v[112:115], v[32:35], a[84:87]
    v_mfma_f32_16x16x32_bf16 a[88:91], v[112:115], v[36:39], a[88:91]
    v_mfma_f32_16x16x32_bf16 a[92:95], v[112:115], v[40:43], a[92:95]
    s_waitcnt lgkmcnt(4)
    v_mfma_f32_16x16x32_bf16 a[96:99], v[92:95], v[28:31], a[96:99]
    ds_read_b64_tr_b16 v[108:109], v23 offset:160
    v_mfma_f32_16x16x32_bf16 a[100:103], v[92:95], v[32:35], a[100:103]
    ds_read_b64_tr_b16 v[110:111], v23 offset:4768
    v_mfma_f32_16x16x32_bf16 a[104:107], v[92:95], v[36:39], a[104:107]
    ds_read_b64_tr_b16 v[112:113], v23 offset:18592
    v_mfma_f32_16x16x32_bf16 a[108:111], v[92:95], v[40:43], a[108:111]
    ds_read_b64_tr_b16 v[114:115], v23 offset:23200
    v_mfma_f32_16x16x32_bf16 a[112:115], v[96:99], v[28:31], a[112:115]
    v_mfma_f32_16x16x32_bf16 a[116:119], v[96:99], v[32:35], a[116:119]
    v_mfma_f32_16x16x32_bf16 a[120:123], v[96:99], v[36:39], a[120:123]
    v_mfma_f32_16x16x32_bf16 a[124:127], v[96:99], v[40:43], a[124:127]
    s_waitcnt lgkmcnt(4)
    v_mfma_f32_16x16x32_bf16 a[128:131], v[100:103], v[28:31], a[128:131]
    ds_read_b64_tr_b16 v[92:93], v23 offset:192
    v_mfma_f32_16x16x32_bf16 a[132:135], v[100:103], v[32:35], a[132:135]
    ds_read_b64_tr_b16 v[94:95], v23 offset:4800
    v_mfma_f32_16x16x32_bf16 a[136:139], v[100:103], v[36:39], a[136:139]
    ds_read_b64_tr_b16 v[96:97], v23 offset:18624
    v_mfma_f32_16x16x32_bf16 a[140:143], v[100:103], v[40:43], a[140:143]
    ds_read_b64_tr_b16 v[98:99], v23 offset:23232
    v_mfma_f32_16x16x32_bf16 a[144:147], v[104:107], v[28:31], a[144:147]
    v_mfma_f32_16x16x32_bf16 a[148:151], v[104:107], v[32:35], a[148:151]
    v_mfma_f32_16x16x32_bf16 a[152:155], v[104:107], v[36:39], a[152:155]
    v_mfma_f32_16x16x32_bf16 a[156:159], v[104:107], v[40:43], a[156:159]
    s_waitcnt lgkmcnt(4)
    v_mfma_f32_16x16x32_bf16 a[160:163], v[108:111], v[28:31], a[160:163]
    ds_read_b64_tr_b16 v[100:101], v23 offset:224
    v_mfma_f32_16x16x32_bf16 a[164:167], v[108:111], v[32:35], a[164:167]
    ds_read_b64_tr_b16 v[102:103], v23 offset:4832
    v_mfma_f32_16x16x32_bf16 a[168:171], v[108:111], v[36:39], a[168:171]
    ds_read_b64_tr_b16 v[104:105], v23 offset:18656
    v_mfma_f32_16x16x32_bf16 a[172:175], v[108:111], v[40:43], a[172:175]
    ds_read_b64_tr_b16 v[106:107], v23 offset:23264
    v_mfma_f32_16x16x32_bf16 a[176:179], v[112:115], v[28:31], a[176:179]
    v_mfma_f32_16x16x32_bf16 a[180:183], v[112:115], v[32:35], a[180:183]
    v_mfma_f32_16x16x32_bf16 a[184:187], v[112:115], v[36:39], a[184:187]
    v_mfma_f32_16x16x32_bf16 a[188:191], v[112:115], v[40:43], a[188:191]
    s_waitcnt lgkmcnt(4)
    v_mfma_f32_16x16x32_bf16 a[192:195], v[92:95], v[28:31], a[192:195]
    ds_read_b64_tr_b16 v[108:109], v23 offset:256
    v_mfma_f32_16x16x32_bf16 a[196:199], v[92:95], v[32:35], a[196:199]
    ds_read_b64_tr_b16 v[110:111], v23 offset:4864
    v_mfma_f32_16x16x32_bf16 a[200:203], v[92:95], v[36:39], a[200:203]
    ds_read_b64_tr_b16 v[112:113], v23 offset:18688
    v_mfma_f32_16x16x32_bf16 a[204:207], v[92:95], v[40:43], a[204:207]
    ds_read_b64_tr_b16 v[114:115], v23 offset:23296
    v_mfma_f32_16x16x32_bf16 a[208:211], v[96:99], v[28:31], a[208:211]
    v_mfma_f32_16x16x32_bf16 a[212:215], v[96:99], v[32:35], a[212:215]
    v_mfma_f32_16x16x32_bf16 a[216:219], v[96:99], v[36:39], a[216:219]
    v_mfma_f32_16x16x32_bf16 a[220:223], v[96:99], v[40:43], a[220:223]
    s_waitcnt lgkmcnt(4)
    v_mfma_f32_16x16x32_bf16 a[224:227], v[100:103], v[28:31], a[224:227]
    ds_read_b64_tr_b16 v[92:93], v23 offset:9216
    v_mfma_f32_16x16x32_bf16 a[228:231], v[100:103], v[32:35], a[228:231]
    ds_read_b64_tr_b16 v[94:95], v23 offset:13824
    v_mfma_f32_16x16x32_bf16 a[232:235], v[100:103], v[36:39], a[232:235]
    ds_read_b64_tr_b16 v[96:97], v23 offset:27648
    v_mfma_f32_16x16x32_bf16 a[236:239], v[100:103], v[40:43], a[236:239]
    ds_read_b64_tr_b16 v[98:99], v23 offset:32256
    v_mfma_f32_16x16x32_bf16 a[240:243], v[104:107], v[28:31], a[240:243]
    v_mfma_f32_16x16x32_bf16 a[244:247], v[104:107], v[32:35], a[244:247]
    v_mfma_f32_16x16x32_bf16 a[248:251], v[104:107], v[36:39], a[248:251]
    v_mfma_f32_16x16x32_bf16 a[252:255], v[104:107], v[40:43], a[252:255]
    s_waitcnt lgkmcnt(4)
    v_mfma_f32_16x16x32_bf16 v[116:119], v[108:111], v[28:31], v[116:119]
    ds_read_b64_tr_b16 v[100:101], v23 offset:9248
    v_mfma_f32_16x16x32_bf16 v[120:123], v[108:111], v[32:35], v[120:123]
    ds_read_b64_tr_b16 v[102:103], v23 offset:13856
    v_mfma_f32_16x16x32_bf16 v[124:127], v[108:111], v[36:39], v[124:127]
    ds_read_b64_tr_b16 v[104:105], v23 offset:27680
    v_mfma_f32_16x16x32_bf16 v[128:131], v[108:111], v[40:43], v[128:131]
    ds_read_b64_tr_b16 v[106:107], v23 offset:32288
    v_mfma_f32_16x16x32_bf16 v[132:135], v[112:115], v[28:31], v[132:135]
    v_mfma_f32_16x16x32_bf16 v[136:139], v[112:115], v[32:35], v[136:139]
    v_mfma_f32_16x16x32_bf16 v[140:143], v[112:115], v[36:39], v[140:143]
    v_mfma_f32_16x16x32_bf16 v[144:147], v[112:115], v[40:43], v[144:147]
    s_waitcnt vmcnt(18)
    s_waitcnt lgkmcnt(4)
    v_mfma_f32_16x16x32_bf16 a[0:3], v[92:95], v[44:47], a[0:3]
    ds_read_b64_tr_b16 v[108:109], v23 offset:9280
    v_mfma_f32_16x16x32_bf16 a[4:7], v[92:95], v[48:51], a[4:7]
    ds_read_b64_tr_b16 v[110:111], v23 offset:13888
    v_mfma_f32_16x16x32_bf16 a[8:11], v[92:95], v[52:55], a[8:11]
    ds_read_b64_tr_b16 v[112:113], v23 offset:27712
    v_mfma_f32_16x16x32_bf16 a[12:15], v[92:95], v[56:59], a[12:15]
    ds_read_b64_tr_b16 v[114:115], v23 offset:32320
    v_mfma_f32_16x16x32_bf16 a[16:19], v[96:99], v[44:47], a[16:19]
    s_mov_b32 s39, 16384
    buffer_load_dwordx4 v[28:31], v17, s[24:27], s39 offen
    v_mfma_f32_16x16x32_bf16 a[20:23], v[96:99], v[48:51], a[20:23]
    s_mov_b32 s39, 16384
    buffer_load_dwordx4 v[32:35], v18, s[24:27], s39 offen
    v_mfma_f32_16x16x32_bf16 a[24:27], v[96:99], v[52:55], a[24:27]
    s_mov_b32 s39, 16384
    buffer_load_dwordx4 v[36:39], v19, s[24:27], s39 offen
    v_mfma_f32_16x16x32_bf16 a[28:31], v[96:99], v[56:59], a[28:31]
    s_waitcnt lgkmcnt(4)
    v_mfma_f32_16x16x32_bf16 a[32:35], v[100:103], v[44:47], a[32:35]
    ds_read_b64_tr_b16 v[92:93], v23 offset:9312
    v_mfma_f32_16x16x32_bf16 a[36:39], v[100:103], v[48:51], a[36:39]
    ds_read_b64_tr_b16 v[94:95], v23 offset:13920
    v_mfma_f32_16x16x32_bf16 a[40:43], v[100:103], v[52:55], a[40:43]
    ds_read_b64_tr_b16 v[96:97], v23 offset:27744
    v_mfma_f32_16x16x32_bf16 a[44:47], v[100:103], v[56:59], a[44:47]
    ds_read_b64_tr_b16 v[98:99], v23 offset:32352
    v_mfma_f32_16x16x32_bf16 a[48:51], v[104:107], v[44:47], a[48:51]
    s_mov_b32 s39, 16384
    buffer_load_dwordx4 v[40:43], v20, s[24:27], s39 offen
    v_mfma_f32_16x16x32_bf16 a[52:55], v[104:107], v[48:51], a[52:55]
    v_mfma_f32_16x16x32_bf16 a[56:59], v[104:107], v[52:55], a[56:59]
    v_mfma_f32_16x16x32_bf16 a[60:63], v[104:107], v[56:59], a[60:63]
    s_waitcnt lgkmcnt(4)
    v_mfma_f32_16x16x32_bf16 a[64:67], v[108:111], v[44:47], a[64:67]
    ds_read_b64_tr_b16 v[100:101], v23 offset:9344
    v_mfma_f32_16x16x32_bf16 a[68:71], v[108:111], v[48:51], a[68:71]
    ds_read_b64_tr_b16 v[102:103], v23 offset:13952
    v_mfma_f32_16x16x32_bf16 a[72:75], v[108:111], v[52:55], a[72:75]
    ds_read_b64_tr_b16 v[104:105], v23 offset:27776
    v_mfma_f32_16x16x32_bf16 a[76:79], v[108:111], v[56:59], a[76:79]
    ds_read_b64_tr_b16 v[106:107], v23 offset:32384
    v_mfma_f32_16x16x32_bf16 a[80:83], v[112:115], v[44:47], a[80:83]
    v_mfma_f32_16x16x32_bf16 a[84:87], v[112:115], v[48:51], a[84:87]
    v_mfma_f32_16x16x32_bf16 a[88:91], v[112:115], v[52:55], a[88:91]
    v_mfma_f32_16x16x32_bf16 a[92:95], v[112:115], v[56:59], a[92:95]
    s_waitcnt lgkmcnt(4)
    v_mfma_f32_16x16x32_bf16 a[96:99], v[92:95], v[44:47], a[96:99]
    ds_read_b64_tr_b16 v[108:109], v23 offset:9376
    v_mfma_f32_16x16x32_bf16 a[100:103], v[92:95], v[48:51], a[100:103]
    ds_read_b64_tr_b16 v[110:111], v23 offset:13984
    v_mfma_f32_16x16x32_bf16 a[104:107], v[92:95], v[52:55], a[104:107]
    ds_read_b64_tr_b16 v[112:113], v23 offset:27808
    v_mfma_f32_16x16x32_bf16 a[108:111], v[92:95], v[56:59], a[108:111]
    ds_read_b64_tr_b16 v[114:115], v23 offset:32416
    v_mfma_f32_16x16x32_bf16 a[112:115], v[96:99], v[44:47], a[112:115]
    v_mfma_f32_16x16x32_bf16 a[116:119], v[96:99], v[48:51], a[116:119]
    v_mfma_f32_16x16x32_bf16 a[120:123], v[96:99], v[52:55], a[120:123]
    v_mfma_f32_16x16x32_bf16 a[124:127], v[96:99], v[56:59], a[124:127]
    s_waitcnt lgkmcnt(4)
    v_mfma_f32_16x16x32_bf16 a[128:131], v[100:103], v[44:47], a[128:131]
    ds_read_b64_tr_b16 v[92:93], v23 offset:9408
    v_mfma_f32_16x16x32_bf16 a[132:135], v[100:103], v[48:51], a[132:135]
    ds_read_b64_tr_b16 v[94:95], v23 offset:14016
    v_mfma_f32_16x16x32_bf16 a[136:139], v[100:103], v[52:55], a[136:139]
    ds_read_b64_tr_b16 v[96:97], v23 offset:27840
    v_mfma_f32_16x16x32_bf16 a[140:143], v[100:103], v[56:59], a[140:143]
    ds_read_b64_tr_b16 v[98:99], v23 offset:32448
    v_mfma_f32_16x16x32_bf16 a[144:147], v[104:107], v[44:47], a[144:147]
    v_mfma_f32_16x16x32_bf16 a[148:151], v[104:107], v[48:51], a[148:151]
    v_mfma_f32_16x16x32_bf16 a[152:155], v[104:107], v[52:55], a[152:155]
    v_mfma_f32_16x16x32_bf16 a[156:159], v[104:107], v[56:59], a[156:159]
    s_waitcnt lgkmcnt(4)
    v_mfma_f32_16x16x32_bf16 a[160:163], v[108:111], v[44:47], a[160:163]
    ds_read_b64_tr_b16 v[100:101], v23 offset:9440
    v_mfma_f32_16x16x32_bf16 a[164:167], v[108:111], v[48:51], a[164:167]
    ds_read_b64_tr_b16 v[102:103], v23 offset:14048
    v_mfma_f32_16x16x32_bf16 a[168:171], v[108:111], v[52:55], a[168:171]
    ds_read_b64_tr_b16 v[104:105], v23 offset:27872
    v_mfma_f32_16x16x32_bf16 a[172:175], v[108:111], v[56:59], a[172:175]
    ds_read_b64_tr_b16 v[106:107], v23 offset:32480
    v_mfma_f32_16x16x32_bf16 a[176:179], v[112:115], v[44:47], a[176:179]
    v_mfma_f32_16x16x32_bf16 a[180:183], v[112:115], v[48:51], a[180:183]
    v_mfma_f32_16x16x32_bf16 a[184:187], v[112:115], v[52:55], a[184:187]
    v_mfma_f32_16x16x32_bf16 a[188:191], v[112:115], v[56:59], a[188:191]
    s_barrier
    s_waitcnt lgkmcnt(4)
    v_mfma_f32_16x16x32_bf16 a[192:195], v[92:95], v[44:47], a[192:195]
    ds_read_b64_tr_b16 v[108:109], v23 offset:9472
    v_mfma_f32_16x16x32_bf16 a[196:199], v[92:95], v[48:51], a[196:199]
    ds_read_b64_tr_b16 v[110:111], v23 offset:14080
    v_mfma_f32_16x16x32_bf16 a[200:203], v[92:95], v[52:55], a[200:203]
    ds_read_b64_tr_b16 v[112:113], v23 offset:27904
    v_mfma_f32_16x16x32_bf16 a[204:207], v[92:95], v[56:59], a[204:207]
    ds_read_b64_tr_b16 v[114:115], v23 offset:32512
    v_mfma_f32_16x16x32_bf16 a[208:211], v[96:99], v[44:47], a[208:211]
    v_mfma_f32_16x16x32_bf16 a[212:215], v[96:99], v[48:51], a[212:215]
    v_mfma_f32_16x16x32_bf16 a[216:219], v[96:99], v[52:55], a[216:219]
    v_mfma_f32_16x16x32_bf16 a[220:223], v[96:99], v[56:59], a[220:223]
    s_waitcnt lgkmcnt(4)
    v_mfma_f32_16x16x32_bf16 a[224:227], v[100:103], v[44:47], a[224:227]
    ds_read_b64_tr_b16 v[92:93], v24 offset:0
    v_mfma_f32_16x16x32_bf16 a[228:231], v[100:103], v[48:51], a[228:231]
    ds_read_b64_tr_b16 v[94:95], v24 offset:4608
    v_mfma_f32_16x16x32_bf16 a[232:235], v[100:103], v[52:55], a[232:235]
    ds_read_b64_tr_b16 v[96:97], v24 offset:18432
    v_mfma_f32_16x16x32_bf16 a[236:239], v[100:103], v[56:59], a[236:239]
    ds_read_b64_tr_b16 v[98:99], v24 offset:23040
    v_mfma_f32_16x16x32_bf16 a[240:243], v[104:107], v[44:47], a[240:243]
    v_mfma_f32_16x16x32_bf16 a[244:247], v[104:107], v[48:51], a[244:247]
    v_mfma_f32_16x16x32_bf16 a[248:251], v[104:107], v[52:55], a[248:251]
    v_mfma_f32_16x16x32_bf16 a[252:255], v[104:107], v[56:59], a[252:255]
    s_waitcnt lgkmcnt(4)
    v_mfma_f32_16x16x32_bf16 v[116:119], v[108:111], v[44:47], v[116:119]
    ds_read_b64_tr_b16 v[100:101], v24 offset:32
    v_mfma_f32_16x16x32_bf16 v[120:123], v[108:111], v[48:51], v[120:123]
    ds_read_b64_tr_b16 v[102:103], v24 offset:4640
    v_mfma_f32_16x16x32_bf16 v[124:127], v[108:111], v[52:55], v[124:127]
    ds_read_b64_tr_b16 v[104:105], v24 offset:18464
    v_mfma_f32_16x16x32_bf16 v[128:131], v[108:111], v[56:59], v[128:131]
    ds_read_b64_tr_b16 v[106:107], v24 offset:23072
    v_mfma_f32_16x16x32_bf16 v[132:135], v[112:115], v[44:47], v[132:135]
    v_mfma_f32_16x16x32_bf16 v[136:139], v[112:115], v[48:51], v[136:139]
    v_mfma_f32_16x16x32_bf16 v[140:143], v[112:115], v[52:55], v[140:143]
    v_mfma_f32_16x16x32_bf16 v[144:147], v[112:115], v[56:59], v[144:147]
    s_waitcnt vmcnt(18)
    s_waitcnt lgkmcnt(4)
    v_mfma_f32_16x16x32_bf16 a[0:3], v[92:95], v[60:63], a[0:3]
    ds_read_b64_tr_b16 v[108:109], v24 offset:64
    v_mfma_f32_16x16x32_bf16 a[4:7], v[92:95], v[64:67], a[4:7]
    ds_read_b64_tr_b16 v[110:111], v24 offset:4672
    v_mfma_f32_16x16x32_bf16 a[8:11], v[92:95], v[68:71], a[8:11]
    ds_read_b64_tr_b16 v[112:113], v24 offset:18496
    v_mfma_f32_16x16x32_bf16 a[12:15], v[92:95], v[72:75], a[12:15]
    ds_read_b64_tr_b16 v[114:115], v24 offset:23104
    v_mfma_f32_16x16x32_bf16 a[16:19], v[96:99], v[60:63], a[16:19]
    s_mov_b32 s39, 17408
    buffer_load_dwordx4 v[44:47], v17, s[24:27], s39 offen
    v_mfma_f32_16x16x32_bf16 a[20:23], v[96:99], v[64:67], a[20:23]
    s_mov_b32 s39, 17408
    buffer_load_dwordx4 v[48:51], v18, s[24:27], s39 offen
    v_mfma_f32_16x16x32_bf16 a[24:27], v[96:99], v[68:71], a[24:27]
    s_mov_b32 s39, 17408
    buffer_load_dwordx4 v[52:55], v19, s[24:27], s39 offen
    v_mfma_f32_16x16x32_bf16 a[28:31], v[96:99], v[72:75], a[28:31]
    s_waitcnt lgkmcnt(4)
    v_mfma_f32_16x16x32_bf16 a[32:35], v[100:103], v[60:63], a[32:35]
    ds_read_b64_tr_b16 v[92:93], v24 offset:96
    v_mfma_f32_16x16x32_bf16 a[36:39], v[100:103], v[64:67], a[36:39]
    ds_read_b64_tr_b16 v[94:95], v24 offset:4704
    v_mfma_f32_16x16x32_bf16 a[40:43], v[100:103], v[68:71], a[40:43]
    ds_read_b64_tr_b16 v[96:97], v24 offset:18528
    v_mfma_f32_16x16x32_bf16 a[44:47], v[100:103], v[72:75], a[44:47]
    ds_read_b64_tr_b16 v[98:99], v24 offset:23136
    v_mfma_f32_16x16x32_bf16 a[48:51], v[104:107], v[60:63], a[48:51]
    s_mov_b32 s39, 17408
    buffer_load_dwordx4 v[56:59], v20, s[24:27], s39 offen
    v_mfma_f32_16x16x32_bf16 a[52:55], v[104:107], v[64:67], a[52:55]
    v_mfma_f32_16x16x32_bf16 a[56:59], v[104:107], v[68:71], a[56:59]
    v_mfma_f32_16x16x32_bf16 a[60:63], v[104:107], v[72:75], a[60:63]
    s_waitcnt lgkmcnt(4)
    v_mfma_f32_16x16x32_bf16 a[64:67], v[108:111], v[60:63], a[64:67]
    ds_read_b64_tr_b16 v[100:101], v24 offset:128
    v_mfma_f32_16x16x32_bf16 a[68:71], v[108:111], v[64:67], a[68:71]
    ds_read_b64_tr_b16 v[102:103], v24 offset:4736
    v_mfma_f32_16x16x32_bf16 a[72:75], v[108:111], v[68:71], a[72:75]
    ds_read_b64_tr_b16 v[104:105], v24 offset:18560
    v_mfma_f32_16x16x32_bf16 a[76:79], v[108:111], v[72:75], a[76:79]
    ds_read_b64_tr_b16 v[106:107], v24 offset:23168
    v_mfma_f32_16x16x32_bf16 a[80:83], v[112:115], v[60:63], a[80:83]
    v_mfma_f32_16x16x32_bf16 a[84:87], v[112:115], v[64:67], a[84:87]
    v_mfma_f32_16x16x32_bf16 a[88:91], v[112:115], v[68:71], a[88:91]
    v_mfma_f32_16x16x32_bf16 a[92:95], v[112:115], v[72:75], a[92:95]
    s_waitcnt lgkmcnt(4)
    v_mfma_f32_16x16x32_bf16 a[96:99], v[92:95], v[60:63], a[96:99]
    ds_read_b64_tr_b16 v[108:109], v24 offset:160
    v_mfma_f32_16x16x32_bf16 a[100:103], v[92:95], v[64:67], a[100:103]
    ds_read_b64_tr_b16 v[110:111], v24 offset:4768
    v_mfma_f32_16x16x32_bf16 a[104:107], v[92:95], v[68:71], a[104:107]
    ds_read_b64_tr_b16 v[112:113], v24 offset:18592
    v_mfma_f32_16x16x32_bf16 a[108:111], v[92:95], v[72:75], a[108:111]
    ds_read_b64_tr_b16 v[114:115], v24 offset:23200
    v_mfma_f32_16x16x32_bf16 a[112:115], v[96:99], v[60:63], a[112:115]
    v_mfma_f32_16x16x32_bf16 a[116:119], v[96:99], v[64:67], a[116:119]
    v_mfma_f32_16x16x32_bf16 a[120:123], v[96:99], v[68:71], a[120:123]
    v_mfma_f32_16x16x32_bf16 a[124:127], v[96:99], v[72:75], a[124:127]
    s_waitcnt lgkmcnt(4)
    v_mfma_f32_16x16x32_bf16 a[128:131], v[100:103], v[60:63], a[128:131]
    ds_read_b64_tr_b16 v[92:93], v24 offset:192
    v_mfma_f32_16x16x32_bf16 a[132:135], v[100:103], v[64:67], a[132:135]
    ds_read_b64_tr_b16 v[94:95], v24 offset:4800
    v_mfma_f32_16x16x32_bf16 a[136:139], v[100:103], v[68:71], a[136:139]
    ds_read_b64_tr_b16 v[96:97], v24 offset:18624
    v_mfma_f32_16x16x32_bf16 a[140:143], v[100:103], v[72:75], a[140:143]
    ds_read_b64_tr_b16 v[98:99], v24 offset:23232
    v_mfma_f32_16x16x32_bf16 a[144:147], v[104:107], v[60:63], a[144:147]
    v_mfma_f32_16x16x32_bf16 a[148:151], v[104:107], v[64:67], a[148:151]
    v_mfma_f32_16x16x32_bf16 a[152:155], v[104:107], v[68:71], a[152:155]
    v_mfma_f32_16x16x32_bf16 a[156:159], v[104:107], v[72:75], a[156:159]
    s_waitcnt lgkmcnt(4)
    v_mfma_f32_16x16x32_bf16 a[160:163], v[108:111], v[60:63], a[160:163]
    ds_read_b64_tr_b16 v[100:101], v24 offset:224
    v_mfma_f32_16x16x32_bf16 a[164:167], v[108:111], v[64:67], a[164:167]
    ds_read_b64_tr_b16 v[102:103], v24 offset:4832
    v_mfma_f32_16x16x32_bf16 a[168:171], v[108:111], v[68:71], a[168:171]
    ds_read_b64_tr_b16 v[104:105], v24 offset:18656
    v_mfma_f32_16x16x32_bf16 a[172:175], v[108:111], v[72:75], a[172:175]
    ds_read_b64_tr_b16 v[106:107], v24 offset:23264
    v_mfma_f32_16x16x32_bf16 a[176:179], v[112:115], v[60:63], a[176:179]
    v_mfma_f32_16x16x32_bf16 a[180:183], v[112:115], v[64:67], a[180:183]
    v_mfma_f32_16x16x32_bf16 a[184:187], v[112:115], v[68:71], a[184:187]
    v_mfma_f32_16x16x32_bf16 a[188:191], v[112:115], v[72:75], a[188:191]
    s_waitcnt lgkmcnt(4)
    v_mfma_f32_16x16x32_bf16 a[192:195], v[92:95], v[60:63], a[192:195]
    ds_read_b64_tr_b16 v[108:109], v24 offset:256
    v_mfma_f32_16x16x32_bf16 a[196:199], v[92:95], v[64:67], a[196:199]
    ds_read_b64_tr_b16 v[110:111], v24 offset:4864
    v_mfma_f32_16x16x32_bf16 a[200:203], v[92:95], v[68:71], a[200:203]
    ds_read_b64_tr_b16 v[112:113], v24 offset:18688
    v_mfma_f32_16x16x32_bf16 a[204:207], v[92:95], v[72:75], a[204:207]
    ds_read_b64_tr_b16 v[114:115], v24 offset:23296
    v_mfma_f32_16x16x32_bf16 a[208:211], v[96:99], v[60:63], a[208:211]
    v_mfma_f32_16x16x32_bf16 a[212:215], v[96:99], v[64:67], a[212:215]
    v_mfma_f32_16x16x32_bf16 a[216:219], v[96:99], v[68:71], a[216:219]
    v_mfma_f32_16x16x32_bf16 a[220:223], v[96:99], v[72:75], a[220:223]
    s_waitcnt lgkmcnt(4)
    v_mfma_f32_16x16x32_bf16 a[224:227], v[100:103], v[60:63], a[224:227]
    ds_read_b64_tr_b16 v[92:93], v24 offset:9216
    v_mfma_f32_16x16x32_bf16 a[228:231], v[100:103], v[64:67], a[228:231]
    ds_read_b64_tr_b16 v[94:95], v24 offset:13824
    v_mfma_f32_16x16x32_bf16 a[232:235], v[100:103], v[68:71], a[232:235]
    ds_read_b64_tr_b16 v[96:97], v24 offset:27648
    v_mfma_f32_16x16x32_bf16 a[236:239], v[100:103], v[72:75], a[236:239]
    ds_read_b64_tr_b16 v[98:99], v24 offset:32256
    v_mfma_f32_16x16x32_bf16 a[240:243], v[104:107], v[60:63], a[240:243]
    v_mfma_f32_16x16x32_bf16 a[244:247], v[104:107], v[64:67], a[244:247]
    v_mfma_f32_16x16x32_bf16 a[248:251], v[104:107], v[68:71], a[248:251]
    v_mfma_f32_16x16x32_bf16 a[252:255], v[104:107], v[72:75], a[252:255]
    s_waitcnt lgkmcnt(4)
    v_mfma_f32_16x16x32_bf16 v[116:119], v[108:111], v[60:63], v[116:119]
    ds_read_b64_tr_b16 v[100:101], v24 offset:9248
    v_mfma_f32_16x16x32_bf16 v[120:123], v[108:111], v[64:67], v[120:123]
    ds_read_b64_tr_b16 v[102:103], v24 offset:13856
    v_mfma_f32_16x16x32_bf16 v[124:127], v[108:111], v[68:71], v[124:127]
    ds_read_b64_tr_b16 v[104:105], v24 offset:27680
    v_mfma_f32_16x16x32_bf16 v[128:131], v[108:111], v[72:75], v[128:131]
    ds_read_b64_tr_b16 v[106:107], v24 offset:32288
    v_mfma_f32_16x16x32_bf16 v[132:135], v[112:115], v[60:63], v[132:135]
    v_mfma_f32_16x16x32_bf16 v[136:139], v[112:115], v[64:67], v[136:139]
    v_mfma_f32_16x16x32_bf16 v[140:143], v[112:115], v[68:71], v[140:143]
    v_mfma_f32_16x16x32_bf16 v[144:147], v[112:115], v[72:75], v[144:147]
    s_waitcnt vmcnt(8)
    s_waitcnt lgkmcnt(4)
    v_mfma_f32_16x16x32_bf16 a[0:3], v[92:95], v[76:79], a[0:3]
    ds_read_b64_tr_b16 v[108:109], v24 offset:9280
    v_mfma_f32_16x16x32_bf16 a[4:7], v[92:95], v[80:83], a[4:7]
    ds_read_b64_tr_b16 v[110:111], v24 offset:13888
    v_mfma_f32_16x16x32_bf16 a[8:11], v[92:95], v[84:87], a[8:11]
    ds_read_b64_tr_b16 v[112:113], v24 offset:27712
    v_mfma_f32_16x16x32_bf16 a[12:15], v[92:95], v[88:91], a[12:15]
    ds_read_b64_tr_b16 v[114:115], v24 offset:32320
    v_mfma_f32_16x16x32_bf16 a[16:19], v[96:99], v[76:79], a[16:19]
    v_mfma_f32_16x16x32_bf16 a[20:23], v[96:99], v[80:83], a[20:23]
    v_mfma_f32_16x16x32_bf16 a[24:27], v[96:99], v[84:87], a[24:27]
    v_mfma_f32_16x16x32_bf16 a[28:31], v[96:99], v[88:91], a[28:31]
    s_waitcnt lgkmcnt(4)
    v_mfma_f32_16x16x32_bf16 a[32:35], v[100:103], v[76:79], a[32:35]
    ds_read_b64_tr_b16 v[92:93], v24 offset:9312
    v_mfma_f32_16x16x32_bf16 a[36:39], v[100:103], v[80:83], a[36:39]
    ds_read_b64_tr_b16 v[94:95], v24 offset:13920
    v_mfma_f32_16x16x32_bf16 a[40:43], v[100:103], v[84:87], a[40:43]
    ds_read_b64_tr_b16 v[96:97], v24 offset:27744
    v_mfma_f32_16x16x32_bf16 a[44:47], v[100:103], v[88:91], a[44:47]
    ds_read_b64_tr_b16 v[98:99], v24 offset:32352
    v_mfma_f32_16x16x32_bf16 a[48:51], v[104:107], v[76:79], a[48:51]
    v_mfma_f32_16x16x32_bf16 a[52:55], v[104:107], v[80:83], a[52:55]
    v_mfma_f32_16x16x32_bf16 a[56:59], v[104:107], v[84:87], a[56:59]
    v_mfma_f32_16x16x32_bf16 a[60:63], v[104:107], v[88:91], a[60:63]
    s_waitcnt lgkmcnt(4)
    v_mfma_f32_16x16x32_bf16 a[64:67], v[108:111], v[76:79], a[64:67]
    ds_read_b64_tr_b16 v[100:101], v24 offset:9344
    v_mfma_f32_16x16x32_bf16 a[68:71], v[108:111], v[80:83], a[68:71]
    ds_read_b64_tr_b16 v[102:103], v24 offset:13952
    v_mfma_f32_16x16x32_bf16 a[72:75], v[108:111], v[84:87], a[72:75]
    ds_read_b64_tr_b16 v[104:105], v24 offset:27776
    v_mfma_f32_16x16x32_bf16 a[76:79], v[108:111], v[88:91], a[76:79]
    ds_read_b64_tr_b16 v[106:107], v24 offset:32384
    v_mfma_f32_16x16x32_bf16 a[80:83], v[112:115], v[76:79], a[80:83]
    v_mfma_f32_16x16x32_bf16 a[84:87], v[112:115], v[80:83], a[84:87]
    v_mfma_f32_16x16x32_bf16 a[88:91], v[112:115], v[84:87], a[88:91]
    v_mfma_f32_16x16x32_bf16 a[92:95], v[112:115], v[88:91], a[92:95]
    s_waitcnt lgkmcnt(4)
    v_mfma_f32_16x16x32_bf16 a[96:99], v[92:95], v[76:79], a[96:99]
    ds_read_b64_tr_b16 v[108:109], v24 offset:9376
    v_mfma_f32_16x16x32_bf16 a[100:103], v[92:95], v[80:83], a[100:103]
    ds_read_b64_tr_b16 v[110:111], v24 offset:13984
    v_mfma_f32_16x16x32_bf16 a[104:107], v[92:95], v[84:87], a[104:107]
    ds_read_b64_tr_b16 v[112:113], v24 offset:27808
    v_mfma_f32_16x16x32_bf16 a[108:111], v[92:95], v[88:91], a[108:111]
    ds_read_b64_tr_b16 v[114:115], v24 offset:32416
    v_mfma_f32_16x16x32_bf16 a[112:115], v[96:99], v[76:79], a[112:115]
    v_mfma_f32_16x16x32_bf16 a[116:119], v[96:99], v[80:83], a[116:119]
    v_mfma_f32_16x16x32_bf16 a[120:123], v[96:99], v[84:87], a[120:123]
    v_mfma_f32_16x16x32_bf16 a[124:127], v[96:99], v[88:91], a[124:127]
    s_waitcnt lgkmcnt(4)
    v_mfma_f32_16x16x32_bf16 a[128:131], v[100:103], v[76:79], a[128:131]
    ds_read_b64_tr_b16 v[92:93], v24 offset:9408
    v_mfma_f32_16x16x32_bf16 a[132:135], v[100:103], v[80:83], a[132:135]
    ds_read_b64_tr_b16 v[94:95], v24 offset:14016
    v_mfma_f32_16x16x32_bf16 a[136:139], v[100:103], v[84:87], a[136:139]
    ds_read_b64_tr_b16 v[96:97], v24 offset:27840
    v_mfma_f32_16x16x32_bf16 a[140:143], v[100:103], v[88:91], a[140:143]
    ds_read_b64_tr_b16 v[98:99], v24 offset:32448
    v_mfma_f32_16x16x32_bf16 a[144:147], v[104:107], v[76:79], a[144:147]
    v_mfma_f32_16x16x32_bf16 a[148:151], v[104:107], v[80:83], a[148:151]
    v_mfma_f32_16x16x32_bf16 a[152:155], v[104:107], v[84:87], a[152:155]
    v_mfma_f32_16x16x32_bf16 a[156:159], v[104:107], v[88:91], a[156:159]
    s_waitcnt lgkmcnt(4)
    v_mfma_f32_16x16x32_bf16 a[160:163], v[108:111], v[76:79], a[160:163]
    ds_read_b64_tr_b16 v[100:101], v24 offset:9440
    v_mfma_f32_16x16x32_bf16 a[164:167], v[108:111], v[80:83], a[164:167]
    ds_read_b64_tr_b16 v[102:103], v24 offset:14048
    v_mfma_f32_16x16x32_bf16 a[168:171], v[108:111], v[84:87], a[168:171]
    ds_read_b64_tr_b16 v[104:105], v24 offset:27872
    v_mfma_f32_16x16x32_bf16 a[172:175], v[108:111], v[88:91], a[172:175]
    ds_read_b64_tr_b16 v[106:107], v24 offset:32480
    v_mfma_f32_16x16x32_bf16 a[176:179], v[112:115], v[76:79], a[176:179]
    v_mfma_f32_16x16x32_bf16 a[180:183], v[112:115], v[80:83], a[180:183]
    v_mfma_f32_16x16x32_bf16 a[184:187], v[112:115], v[84:87], a[184:187]
    v_mfma_f32_16x16x32_bf16 a[188:191], v[112:115], v[88:91], a[188:191]
    s_barrier
    s_waitcnt lgkmcnt(4)
    v_mfma_f32_16x16x32_bf16 a[192:195], v[92:95], v[76:79], a[192:195]
    ds_read_b64_tr_b16 v[108:109], v24 offset:9472
    v_mfma_f32_16x16x32_bf16 a[196:199], v[92:95], v[80:83], a[196:199]
    ds_read_b64_tr_b16 v[110:111], v24 offset:14080
    v_mfma_f32_16x16x32_bf16 a[200:203], v[92:95], v[84:87], a[200:203]
    ds_read_b64_tr_b16 v[112:113], v24 offset:27904
    v_mfma_f32_16x16x32_bf16 a[204:207], v[92:95], v[88:91], a[204:207]
    ds_read_b64_tr_b16 v[114:115], v24 offset:32512
    v_mfma_f32_16x16x32_bf16 a[208:211], v[96:99], v[76:79], a[208:211]
    v_mfma_f32_16x16x32_bf16 a[212:215], v[96:99], v[80:83], a[212:215]
    v_mfma_f32_16x16x32_bf16 a[216:219], v[96:99], v[84:87], a[216:219]
    v_mfma_f32_16x16x32_bf16 a[220:223], v[96:99], v[88:91], a[220:223]
    s_waitcnt lgkmcnt(4)
    v_mfma_f32_16x16x32_bf16 a[224:227], v[100:103], v[76:79], a[224:227]
    ds_read_b64_tr_b16 v[92:93], v21 offset:0
    v_mfma_f32_16x16x32_bf16 a[228:231], v[100:103], v[80:83], a[228:231]
    ds_read_b64_tr_b16 v[94:95], v21 offset:4608
    v_mfma_f32_16x16x32_bf16 a[232:235], v[100:103], v[84:87], a[232:235]
    ds_read_b64_tr_b16 v[96:97], v21 offset:18432
    v_mfma_f32_16x16x32_bf16 a[236:239], v[100:103], v[88:91], a[236:239]
    ds_read_b64_tr_b16 v[98:99], v21 offset:23040
    v_mfma_f32_16x16x32_bf16 a[240:243], v[104:107], v[76:79], a[240:243]
    v_mfma_f32_16x16x32_bf16 a[244:247], v[104:107], v[80:83], a[244:247]
    v_mfma_f32_16x16x32_bf16 a[248:251], v[104:107], v[84:87], a[248:251]
    v_mfma_f32_16x16x32_bf16 a[252:255], v[104:107], v[88:91], a[252:255]
    s_waitcnt lgkmcnt(4)
    v_mfma_f32_16x16x32_bf16 v[116:119], v[108:111], v[76:79], v[116:119]
    ds_read_b64_tr_b16 v[100:101], v21 offset:32
    v_mfma_f32_16x16x32_bf16 v[120:123], v[108:111], v[80:83], v[120:123]
    ds_read_b64_tr_b16 v[102:103], v21 offset:4640
    v_mfma_f32_16x16x32_bf16 v[124:127], v[108:111], v[84:87], v[124:127]
    ds_read_b64_tr_b16 v[104:105], v21 offset:18464
    v_mfma_f32_16x16x32_bf16 v[128:131], v[108:111], v[88:91], v[128:131]
    ds_read_b64_tr_b16 v[106:107], v21 offset:23072
    v_mfma_f32_16x16x32_bf16 v[132:135], v[112:115], v[76:79], v[132:135]
    v_mfma_f32_16x16x32_bf16 v[136:139], v[112:115], v[80:83], v[136:139]
    v_mfma_f32_16x16x32_bf16 v[140:143], v[112:115], v[84:87], v[140:143]
    v_mfma_f32_16x16x32_bf16 v[144:147], v[112:115], v[88:91], v[144:147]
    s_waitcnt vmcnt(4)
    s_waitcnt lgkmcnt(4)
    v_mfma_f32_16x16x32_bf16 a[0:3], v[92:95], v[28:31], a[0:3]
    ds_read_b64_tr_b16 v[108:109], v21 offset:64
    v_mfma_f32_16x16x32_bf16 a[4:7], v[92:95], v[32:35], a[4:7]
    ds_read_b64_tr_b16 v[110:111], v21 offset:4672
    v_mfma_f32_16x16x32_bf16 a[8:11], v[92:95], v[36:39], a[8:11]
    ds_read_b64_tr_b16 v[112:113], v21 offset:18496
    v_mfma_f32_16x16x32_bf16 a[12:15], v[92:95], v[40:43], a[12:15]
    ds_read_b64_tr_b16 v[114:115], v21 offset:23104
    v_mfma_f32_16x16x32_bf16 a[16:19], v[96:99], v[28:31], a[16:19]
    v_mfma_f32_16x16x32_bf16 a[20:23], v[96:99], v[32:35], a[20:23]
    v_mfma_f32_16x16x32_bf16 a[24:27], v[96:99], v[36:39], a[24:27]
    v_mfma_f32_16x16x32_bf16 a[28:31], v[96:99], v[40:43], a[28:31]
    s_waitcnt lgkmcnt(4)
    v_mfma_f32_16x16x32_bf16 a[32:35], v[100:103], v[28:31], a[32:35]
    ds_read_b64_tr_b16 v[92:93], v21 offset:96
    v_mfma_f32_16x16x32_bf16 a[36:39], v[100:103], v[32:35], a[36:39]
    ds_read_b64_tr_b16 v[94:95], v21 offset:4704
    v_mfma_f32_16x16x32_bf16 a[40:43], v[100:103], v[36:39], a[40:43]
    ds_read_b64_tr_b16 v[96:97], v21 offset:18528
    v_mfma_f32_16x16x32_bf16 a[44:47], v[100:103], v[40:43], a[44:47]
    ds_read_b64_tr_b16 v[98:99], v21 offset:23136
    v_mfma_f32_16x16x32_bf16 a[48:51], v[104:107], v[28:31], a[48:51]
    v_mfma_f32_16x16x32_bf16 a[52:55], v[104:107], v[32:35], a[52:55]
    v_mfma_f32_16x16x32_bf16 a[56:59], v[104:107], v[36:39], a[56:59]
    v_mfma_f32_16x16x32_bf16 a[60:63], v[104:107], v[40:43], a[60:63]
    s_waitcnt lgkmcnt(4)
    v_mfma_f32_16x16x32_bf16 a[64:67], v[108:111], v[28:31], a[64:67]
    ds_read_b64_tr_b16 v[100:101], v21 offset:128
    v_mfma_f32_16x16x32_bf16 a[68:71], v[108:111], v[32:35], a[68:71]
    ds_read_b64_tr_b16 v[102:103], v21 offset:4736
    v_mfma_f32_16x16x32_bf16 a[72:75], v[108:111], v[36:39], a[72:75]
    ds_read_b64_tr_b16 v[104:105], v21 offset:18560
    v_mfma_f32_16x16x32_bf16 a[76:79], v[108:111], v[40:43], a[76:79]
    ds_read_b64_tr_b16 v[106:107], v21 offset:23168
    v_mfma_f32_16x16x32_bf16 a[80:83], v[112:115], v[28:31], a[80:83]
    v_mfma_f32_16x16x32_bf16 a[84:87], v[112:115], v[32:35], a[84:87]
    v_mfma_f32_16x16x32_bf16 a[88:91], v[112:115], v[36:39], a[88:91]
    v_mfma_f32_16x16x32_bf16 a[92:95], v[112:115], v[40:43], a[92:95]
    s_waitcnt lgkmcnt(4)
    v_mfma_f32_16x16x32_bf16 a[96:99], v[92:95], v[28:31], a[96:99]
    ds_read_b64_tr_b16 v[108:109], v21 offset:160
    v_mfma_f32_16x16x32_bf16 a[100:103], v[92:95], v[32:35], a[100:103]
    ds_read_b64_tr_b16 v[110:111], v21 offset:4768
    v_mfma_f32_16x16x32_bf16 a[104:107], v[92:95], v[36:39], a[104:107]
    ds_read_b64_tr_b16 v[112:113], v21 offset:18592
    v_mfma_f32_16x16x32_bf16 a[108:111], v[92:95], v[40:43], a[108:111]
    ds_read_b64_tr_b16 v[114:115], v21 offset:23200
    v_mfma_f32_16x16x32_bf16 a[112:115], v[96:99], v[28:31], a[112:115]
    v_mfma_f32_16x16x32_bf16 a[116:119], v[96:99], v[32:35], a[116:119]
    v_mfma_f32_16x16x32_bf16 a[120:123], v[96:99], v[36:39], a[120:123]
    v_mfma_f32_16x16x32_bf16 a[124:127], v[96:99], v[40:43], a[124:127]
    s_waitcnt lgkmcnt(4)
    v_mfma_f32_16x16x32_bf16 a[128:131], v[100:103], v[28:31], a[128:131]
    ds_read_b64_tr_b16 v[92:93], v21 offset:192
    v_mfma_f32_16x16x32_bf16 a[132:135], v[100:103], v[32:35], a[132:135]
    ds_read_b64_tr_b16 v[94:95], v21 offset:4800
    v_mfma_f32_16x16x32_bf16 a[136:139], v[100:103], v[36:39], a[136:139]
    ds_read_b64_tr_b16 v[96:97], v21 offset:18624
    v_mfma_f32_16x16x32_bf16 a[140:143], v[100:103], v[40:43], a[140:143]
    ds_read_b64_tr_b16 v[98:99], v21 offset:23232
    v_mfma_f32_16x16x32_bf16 a[144:147], v[104:107], v[28:31], a[144:147]
    v_mfma_f32_16x16x32_bf16 a[148:151], v[104:107], v[32:35], a[148:151]
    v_mfma_f32_16x16x32_bf16 a[152:155], v[104:107], v[36:39], a[152:155]
    v_mfma_f32_16x16x32_bf16 a[156:159], v[104:107], v[40:43], a[156:159]
    s_waitcnt lgkmcnt(4)
    v_mfma_f32_16x16x32_bf16 a[160:163], v[108:111], v[28:31], a[160:163]
    ds_read_b64_tr_b16 v[100:101], v21 offset:224
    v_mfma_f32_16x16x32_bf16 a[164:167], v[108:111], v[32:35], a[164:167]
    ds_read_b64_tr_b16 v[102:103], v21 offset:4832
    v_mfma_f32_16x16x32_bf16 a[168:171], v[108:111], v[36:39], a[168:171]
    ds_read_b64_tr_b16 v[104:105], v21 offset:18656
    v_mfma_f32_16x16x32_bf16 a[172:175], v[108:111], v[40:43], a[172:175]
    ds_read_b64_tr_b16 v[106:107], v21 offset:23264
    v_mfma_f32_16x16x32_bf16 a[176:179], v[112:115], v[28:31], a[176:179]
    v_mfma_f32_16x16x32_bf16 a[180:183], v[112:115], v[32:35], a[180:183]
    v_mfma_f32_16x16x32_bf16 a[184:187], v[112:115], v[36:39], a[184:187]
    v_mfma_f32_16x16x32_bf16 a[188:191], v[112:115], v[40:43], a[188:191]
    s_waitcnt lgkmcnt(4)
    v_mfma_f32_16x16x32_bf16 a[192:195], v[92:95], v[28:31], a[192:195]
    ds_read_b64_tr_b16 v[108:109], v21 offset:256
    v_mfma_f32_16x16x32_bf16 a[196:199], v[92:95], v[32:35], a[196:199]
    ds_read_b64_tr_b16 v[110:111], v21 offset:4864
    v_mfma_f32_16x16x32_bf16 a[200:203], v[92:95], v[36:39], a[200:203]
    ds_read_b64_tr_b16 v[112:113], v21 offset:18688
    v_mfma_f32_16x16x32_bf16 a[204:207], v[92:95], v[40:43], a[204:207]
    ds_read_b64_tr_b16 v[114:115], v21 offset:23296
    v_mfma_f32_16x16x32_bf16 a[208:211], v[96:99], v[28:31], a[208:211]
    v_mfma_f32_16x16x32_bf16 a[212:215], v[96:99], v[32:35], a[212:215]
    v_mfma_f32_16x16x32_bf16 a[216:219], v[96:99], v[36:39], a[216:219]
    v_mfma_f32_16x16x32_bf16 a[220:223], v[96:99], v[40:43], a[220:223]
    s_waitcnt lgkmcnt(4)
    v_mfma_f32_16x16x32_bf16 a[224:227], v[100:103], v[28:31], a[224:227]
    ds_read_b64_tr_b16 v[92:93], v21 offset:9216
    v_mfma_f32_16x16x32_bf16 a[228:231], v[100:103], v[32:35], a[228:231]
    ds_read_b64_tr_b16 v[94:95], v21 offset:13824
    v_mfma_f32_16x16x32_bf16 a[232:235], v[100:103], v[36:39], a[232:235]
    ds_read_b64_tr_b16 v[96:97], v21 offset:27648
    v_mfma_f32_16x16x32_bf16 a[236:239], v[100:103], v[40:43], a[236:239]
    ds_read_b64_tr_b16 v[98:99], v21 offset:32256
    v_mfma_f32_16x16x32_bf16 a[240:243], v[104:107], v[28:31], a[240:243]
    v_mfma_f32_16x16x32_bf16 a[244:247], v[104:107], v[32:35], a[244:247]
    v_mfma_f32_16x16x32_bf16 a[248:251], v[104:107], v[36:39], a[248:251]
    v_mfma_f32_16x16x32_bf16 a[252:255], v[104:107], v[40:43], a[252:255]
    s_waitcnt lgkmcnt(4)
    v_mfma_f32_16x16x32_bf16 v[116:119], v[108:111], v[28:31], v[116:119]
    ds_read_b64_tr_b16 v[100:101], v21 offset:9248
    v_mfma_f32_16x16x32_bf16 v[120:123], v[108:111], v[32:35], v[120:123]
    ds_read_b64_tr_b16 v[102:103], v21 offset:13856
    v_mfma_f32_16x16x32_bf16 v[124:127], v[108:111], v[36:39], v[124:127]
    ds_read_b64_tr_b16 v[104:105], v21 offset:27680
    v_mfma_f32_16x16x32_bf16 v[128:131], v[108:111], v[40:43], v[128:131]
    ds_read_b64_tr_b16 v[106:107], v21 offset:32288
    v_mfma_f32_16x16x32_bf16 v[132:135], v[112:115], v[28:31], v[132:135]
    v_mfma_f32_16x16x32_bf16 v[136:139], v[112:115], v[32:35], v[136:139]
    v_mfma_f32_16x16x32_bf16 v[140:143], v[112:115], v[36:39], v[140:143]
    v_mfma_f32_16x16x32_bf16 v[144:147], v[112:115], v[40:43], v[144:147]
    s_waitcnt vmcnt(0)
    s_waitcnt lgkmcnt(4)
    v_mfma_f32_16x16x32_bf16 a[0:3], v[92:95], v[44:47], a[0:3]
    ds_read_b64_tr_b16 v[108:109], v21 offset:9280
    v_mfma_f32_16x16x32_bf16 a[4:7], v[92:95], v[48:51], a[4:7]
    ds_read_b64_tr_b16 v[110:111], v21 offset:13888
    v_mfma_f32_16x16x32_bf16 a[8:11], v[92:95], v[52:55], a[8:11]
    ds_read_b64_tr_b16 v[112:113], v21 offset:27712
    v_mfma_f32_16x16x32_bf16 a[12:15], v[92:95], v[56:59], a[12:15]
    ds_read_b64_tr_b16 v[114:115], v21 offset:32320
    v_mfma_f32_16x16x32_bf16 a[16:19], v[96:99], v[44:47], a[16:19]
    v_mfma_f32_16x16x32_bf16 a[20:23], v[96:99], v[48:51], a[20:23]
    v_mfma_f32_16x16x32_bf16 a[24:27], v[96:99], v[52:55], a[24:27]
    v_mfma_f32_16x16x32_bf16 a[28:31], v[96:99], v[56:59], a[28:31]
    s_waitcnt lgkmcnt(4)
    v_mfma_f32_16x16x32_bf16 a[32:35], v[100:103], v[44:47], a[32:35]
    ds_read_b64_tr_b16 v[92:93], v21 offset:9312
    v_mfma_f32_16x16x32_bf16 a[36:39], v[100:103], v[48:51], a[36:39]
    ds_read_b64_tr_b16 v[94:95], v21 offset:13920
    v_mfma_f32_16x16x32_bf16 a[40:43], v[100:103], v[52:55], a[40:43]
    ds_read_b64_tr_b16 v[96:97], v21 offset:27744
    v_mfma_f32_16x16x32_bf16 a[44:47], v[100:103], v[56:59], a[44:47]
    ds_read_b64_tr_b16 v[98:99], v21 offset:32352
    v_mfma_f32_16x16x32_bf16 a[48:51], v[104:107], v[44:47], a[48:51]
    v_mfma_f32_16x16x32_bf16 a[52:55], v[104:107], v[48:51], a[52:55]
    v_mfma_f32_16x16x32_bf16 a[56:59], v[104:107], v[52:55], a[56:59]
    v_mfma_f32_16x16x32_bf16 a[60:63], v[104:107], v[56:59], a[60:63]
    s_waitcnt lgkmcnt(4)
    v_mfma_f32_16x16x32_bf16 a[64:67], v[108:111], v[44:47], a[64:67]
    ds_read_b64_tr_b16 v[100:101], v21 offset:9344
    v_mfma_f32_16x16x32_bf16 a[68:71], v[108:111], v[48:51], a[68:71]
    ds_read_b64_tr_b16 v[102:103], v21 offset:13952
    v_mfma_f32_16x16x32_bf16 a[72:75], v[108:111], v[52:55], a[72:75]
    ds_read_b64_tr_b16 v[104:105], v21 offset:27776
    v_mfma_f32_16x16x32_bf16 a[76:79], v[108:111], v[56:59], a[76:79]
    ds_read_b64_tr_b16 v[106:107], v21 offset:32384
    v_mfma_f32_16x16x32_bf16 a[80:83], v[112:115], v[44:47], a[80:83]
    v_mfma_f32_16x16x32_bf16 a[84:87], v[112:115], v[48:51], a[84:87]
    v_mfma_f32_16x16x32_bf16 a[88:91], v[112:115], v[52:55], a[88:91]
    v_mfma_f32_16x16x32_bf16 a[92:95], v[112:115], v[56:59], a[92:95]
    s_waitcnt lgkmcnt(4)
    v_mfma_f32_16x16x32_bf16 a[96:99], v[92:95], v[44:47], a[96:99]
    ds_read_b64_tr_b16 v[108:109], v21 offset:9376
    v_mfma_f32_16x16x32_bf16 a[100:103], v[92:95], v[48:51], a[100:103]
    ds_read_b64_tr_b16 v[110:111], v21 offset:13984
    v_mfma_f32_16x16x32_bf16 a[104:107], v[92:95], v[52:55], a[104:107]
    ds_read_b64_tr_b16 v[112:113], v21 offset:27808
    v_mfma_f32_16x16x32_bf16 a[108:111], v[92:95], v[56:59], a[108:111]
    ds_read_b64_tr_b16 v[114:115], v21 offset:32416
    v_mfma_f32_16x16x32_bf16 a[112:115], v[96:99], v[44:47], a[112:115]
    v_mfma_f32_16x16x32_bf16 a[116:119], v[96:99], v[48:51], a[116:119]
    v_mfma_f32_16x16x32_bf16 a[120:123], v[96:99], v[52:55], a[120:123]
    v_mfma_f32_16x16x32_bf16 a[124:127], v[96:99], v[56:59], a[124:127]
    s_waitcnt lgkmcnt(4)
    v_mfma_f32_16x16x32_bf16 a[128:131], v[100:103], v[44:47], a[128:131]
    ds_read_b64_tr_b16 v[92:93], v21 offset:9408
    v_mfma_f32_16x16x32_bf16 a[132:135], v[100:103], v[48:51], a[132:135]
    ds_read_b64_tr_b16 v[94:95], v21 offset:14016
    v_mfma_f32_16x16x32_bf16 a[136:139], v[100:103], v[52:55], a[136:139]
    ds_read_b64_tr_b16 v[96:97], v21 offset:27840
    v_mfma_f32_16x16x32_bf16 a[140:143], v[100:103], v[56:59], a[140:143]
    ds_read_b64_tr_b16 v[98:99], v21 offset:32448
    v_mfma_f32_16x16x32_bf16 a[144:147], v[104:107], v[44:47], a[144:147]
    v_mfma_f32_16x16x32_bf16 a[148:151], v[104:107], v[48:51], a[148:151]
    v_mfma_f32_16x16x32_bf16 a[152:155], v[104:107], v[52:55], a[152:155]
    v_mfma_f32_16x16x32_bf16 a[156:159], v[104:107], v[56:59], a[156:159]
    s_waitcnt lgkmcnt(4)
    v_mfma_f32_16x16x32_bf16 a[160:163], v[108:111], v[44:47], a[160:163]
    ds_read_b64_tr_b16 v[100:101], v21 offset:9440
    v_mfma_f32_16x16x32_bf16 a[164:167], v[108:111], v[48:51], a[164:167]
    ds_read_b64_tr_b16 v[102:103], v21 offset:14048
    v_mfma_f32_16x16x32_bf16 a[168:171], v[108:111], v[52:55], a[168:171]
    ds_read_b64_tr_b16 v[104:105], v21 offset:27872
    v_mfma_f32_16x16x32_bf16 a[172:175], v[108:111], v[56:59], a[172:175]
    ds_read_b64_tr_b16 v[106:107], v21 offset:32480
    v_mfma_f32_16x16x32_bf16 a[176:179], v[112:115], v[44:47], a[176:179]
    v_mfma_f32_16x16x32_bf16 a[180:183], v[112:115], v[48:51], a[180:183]
    v_mfma_f32_16x16x32_bf16 a[184:187], v[112:115], v[52:55], a[184:187]
    v_mfma_f32_16x16x32_bf16 a[188:191], v[112:115], v[56:59], a[188:191]
    s_waitcnt lgkmcnt(4)
    v_mfma_f32_16x16x32_bf16 a[192:195], v[92:95], v[44:47], a[192:195]
    ds_read_b64_tr_b16 v[108:109], v21 offset:9472
    v_mfma_f32_16x16x32_bf16 a[196:199], v[92:95], v[48:51], a[196:199]
    ds_read_b64_tr_b16 v[110:111], v21 offset:14080
    v_mfma_f32_16x16x32_bf16 a[200:203], v[92:95], v[52:55], a[200:203]
    ds_read_b64_tr_b16 v[112:113], v21 offset:27904
    v_mfma_f32_16x16x32_bf16 a[204:207], v[92:95], v[56:59], a[204:207]
    ds_read_b64_tr_b16 v[114:115], v21 offset:32512
    v_mfma_f32_16x16x32_bf16 a[208:211], v[96:99], v[44:47], a[208:211]
    v_mfma_f32_16x16x32_bf16 a[212:215], v[96:99], v[48:51], a[212:215]
    v_mfma_f32_16x16x32_bf16 a[216:219], v[96:99], v[52:55], a[216:219]
    v_mfma_f32_16x16x32_bf16 a[220:223], v[96:99], v[56:59], a[220:223]
    s_waitcnt lgkmcnt(4)
    v_mfma_f32_16x16x32_bf16 a[224:227], v[100:103], v[44:47], a[224:227]
    v_mfma_f32_16x16x32_bf16 a[228:231], v[100:103], v[48:51], a[228:231]
    v_mfma_f32_16x16x32_bf16 a[232:235], v[100:103], v[52:55], a[232:235]
    v_mfma_f32_16x16x32_bf16 a[236:239], v[100:103], v[56:59], a[236:239]
    v_mfma_f32_16x16x32_bf16 a[240:243], v[104:107], v[44:47], a[240:243]
    v_mfma_f32_16x16x32_bf16 a[244:247], v[104:107], v[48:51], a[244:247]
    v_mfma_f32_16x16x32_bf16 a[248:251], v[104:107], v[52:55], a[248:251]
    v_mfma_f32_16x16x32_bf16 a[252:255], v[104:107], v[56:59], a[252:255]
    s_waitcnt lgkmcnt(0)
    v_mfma_f32_16x16x32_bf16 v[116:119], v[108:111], v[44:47], v[116:119]
    v_mfma_f32_16x16x32_bf16 v[120:123], v[108:111], v[48:51], v[120:123]
    v_mfma_f32_16x16x32_bf16 v[124:127], v[108:111], v[52:55], v[124:127]
    v_mfma_f32_16x16x32_bf16 v[128:131], v[108:111], v[56:59], v[128:131]
    v_mfma_f32_16x16x32_bf16 v[132:135], v[112:115], v[44:47], v[132:135]
    v_mfma_f32_16x16x32_bf16 v[136:139], v[112:115], v[48:51], v[136:139]
    v_mfma_f32_16x16x32_bf16 v[140:143], v[112:115], v[52:55], v[140:143]
    v_mfma_f32_16x16x32_bf16 v[144:147], v[112:115], v[56:59], v[144:147]
    s_nop 7
    s_nop 7
    s_lshl_b32 s36, s15, 4
    s_lshl_b32 s37, s17, 2
    s_add_u32 s36, s36, s37
    s_mul_i32 s36, s36, 147456
    s_mul_i32 s37, s14, 9
    s_lshr_b32 s40, s37, 1
    s_lshl_b32 s40, s40, 10
    s_add_u32 s36, s36, s40
    v_lshlrev_b32 v3, 4, v2
    v_add_u32 v3, s36, v3
    s_and_b32 s37, s37, 1
    s_cmp_eq_u32 s37, 1
    s_cbranch_scc1 L_gemm1_kernel_odd
    v_accvgpr_read_b32 v148, a0
    v_accvgpr_read_b32 v149, a1
    v_accvgpr_read_b32 v150, a2
    v_accvgpr_read_b32 v151, a3
    v_accvgpr_read_b32 v152, a16
    v_accvgpr_read_b32 v153, a17
    v_accvgpr_read_b32 v154, a18
    v_accvgpr_read_b32 v155, a19
    v_cvt_pk_bf16_f32 v156, v148, v149
    v_cvt_pk_bf16_f32 v157, v150, v151
    v_cvt_pk_bf16_f32 v158, v152, v153
    v_cvt_pk_bf16_f32 v159, v154, v155
    v_lshlrev_b32 v148, 16, v156
    v_and_b32 v149, 0xffff0000, v156
    v_lshlrev_b32 v150, 16, v158
    v_and_b32 v151, 0xffff0000, v158
    v_pk_mul_f32 v[148:149], v[148:149], v[150:151]
    v_cvt_pk_bf16_f32 v164, v148, v149
    v_lshlrev_b32 v148, 16, v157
    v_and_b32 v149, 0xffff0000, v157
    v_lshlrev_b32 v150, 16, v159
    v_and_b32 v151, 0xffff0000, v159
    v_pk_mul_f32 v[148:149], v[148:149], v[150:151]
    v_cvt_pk_bf16_f32 v165, v148, v149
    s_mov_b32 s41, 0
    v_accvgpr_read_b32 v148, a32
    v_accvgpr_read_b32 v149, a33
    v_accvgpr_read_b32 v150, a34
    v_accvgpr_read_b32 v151, a35
    v_accvgpr_read_b32 v152, a48
    v_accvgpr_read_b32 v153, a49
    v_accvgpr_read_b32 v154, a50
    v_accvgpr_read_b32 v155, a51
    v_cvt_pk_bf16_f32 v156, v148, v149
    v_cvt_pk_bf16_f32 v157, v150, v151
    v_cvt_pk_bf16_f32 v158, v152, v153
    v_cvt_pk_bf16_f32 v159, v154, v155
    v_lshlrev_b32 v148, 16, v156
    v_and_b32 v149, 0xffff0000, v156
    v_lshlrev_b32 v150, 16, v158
    v_and_b32 v151, 0xffff0000, v158
    v_pk_mul_f32 v[148:149], v[148:149], v[150:151]
    v_cvt_pk_bf16_f32 v166, v148, v149
    v_lshlrev_b32 v148, 16, v157
    v_and_b32 v149, 0xffff0000, v157
    v_lshlrev_b32 v150, 16, v159
    v_and_b32 v151, 0xffff0000, v159
    v_pk_mul_f32 v[148:149], v[148:149], v[150:151]
    v_cvt_pk_bf16_f32 v167, v148, v149
    s_mov_b32 s41, 0
    buffer_store_dwordx4 v[164:167], v3, s[28:31], s41 offen sc1
    v_accvgpr_read_b32 v148, a64
    v_accvgpr_read_b32 v149, a65
    v_accvgpr_read_b32 v150, a66
    v_accvgpr_read_b32 v151, a67
    v_accvgpr_read_b32 v152, a80
    v_accvgpr_read_b32 v153, a81
    v_accvgpr_read_b32 v154, a82
    v_accvgpr_read_b32 v155, a83
    v_cvt_pk_bf16_f32 v156, v148, v149
    v_cvt_pk_bf16_f32 v157, v150, v151
    v_cvt_pk_bf16_f32 v158, v152, v153
    v_cvt_pk_bf16_f32 v159, v154, v155
    v_lshlrev_b32 v148, 16, v156
    v_and_b32 v149, 0xffff0000, v156
    v_lshlrev_b32 v150, 16, v158
    v_and_b32 v151, 0xffff0000, v158
    v_pk_mul_f32 v[148:149], v[148:149], v[150:151]
    v_cvt_pk_bf16_f32 v168, v148, v149
    v_lshlrev_b32 v148, 16, v157
    v_and_b32 v149, 0xffff0000, v157
    v_lshlrev_b32 v150, 16, v159
    v_and_b32 v151, 0xffff0000, v159
    v_pk_mul_f32 v[148:149], v[148:149], v[150:151]
    v_cvt_pk_bf16_f32 v169, v148, v149
    s_mov_b32 s41, 1024
    v_accvgpr_read_b32 v148, a96
    v_accvgpr_read_b32 v149, a97
    v_accvgpr_read_b32 v150, a98
    v_accvgpr_read_b32 v151, a99
    v_accvgpr_read_b32 v152, a112
    v_accvgpr_read_b32 v153, a113
    v_accvgpr_read_b32 v154, a114
    v_accvgpr_read_b32 v155, a115
    v_cvt_pk_bf16_f32 v156, v148, v149
    v_cvt_pk_bf16_f32 v157, v150, v151
    v_cvt_pk_bf16_f32 v158, v152, v153
    v_cvt_pk_bf16_f32 v159, v154, v155
    v_lshlrev_b32 v148, 16, v156
    v_and_b32 v149, 0xffff0000, v156
    v_lshlrev_b32 v150, 16, v158
    v_and_b32 v151, 0xffff0000, v158
    v_pk_mul_f32 v[148:149], v[148:149], v[150:151]
    v_cvt_pk_bf16_f32 v170, v148, v149
    v_lshlrev_b32 v148, 16, v157
    v_and_b32 v149, 0xffff0000, v157
    v_lshlrev_b32 v150, 16, v159
    v_and_b32 v151, 0xffff0000, v159
    v_pk_mul_f32 v[148:149], v[148:149], v[150:151]
    v_cvt_pk_bf16_f32 v171, v148, v149
    s_mov_b32 s41, 1024
    buffer_store_dwordx4 v[168:171], v3, s[28:31], s41 offen sc1
    v_accvgpr_read_b32 v148, a128
    v_accvgpr_read_b32 v149, a129
    v_accvgpr_read_b32 v150, a130
    v_accvgpr_read_b32 v151, a131
    v_accvgpr_read_b32 v152, a144
    v_accvgpr_read_b32 v153, a145
    v_accvgpr_read_b32 v154, a146
    v_accvgpr_read_b32 v155, a147
    v_cvt_pk_bf16_f32 v156, v148, v149
    v_cvt_pk_bf16_f32 v157, v150, v151
    v_cvt_pk_bf16_f32 v158, v152, v153
    v_cvt_pk_bf16_f32 v159, v154, v155
    v_lshlrev_b32 v148, 16, v156
    v_and_b32 v149, 0xffff0000, v156
    v_lshlrev_b32 v150, 16, v158
    v_and_b32 v151, 0xffff0000, v158
    v_pk_mul_f32 v[148:149], v[148:149], v[150:151]
    v_cvt_pk_bf16_f32 v164, v148, v149
    v_lshlrev_b32 v148, 16, v157
    v_and_b32 v149, 0xffff0000, v157
    v_lshlrev_b32 v150, 16, v159
    v_and_b32 v151, 0xffff0000, v159
    v_pk_mul_f32 v[148:149], v[148:149], v[150:151]
    v_cvt_pk_bf16_f32 v165, v148, v149
    s_mov_b32 s41, 2048
    v_accvgpr_read_b32 v148, a160
    v_accvgpr_read_b32 v149, a161
    v_accvgpr_read_b32 v150, a162
    v_accvgpr_read_b32 v151, a163
    v_accvgpr_read_b32 v152, a176
    v_accvgpr_read_b32 v153, a177
    v_accvgpr_read_b32 v154, a178
    v_accvgpr_read_b32 v155, a179
    v_cvt_pk_bf16_f32 v156, v148, v149
    v_cvt_pk_bf16_f32 v157, v150, v151
    v_cvt_pk_bf16_f32 v158, v152, v153
    v_cvt_pk_bf16_f32 v159, v154, v155
    v_lshlrev_b32 v148, 16, v156
    v_and_b32 v149, 0xffff0000, v156
    v_lshlrev_b32 v150, 16, v158
    v_and_b32 v151, 0xffff0000, v158
    v_pk_mul_f32 v[148:149], v[148:149], v[150:151]
    v_cvt_pk_bf16_f32 v166, v148, v149
    v_lshlrev_b32 v148, 16, v157
    v_and_b32 v149, 0xffff0000, v157
    v_lshlrev_b32 v150, 16, v159
    v_and_b32 v151, 0xffff0000, v159
    v_pk_mul_f32 v[148:149], v[148:149], v[150:151]
    v_cvt_pk_bf16_f32 v167, v148, v149
    s_mov_b32 s41, 2048
    buffer_store_dwordx4 v[164:167], v3, s[28:31], s41 offen sc1
    v_accvgpr_read_b32 v148, a192
    v_accvgpr_read_b32 v149, a193
    v_accvgpr_read_b32 v150, a194
    v_accvgpr_read_b32 v151, a195
    v_accvgpr_read_b32 v152, a208
    v_accvgpr_read_b32 v153, a209
    v_accvgpr_read_b32 v154, a210
    v_accvgpr_read_b32 v155, a211
    v_cvt_pk_bf16_f32 v156, v148, v149
    v_cvt_pk_bf16_f32 v157, v150, v151
    v_cvt_pk_bf16_f32 v158, v152, v153
    v_cvt_pk_bf16_f32 v159, v154, v155
    v_lshlrev_b32 v148, 16, v156
    v_and_b32 v149, 0xffff0000, v156
    v_lshlrev_b32 v150, 16, v158
    v_and_b32 v151, 0xffff0000, v158
    v_pk_mul_f32 v[148:149], v[148:149], v[150:151]
    v_cvt_pk_bf16_f32 v168, v148, v149
    v_lshlrev_b32 v148, 16, v157
    v_and_b32 v149, 0xffff0000, v157
    v_lshlrev_b32 v150, 16, v159
    v_and_b32 v151, 0xffff0000, v159
    v_pk_mul_f32 v[148:149], v[148:149], v[150:151]
    v_cvt_pk_bf16_f32 v169, v148, v149
    s_mov_b32 s41, 3072
    v_accvgpr_read_b32 v148, a224
    v_accvgpr_read_b32 v149, a225
    v_accvgpr_read_b32 v150, a226
    v_accvgpr_read_b32 v151, a227
    v_accvgpr_read_b32 v152, a240
    v_accvgpr_read_b32 v153, a241
    v_accvgpr_read_b32 v154, a242
    v_accvgpr_read_b32 v155, a243
    v_cvt_pk_bf16_f32 v156, v148, v149
    v_cvt_pk_bf16_f32 v157, v150, v151
    v_cvt_pk_bf16_f32 v158, v152, v153
    v_cvt_pk_bf16_f32 v159, v154, v155
    v_lshlrev_b32 v148, 16, v156
    v_and_b32 v149, 0xffff0000, v156
    v_lshlrev_b32 v150, 16, v158
    v_and_b32 v151, 0xffff0000, v158
    v_pk_mul_f32 v[148:149], v[148:149], v[150:151]
    v_cvt_pk_bf16_f32 v170, v148, v149
    v_lshlrev_b32 v148, 16, v157
    v_and_b32 v149, 0xffff0000, v157
    v_lshlrev_b32 v150, 16, v159
    v_and_b32 v151, 0xffff0000, v159
    v_pk_mul_f32 v[148:149], v[148:149], v[150:151]
    v_cvt_pk_bf16_f32 v171, v148, v149
    s_mov_b32 s41, 3072
    buffer_store_dwordx4 v[168:171], v3, s[28:31], s41 offen sc1
    v_cvt_pk_bf16_f32 v156, v116, v117
    v_cvt_pk_bf16_f32 v157, v118, v119
    v_cvt_pk_bf16_f32 v158, v132, v133
    v_cvt_pk_bf16_f32 v159, v134, v135
    v_lshlrev_b32 v148, 16, v156
    v_and_b32 v149, 0xffff0000, v156
    v_lshlrev_b32 v150, 16, v158
    v_and_b32 v151, 0xffff0000, v158
    v_pk_mul_f32 v[148:149], v[148:149], v[150:151]
    v_cvt_pk_bf16_f32 v164, v148, v149
    v_lshlrev_b32 v148, 16, v157
    v_and_b32 v149, 0xffff0000, v157
    v_lshlrev_b32 v150, 16, v159
    v_and_b32 v151, 0xffff0000, v159
    v_pk_mul_f32 v[148:149], v[148:149], v[150:151]
    v_cvt_pk_bf16_f32 v165, v148, v149
    s_mov_b32 s41, 4096
    buffer_store_dwordx2 v[164:165], v3, s[28:31], s41 offen sc1
    v_accvgpr_read_b32 v148, a4
    v_accvgpr_read_b32 v149, a5
    v_accvgpr_read_b32 v150, a6
    v_accvgpr_read_b32 v151, a7
    v_accvgpr_read_b32 v152, a20
    v_accvgpr_read_b32 v153, a21
    v_accvgpr_read_b32 v154, a22
    v_accvgpr_read_b32 v155, a23
    v_cvt_pk_bf16_f32 v156, v148, v149
    v_cvt_pk_bf16_f32 v157, v150, v151
    v_cvt_pk_bf16_f32 v158, v152, v153
    v_cvt_pk_bf16_f32 v159, v154, v155
    v_lshlrev_b32 v148, 16, v156
    v_and_b32 v149, 0xffff0000, v156
    v_lshlrev_b32 v150, 16, v158
    v_and_b32 v151, 0xffff0000, v158
    v_pk_mul_f32 v[148:149], v[148:149], v[150:151]
    v_cvt_pk_bf16_f32 v168, v148, v149
    v_lshlrev_b32 v148, 16, v157
    v_and_b32 v149, 0xffff0000, v157
    v_lshlrev_b32 v150, 16, v159
    v_and_b32 v151, 0xffff0000, v159
    v_pk_mul_f32 v[148:149], v[148:149], v[150:151]
    v_cvt_pk_bf16_f32 v169, v148, v149
    s_mov_b32 s41, 147456
    v_accvgpr_read_b32 v148, a36
    v_accvgpr_read_b32 v149, a37
    v_accvgpr_read_b32 v150, a38
    v_accvgpr_read_b32 v151, a39
    v_accvgpr_read_b32 v152, a52
    v_accvgpr_read_b32 v153, a53
    v_accvgpr_read_b32 v154, a54
    v_accvgpr_read_b32 v155, a55
    v_cvt_pk_bf16_f32 v156, v148, v149
    v_cvt_pk_bf16_f32 v157, v150, v151
    v_cvt_pk_bf16_f32 v158, v152, v153
    v_cvt_pk_bf16_f32 v159, v154, v155
    v_lshlrev_b32 v148, 16, v156
    v_and_b32 v149, 0xffff0000, v156
    v_lshlrev_b32 v150, 16, v158
    v_and_b32 v151, 0xffff0000, v158
    v_pk_mul_f32 v[148:149], v[148:149], v[150:151]
    v_cvt_pk_bf16_f32 v170, v148, v149
    v_lshlrev_b32 v148, 16, v157
    v_and_b32 v149, 0xffff0000, v157
    v_lshlrev_b32 v150, 16, v159
    v_and_b32 v151, 0xffff0000, v159
    v_pk_mul_f32 v[148:149], v[148:149], v[150:151]
    v_cvt_pk_bf16_f32 v171, v148, v149
    s_mov_b32 s41, 147456
    buffer_store_dwordx4 v[168:171], v3, s[28:31], s41 offen sc1
    v_accvgpr_read_b32 v148, a68
    v_accvgpr_read_b32 v149, a69
    v_accvgpr_read_b32 v150, a70
    v_accvgpr_read_b32 v151, a71
    v_accvgpr_read_b32 v152, a84
    v_accvgpr_read_b32 v153, a85
    v_accvgpr_read_b32 v154, a86
    v_accvgpr_read_b32 v155, a87
    v_cvt_pk_bf16_f32 v156, v148, v149
    v_cvt_pk_bf16_f32 v157, v150, v151
    v_cvt_pk_bf16_f32 v158, v152, v153
    v_cvt_pk_bf16_f32 v159, v154, v155
    v_lshlrev_b32 v148, 16, v156
    v_and_b32 v149, 0xffff0000, v156
    v_lshlrev_b32 v150, 16, v158
    v_and_b32 v151, 0xffff0000, v158
    v_pk_mul_f32 v[148:149], v[148:149], v[150:151]
    v_cvt_pk_bf16_f32 v164, v148, v149
    v_lshlrev_b32 v148, 16, v157
    v_and_b32 v149, 0xffff0000, v157
    v_lshlrev_b32 v150, 16, v159
    v_and_b32 v151, 0xffff0000, v159
    v_pk_mul_f32 v[148:149], v[148:149], v[150:151]
    v_cvt_pk_bf16_f32 v165, v148, v149
    s_mov_b32 s41, 148480
    v_accvgpr_read_b32 v148, a100
    v_accvgpr_read_b32 v149, a101
    v_accvgpr_read_b32 v150, a102
    v_accvgpr_read_b32 v151, a103
    v_accvgpr_read_b32 v152, a116
    v_accvgpr_read_b32 v153, a117
    v_accvgpr_read_b32 v154, a118
    v_accvgpr_read_b32 v155, a119
    v_cvt_pk_bf16_f32 v156, v148, v149
    v_cvt_pk_bf16_f32 v157, v150, v151
    v_cvt_pk_bf16_f32 v158, v152, v153
    v_cvt_pk_bf16_f32 v159, v154, v155
    v_lshlrev_b32 v148, 16, v156
    v_and_b32 v149, 0xffff0000, v156
    v_lshlrev_b32 v150, 16, v158
    v_and_b32 v151, 0xffff0000, v158
    v_pk_mul_f32 v[148:149], v[148:149], v[150:151]
    v_cvt_pk_bf16_f32 v166, v148, v149
    v_lshlrev_b32 v148, 16, v157
    v_and_b32 v149, 0xffff0000, v157
    v_lshlrev_b32 v150, 16, v159
    v_and_b32 v151, 0xffff0000, v159
    v_pk_mul_f32 v[148:149], v[148:149], v[150:151]
    v_cvt_pk_bf16_f32 v167, v148, v149
    s_mov_b32 s41, 148480
    buffer_store_dwordx4 v[164:167], v3, s[28:31], s41 offen sc1
    v_accvgpr_read_b32 v148, a132
    v_accvgpr_read_b32 v149, a133
    v_accvgpr_read_b32 v150, a134
    v_accvgpr_read_b32 v151, a135
    v_accvgpr_read_b32 v152, a148
    v_accvgpr_read_b32 v153, a149
    v_accvgpr_read_b32 v154, a150
    v_accvgpr_read_b32 v155, a151
    v_cvt_pk_bf16_f32 v156, v148, v149
    v_cvt_pk_bf16_f32 v157, v150, v151
    v_cvt_pk_bf16_f32 v158, v152, v153
    v_cvt_pk_bf16_f32 v159, v154, v155
    v_lshlrev_b32 v148, 16, v156
    v_and_b32 v149, 0xffff0000, v156
    v_lshlrev_b32 v150, 16, v158
    v_and_b32 v151, 0xffff0000, v158
    v_pk_mul_f32 v[148:149], v[148:149], v[150:151]
    v_cvt_pk_bf16_f32 v168, v148, v149
    v_lshlrev_b32 v148, 16, v157
    v_and_b32 v149, 0xffff0000, v157
    v_lshlrev_b32 v150, 16, v159
    v_and_b32 v151, 0xffff0000, v159
    v_pk_mul_f32 v[148:149], v[148:149], v[150:151]
    v_cvt_pk_bf16_f32 v169, v148, v149
    s_mov_b32 s41, 149504
    v_accvgpr_read_b32 v148, a164
    v_accvgpr_read_b32 v149, a165
    v_accvgpr_read_b32 v150, a166
    v_accvgpr_read_b32 v151, a167
    v_accvgpr_read_b32 v152, a180
    v_accvgpr_read_b32 v153, a181
    v_accvgpr_read_b32 v154, a182
    v_accvgpr_read_b32 v155, a183
    v_cvt_pk_bf16_f32 v156, v148, v149
    v_cvt_pk_bf16_f32 v157, v150, v151
    v_cvt_pk_bf16_f32 v158, v152, v153
    v_cvt_pk_bf16_f32 v159, v154, v155
    v_lshlrev_b32 v148, 16, v156
    v_and_b32 v149, 0xffff0000, v156
    v_lshlrev_b32 v150, 16, v158
    v_and_b32 v151, 0xffff0000, v158
    v_pk_mul_f32 v[148:149], v[148:149], v[150:151]
    v_cvt_pk_bf16_f32 v170, v148, v149
    v_lshlrev_b32 v148, 16, v157
    v_and_b32 v149, 0xffff0000, v157
    v_lshlrev_b32 v150, 16, v159
    v_and_b32 v151, 0xffff0000, v159
    v_pk_mul_f32 v[148:149], v[148:149], v[150:151]
    v_cvt_pk_bf16_f32 v171, v148, v149
    s_mov_b32 s41, 149504
    buffer_store_dwordx4 v[168:171], v3, s[28:31], s41 offen sc1
    v_accvgpr_read_b32 v148, a196
    v_accvgpr_read_b32 v149, a197
    v_accvgpr_read_b32 v150, a198
    v_accvgpr_read_b32 v151, a199
    v_accvgpr_read_b32 v152, a212
    v_accvgpr_read_b32 v153, a213
    v_accvgpr_read_b32 v154, a214
    v_accvgpr_read_b32 v155, a215
    v_cvt_pk_bf16_f32 v156, v148, v149
    v_cvt_pk_bf16_f32 v157, v150, v151
    v_cvt_pk_bf16_f32 v158, v152, v153
    v_cvt_pk_bf16_f32 v159, v154, v155
    v_lshlrev_b32 v148, 16, v156
    v_and_b32 v149, 0xffff0000, v156
    v_lshlrev_b32 v150, 16, v158
    v_and_b32 v151, 0xffff0000, v158
    v_pk_mul_f32 v[148:149], v[148:149], v[150:151]
    v_cvt_pk_bf16_f32 v164, v148, v149
    v_lshlrev_b32 v148, 16, v157
    v_and_b32 v149, 0xffff0000, v157
    v_lshlrev_b32 v150, 16, v159
    v_and_b32 v151, 0xffff0000, v159
    v_pk_mul_f32 v[148:149], v[148:149], v[150:151]
    v_cvt_pk_bf16_f32 v165, v148, v149
    s_mov_b32 s41, 150528
    v_accvgpr_read_b32 v148, a228
    v_accvgpr_read_b32 v149, a229
    v_accvgpr_read_b32 v150, a230
    v_accvgpr_read_b32 v151, a231
    v_accvgpr_read_b32 v152, a244
    v_accvgpr_read_b32 v153, a245
    v_accvgpr_read_b32 v154, a246
    v_accvgpr_read_b32 v155, a247
    v_cvt_pk_bf16_f32 v156, v148, v149
    v_cvt_pk_bf16_f32 v157, v150, v151
    v_cvt_pk_bf16_f32 v158, v152, v153
    v_cvt_pk_bf16_f32 v159, v154, v155
    v_lshlrev_b32 v148, 16, v156
    v_and_b32 v149, 0xffff0000, v156
    v_lshlrev_b32 v150, 16, v158
    v_and_b32 v151, 0xffff0000, v158
    v_pk_mul_f32 v[148:149], v[148:149], v[150:151]
    v_cvt_pk_bf16_f32 v166, v148, v149
    v_lshlrev_b32 v148, 16, v157
    v_and_b32 v149, 0xffff0000, v157
    v_lshlrev_b32 v150, 16, v159
    v_and_b32 v151, 0xffff0000, v159
    v_pk_mul_f32 v[148:149], v[148:149], v[150:151]
    v_cvt_pk_bf16_f32 v167, v148, v149
    s_mov_b32 s41, 150528
    buffer_store_dwordx4 v[164:167], v3, s[28:31], s41 offen sc1
    v_cvt_pk_bf16_f32 v156, v120, v121
    v_cvt_pk_bf16_f32 v157, v122, v123
    v_cvt_pk_bf16_f32 v158, v136, v137
    v_cvt_pk_bf16_f32 v159, v138, v139
    v_lshlrev_b32 v148, 16, v156
    v_and_b32 v149, 0xffff0000, v156
    v_lshlrev_b32 v150, 16, v158
    v_and_b32 v151, 0xffff0000, v158
    v_pk_mul_f32 v[148:149], v[148:149], v[150:151]
    v_cvt_pk_bf16_f32 v168, v148, v149
    v_lshlrev_b32 v148, 16, v157
    v_and_b32 v149, 0xffff0000, v157
    v_lshlrev_b32 v150, 16, v159
    v_and_b32 v151, 0xffff0000, v159
    v_pk_mul_f32 v[148:149], v[148:149], v[150:151]
    v_cvt_pk_bf16_f32 v169, v148, v149
    s_mov_b32 s41, 151552
    buffer_store_dwordx2 v[168:169], v3, s[28:31], s41 offen sc1
    v_accvgpr_read_b32 v148, a8
    v_accvgpr_read_b32 v149, a9
    v_accvgpr_read_b32 v150, a10
    v_accvgpr_read_b32 v151, a11
    v_accvgpr_read_b32 v152, a24
    v_accvgpr_read_b32 v153, a25
    v_accvgpr_read_b32 v154, a26
    v_accvgpr_read_b32 v155, a27
    v_cvt_pk_bf16_f32 v156, v148, v149
    v_cvt_pk_bf16_f32 v157, v150, v151
    v_cvt_pk_bf16_f32 v158, v152, v153
    v_cvt_pk_bf16_f32 v159, v154, v155
    v_lshlrev_b32 v148, 16, v156
    v_and_b32 v149, 0xffff0000, v156
    v_lshlrev_b32 v150, 16, v158
    v_and_b32 v151, 0xffff0000, v158
    v_pk_mul_f32 v[148:149], v[148:149], v[150:151]
    v_cvt_pk_bf16_f32 v164, v148, v149
    v_lshlrev_b32 v148, 16, v157
    v_and_b32 v149, 0xffff0000, v157
    v_lshlrev_b32 v150, 16, v159
    v_and_b32 v151, 0xffff0000, v159
    v_pk_mul_f32 v[148:149], v[148:149], v[150:151]
    v_cvt_pk_bf16_f32 v165, v148, v149
    s_mov_b32 s41, 294912
    v_accvgpr_read_b32 v148, a40
    v_accvgpr_read_b32 v149, a41
    v_accvgpr_read_b32 v150, a42
    v_accvgpr_read_b32 v151, a43
    v_accvgpr_read_b32 v152, a56
    v_accvgpr_read_b32 v153, a57
    v_accvgpr_read_b32 v154, a58
    v_accvgpr_read_b32 v155, a59
    v_cvt_pk_bf16_f32 v156, v148, v149
    v_cvt_pk_bf16_f32 v157, v150, v151
    v_cvt_pk_bf16_f32 v158, v152, v153
    v_cvt_pk_bf16_f32 v159, v154, v155
    v_lshlrev_b32 v148, 16, v156
    v_and_b32 v149, 0xffff0000, v156
    v_lshlrev_b32 v150, 16, v158
    v_and_b32 v151, 0xffff0000, v158
    v_pk_mul_f32 v[148:149], v[148:149], v[150:151]
    v_cvt_pk_bf16_f32 v166, v148, v149
    v_lshlrev_b32 v148, 16, v157
    v_and_b32 v149, 0xffff0000, v157
    v_lshlrev_b32 v150, 16, v159
    v_and_b32 v151, 0xffff0000, v159
    v_pk_mul_f32 v[148:149], v[148:149], v[150:151]
    v_cvt_pk_bf16_f32 v167, v148, v149
    s_mov_b32 s41, 294912
    buffer_store_dwordx4 v[164:167], v3, s[28:31], s41 offen sc1
    v_accvgpr_read_b32 v148, a72
    v_accvgpr_read_b32 v149, a73
    v_accvgpr_read_b32 v150, a74
    v_accvgpr_read_b32 v151, a75
    v_accvgpr_read_b32 v152, a88
    v_accvgpr_read_b32 v153, a89
    v_accvgpr_read_b32 v154, a90
    v_accvgpr_read_b32 v155, a91
    v_cvt_pk_bf16_f32 v156, v148, v149
    v_cvt_pk_bf16_f32 v157, v150, v151
    v_cvt_pk_bf16_f32 v158, v152, v153
    v_cvt_pk_bf16_f32 v159, v154, v155
    v_lshlrev_b32 v148, 16, v156
    v_and_b32 v149, 0xffff0000, v156
    v_lshlrev_b32 v150, 16, v158
    v_and_b32 v151, 0xffff0000, v158
    v_pk_mul_f32 v[148:149], v[148:149], v[150:151]
    v_cvt_pk_bf16_f32 v168, v148, v149
    v_lshlrev_b32 v148, 16, v157
    v_and_b32 v149, 0xffff0000, v157
    v_lshlrev_b32 v150, 16, v159
    v_and_b32 v151, 0xffff0000, v159
    v_pk_mul_f32 v[148:149], v[148:149], v[150:151]
    v_cvt_pk_bf16_f32 v169, v148, v149
    s_mov_b32 s41, 295936
    v_accvgpr_read_b32 v148, a104
    v_accvgpr_read_b32 v149, a105
    v_accvgpr_read_b32 v150, a106
    v_accvgpr_read_b32 v151, a107
    v_accvgpr_read_b32 v152, a120
    v_accvgpr_read_b32 v153, a121
    v_accvgpr_read_b32 v154, a122
    v_accvgpr_read_b32 v155, a123
    v_cvt_pk_bf16_f32 v156, v148, v149
    v_cvt_pk_bf16_f32 v157, v150, v151
    v_cvt_pk_bf16_f32 v158, v152, v153
    v_cvt_pk_bf16_f32 v159, v154, v155
    v_lshlrev_b32 v148, 16, v156
    v_and_b32 v149, 0xffff0000, v156
    v_lshlrev_b32 v150, 16, v158
    v_and_b32 v151, 0xffff0000, v158
    v_pk_mul_f32 v[148:149], v[148:149], v[150:151]
    v_cvt_pk_bf16_f32 v170, v148, v149
    v_lshlrev_b32 v148, 16, v157
    v_and_b32 v149, 0xffff0000, v157
    v_lshlrev_b32 v150, 16, v159
    v_and_b32 v151, 0xffff0000, v159
    v_pk_mul_f32 v[148:149], v[148:149], v[150:151]
    v_cvt_pk_bf16_f32 v171, v148, v149
    s_mov_b32 s41, 295936
    buffer_store_dwordx4 v[168:171], v3, s[28:31], s41 offen sc1
    v_accvgpr_read_b32 v148, a136
    v_accvgpr_read_b32 v149, a137
    v_accvgpr_read_b32 v150, a138
    v_accvgpr_read_b32 v151, a139
    v_accvgpr_read_b32 v152, a152
    v_accvgpr_read_b32 v153, a153
    v_accvgpr_read_b32 v154, a154
    v_accvgpr_read_b32 v155, a155
    v_cvt_pk_bf16_f32 v156, v148, v149
    v_cvt_pk_bf16_f32 v157, v150, v151
    v_cvt_pk_bf16_f32 v158, v152, v153
    v_cvt_pk_bf16_f32 v159, v154, v155
    v_lshlrev_b32 v148, 16, v156
    v_and_b32 v149, 0xffff0000, v156
    v_lshlrev_b32 v150, 16, v158
    v_and_b32 v151, 0xffff0000, v158
    v_pk_mul_f32 v[148:149], v[148:149], v[150:151]
    v_cvt_pk_bf16_f32 v164, v148, v149
    v_lshlrev_b32 v148, 16, v157
    v_and_b32 v149, 0xffff0000, v157
    v_lshlrev_b32 v150, 16, v159
    v_and_b32 v151, 0xffff0000, v159
    v_pk_mul_f32 v[148:149], v[148:149], v[150:151]
    v_cvt_pk_bf16_f32 v165, v148, v149
    s_mov_b32 s41, 296960
    v_accvgpr_read_b32 v148, a168
    v_accvgpr_read_b32 v149, a169
    v_accvgpr_read_b32 v150, a170
    v_accvgpr_read_b32 v151, a171
    v_accvgpr_read_b32 v152, a184
    v_accvgpr_read_b32 v153, a185
    v_accvgpr_read_b32 v154, a186
    v_accvgpr_read_b32 v155, a187
    v_cvt_pk_bf16_f32 v156, v148, v149
    v_cvt_pk_bf16_f32 v157, v150, v151
    v_cvt_pk_bf16_f32 v158, v152, v153
    v_cvt_pk_bf16_f32 v159, v154, v155
    v_lshlrev_b32 v148, 16, v156
    v_and_b32 v149, 0xffff0000, v156
    v_lshlrev_b32 v150, 16, v158
    v_and_b32 v151, 0xffff0000, v158
    v_pk_mul_f32 v[148:149], v[148:149], v[150:151]
    v_cvt_pk_bf16_f32 v166, v148, v149
    v_lshlrev_b32 v148, 16, v157
    v_and_b32 v149, 0xffff0000, v157
    v_lshlrev_b32 v150, 16, v159
    v_and_b32 v151, 0xffff0000, v159
    v_pk_mul_f32 v[148:149], v[148:149], v[150:151]
    v_cvt_pk_bf16_f32 v167, v148, v149
    s_mov_b32 s41, 296960
    buffer_store_dwordx4 v[164:167], v3, s[28:31], s41 offen sc1
    v_accvgpr_read_b32 v148, a200
    v_accvgpr_read_b32 v149, a201
    v_accvgpr_read_b32 v150, a202
    v_accvgpr_read_b32 v151, a203
    v_accvgpr_read_b32 v152, a216
    v_accvgpr_read_b32 v153, a217
    v_accvgpr_read_b32 v154, a218
    v_accvgpr_read_b32 v155, a219
    v_cvt_pk_bf16_f32 v156, v148, v149
    v_cvt_pk_bf16_f32 v157, v150, v151
    v_cvt_pk_bf16_f32 v158, v152, v153
    v_cvt_pk_bf16_f32 v159, v154, v155
    v_lshlrev_b32 v148, 16, v156
    v_and_b32 v149, 0xffff0000, v156
    v_lshlrev_b32 v150, 16, v158
    v_and_b32 v151, 0xffff0000, v158
    v_pk_mul_f32 v[148:149], v[148:149], v[150:151]
    v_cvt_pk_bf16_f32 v168, v148, v149
    v_lshlrev_b32 v148, 16, v157
    v_and_b32 v149, 0xffff0000, v157
    v_lshlrev_b32 v150, 16, v159
    v_and_b32 v151, 0xffff0000, v159
    v_pk_mul_f32 v[148:149], v[148:149], v[150:151]
    v_cvt_pk_bf16_f32 v169, v148, v149
    s_mov_b32 s41, 297984
    v_accvgpr_read_b32 v148, a232
    v_accvgpr_read_b32 v149, a233
    v_accvgpr_read_b32 v150, a234
    v_accvgpr_read_b32 v151, a235
    v_accvgpr_read_b32 v152, a248
    v_accvgpr_read_b32 v153, a249
    v_accvgpr_read_b32 v154, a250
    v_accvgpr_read_b32 v155, a251
    v_cvt_pk_bf16_f32 v156, v148, v149
    v_cvt_pk_bf16_f32 v157, v150, v151
    v_cvt_pk_bf16_f32 v158, v152, v153
    v_cvt_pk_bf16_f32 v159, v154, v155
    v_lshlrev_b32 v148, 16, v156
    v_and_b32 v149, 0xffff0000, v156
    v_lshlrev_b32 v150, 16, v158
    v_and_b32 v151, 0xffff0000, v158
    v_pk_mul_f32 v[148:149], v[148:149], v[150:151]
    v_cvt_pk_bf16_f32 v170, v148, v149
    v_lshlrev_b32 v148, 16, v157
    v_and_b32 v149, 0xffff0000, v157
    v_lshlrev_b32 v150, 16, v159
    v_and_b32 v151, 0xffff0000, v159
    v_pk_mul_f32 v[148:149], v[148:149], v[150:151]
    v_cvt_pk_bf16_f32 v171, v148, v149
    s_mov_b32 s41, 297984
    buffer_store_dwordx4 v[168:171], v3, s[28:31], s41 offen sc1
    v_cvt_pk_bf16_f32 v156, v124, v125
    v_cvt_pk_bf16_f32 v157, v126, v127
    v_cvt_pk_bf16_f32 v158, v140, v141
    v_cvt_pk_bf16_f32 v159, v142, v143
    v_lshlrev_b32 v148, 16, v156
    v_and_b32 v149, 0xffff0000, v156
    v_lshlrev_b32 v150, 16, v158
    v_and_b32 v151, 0xffff0000, v158
    v_pk_mul_f32 v[148:149], v[148:149], v[150:151]
    v_cvt_pk_bf16_f32 v164, v148, v149
    v_lshlrev_b32 v148, 16, v157
    v_and_b32 v149, 0xffff0000, v157
    v_lshlrev_b32 v150, 16, v159
    v_and_b32 v151, 0xffff0000, v159
    v_pk_mul_f32 v[148:149], v[148:149], v[150:151]
    v_cvt_pk_bf16_f32 v165, v148, v149
    s_mov_b32 s41, 299008
    buffer_store_dwordx2 v[164:165], v3, s[28:31], s41 offen sc1
    v_accvgpr_read_b32 v148, a12
    v_accvgpr_read_b32 v149, a13
    v_accvgpr_read_b32 v150, a14
    v_accvgpr_read_b32 v151, a15
    v_accvgpr_read_b32 v152, a28
    v_accvgpr_read_b32 v153, a29
    v_accvgpr_read_b32 v154, a30
    v_accvgpr_read_b32 v155, a31
    v_cvt_pk_bf16_f32 v156, v148, v149
    v_cvt_pk_bf16_f32 v157, v150, v151
    v_cvt_pk_bf16_f32 v158, v152, v153
    v_cvt_pk_bf16_f32 v159, v154, v155
    v_lshlrev_b32 v148, 16, v156
    v_and_b32 v149, 0xffff0000, v156
    v_lshlrev_b32 v150, 16, v158
    v_and_b32 v151, 0xffff0000, v158
    v_pk_mul_f32 v[148:149], v[148:149], v[150:151]
    v_cvt_pk_bf16_f32 v168, v148, v149
    v_lshlrev_b32 v148, 16, v157
    v_and_b32 v149, 0xffff0000, v157
    v_lshlrev_b32 v150, 16, v159
    v_and_b32 v151, 0xffff0000, v159
    v_pk_mul_f32 v[148:149], v[148:149], v[150:151]
    v_cvt_pk_bf16_f32 v169, v148, v149
    s_mov_b32 s41, 442368
    v_accvgpr_read_b32 v148, a44
    v_accvgpr_read_b32 v149, a45
    v_accvgpr_read_b32 v150, a46
    v_accvgpr_read_b32 v151, a47
    v_accvgpr_read_b32 v152, a60
    v_accvgpr_read_b32 v153, a61
    v_accvgpr_read_b32 v154, a62
    v_accvgpr_read_b32 v155, a63
    v_cvt_pk_bf16_f32 v156, v148, v149
    v_cvt_pk_bf16_f32 v157, v150, v151
    v_cvt_pk_bf16_f32 v158, v152, v153
    v_cvt_pk_bf16_f32 v159, v154, v155
    v_lshlrev_b32 v148, 16, v156
    v_and_b32 v149, 0xffff0000, v156
    v_lshlrev_b32 v150, 16, v158
    v_and_b32 v151, 0xffff0000, v158
    v_pk_mul_f32 v[148:149], v[148:149], v[150:151]
    v_cvt_pk_bf16_f32 v170, v148, v149
    v_lshlrev_b32 v148, 16, v157
    v_and_b32 v149, 0xffff0000, v157
    v_lshlrev_b32 v150, 16, v159
    v_and_b32 v151, 0xffff0000, v159
    v_pk_mul_f32 v[148:149], v[148:149], v[150:151]
    v_cvt_pk_bf16_f32 v171, v148, v149
    s_mov_b32 s41, 442368
    buffer_store_dwordx4 v[168:171], v3, s[28:31], s41 offen sc1
    v_accvgpr_read_b32 v148, a76
    v_accvgpr_read_b32 v149, a77
    v_accvgpr_read_b32 v150, a78
    v_accvgpr_read_b32 v151, a79
    v_accvgpr_read_b32 v152, a92
    v_accvgpr_read_b32 v153, a93
    v_accvgpr_read_b32 v154, a94
    v_accvgpr_read_b32 v155, a95
    v_cvt_pk_bf16_f32 v156, v148, v149
    v_cvt_pk_bf16_f32 v157, v150, v151
    v_cvt_pk_bf16_f32 v158, v152, v153
    v_cvt_pk_bf16_f32 v159, v154, v155
    v_lshlrev_b32 v148, 16, v156
    v_and_b32 v149, 0xffff0000, v156
    v_lshlrev_b32 v150, 16, v158
    v_and_b32 v151, 0xffff0000, v158
    v_pk_mul_f32 v[148:149], v[148:149], v[150:151]
    v_cvt_pk_bf16_f32 v164, v148, v149
    v_lshlrev_b32 v148, 16, v157
    v_and_b32 v149, 0xffff0000, v157
    v_lshlrev_b32 v150, 16, v159
    v_and_b32 v151, 0xffff0000, v159
    v_pk_mul_f32 v[148:149], v[148:149], v[150:151]
    v_cvt_pk_bf16_f32 v165, v148, v149
    s_mov_b32 s41, 443392
    v_accvgpr_read_b32 v148, a108
    v_accvgpr_read_b32 v149, a109
    v_accvgpr_read_b32 v150, a110
    v_accvgpr_read_b32 v151, a111
    v_accvgpr_read_b32 v152, a124
    v_accvgpr_read_b32 v153, a125
    v_accvgpr_read_b32 v154, a126
    v_accvgpr_read_b32 v155, a127
    v_cvt_pk_bf16_f32 v156, v148, v149
    v_cvt_pk_bf16_f32 v157, v150, v151
    v_cvt_pk_bf16_f32 v158, v152, v153
    v_cvt_pk_bf16_f32 v159, v154, v155
    v_lshlrev_b32 v148, 16, v156
    v_and_b32 v149, 0xffff0000, v156
    v_lshlrev_b32 v150, 16, v158
    v_and_b32 v151, 0xffff0000, v158
    v_pk_mul_f32 v[148:149], v[148:149], v[150:151]
    v_cvt_pk_bf16_f32 v166, v148, v149
    v_lshlrev_b32 v148, 16, v157
    v_and_b32 v149, 0xffff0000, v157
    v_lshlrev_b32 v150, 16, v159
    v_and_b32 v151, 0xffff0000, v159
    v_pk_mul_f32 v[148:149], v[148:149], v[150:151]
    v_cvt_pk_bf16_f32 v167, v148, v149
    s_mov_b32 s41, 443392
    buffer_store_dwordx4 v[164:167], v3, s[28:31], s41 offen sc1
    v_accvgpr_read_b32 v148, a140
    v_accvgpr_read_b32 v149, a141
    v_accvgpr_read_b32 v150, a142
    v_accvgpr_read_b32 v151, a143
    v_accvgpr_read_b32 v152, a156
    v_accvgpr_read_b32 v153, a157
    v_accvgpr_read_b32 v154, a158
    v_accvgpr_read_b32 v155, a159
    v_cvt_pk_bf16_f32 v156, v148, v149
    v_cvt_pk_bf16_f32 v157, v150, v151
    v_cvt_pk_bf16_f32 v158, v152, v153
    v_cvt_pk_bf16_f32 v159, v154, v155
    v_lshlrev_b32 v148, 16, v156
    v_and_b32 v149, 0xffff0000, v156
    v_lshlrev_b32 v150, 16, v158
    v_and_b32 v151, 0xffff0000, v158
    v_pk_mul_f32 v[148:149], v[148:149], v[150:151]
    v_cvt_pk_bf16_f32 v168, v148, v149
    v_lshlrev_b32 v148, 16, v157
    v_and_b32 v149, 0xffff0000, v157
    v_lshlrev_b32 v150, 16, v159
    v_and_b32 v151, 0xffff0000, v159
    v_pk_mul_f32 v[148:149], v[148:149], v[150:151]
    v_cvt_pk_bf16_f32 v169, v148, v149
    s_mov_b32 s41, 444416
    v_accvgpr_read_b32 v148, a172
    v_accvgpr_read_b32 v149, a173
    v_accvgpr_read_b32 v150, a174
    v_accvgpr_read_b32 v151, a175
    v_accvgpr_read_b32 v152, a188
    v_accvgpr_read_b32 v153, a189
    v_accvgpr_read_b32 v154, a190
    v_accvgpr_read_b32 v155, a191
    v_cvt_pk_bf16_f32 v156, v148, v149
    v_cvt_pk_bf16_f32 v157, v150, v151
    v_cvt_pk_bf16_f32 v158, v152, v153
    v_cvt_pk_bf16_f32 v159, v154, v155
    v_lshlrev_b32 v148, 16, v156
    v_and_b32 v149, 0xffff0000, v156
    v_lshlrev_b32 v150, 16, v158
    v_and_b32 v151, 0xffff0000, v158
    v_pk_mul_f32 v[148:149], v[148:149], v[150:151]
    v_cvt_pk_bf16_f32 v170, v148, v149
    v_lshlrev_b32 v148, 16, v157
    v_and_b32 v149, 0xffff0000, v157
    v_lshlrev_b32 v150, 16, v159
    v_and_b32 v151, 0xffff0000, v159
    v_pk_mul_f32 v[148:149], v[148:149], v[150:151]
    v_cvt_pk_bf16_f32 v171, v148, v149
    s_mov_b32 s41, 444416
    buffer_store_dwordx4 v[168:171], v3, s[28:31], s41 offen sc1
    v_accvgpr_read_b32 v148, a204
    v_accvgpr_read_b32 v149, a205
    v_accvgpr_read_b32 v150, a206
    v_accvgpr_read_b32 v151, a207
    v_accvgpr_read_b32 v152, a220
    v_accvgpr_read_b32 v153, a221
    v_accvgpr_read_b32 v154, a222
    v_accvgpr_read_b32 v155, a223
    v_cvt_pk_bf16_f32 v156, v148, v149
    v_cvt_pk_bf16_f32 v157, v150, v151
    v_cvt_pk_bf16_f32 v158, v152, v153
    v_cvt_pk_bf16_f32 v159, v154, v155
    v_lshlrev_b32 v148, 16, v156
    v_and_b32 v149, 0xffff0000, v156
    v_lshlrev_b32 v150, 16, v158
    v_and_b32 v151, 0xffff0000, v158
    v_pk_mul_f32 v[148:149], v[148:149], v[150:151]
    v_cvt_pk_bf16_f32 v164, v148, v149
    v_lshlrev_b32 v148, 16, v157
    v_and_b32 v149, 0xffff0000, v157
    v_lshlrev_b32 v150, 16, v159
    v_and_b32 v151, 0xffff0000, v159
    v_pk_mul_f32 v[148:149], v[148:149], v[150:151]
    v_cvt_pk_bf16_f32 v165, v148, v149
    s_mov_b32 s41, 445440
    v_accvgpr_read_b32 v148, a236
    v_accvgpr_read_b32 v149, a237
    v_accvgpr_read_b32 v150, a238
    v_accvgpr_read_b32 v151, a239
    v_accvgpr_read_b32 v152, a252
    v_accvgpr_read_b32 v153, a253
    v_accvgpr_read_b32 v154, a254
    v_accvgpr_read_b32 v155, a255
    v_cvt_pk_bf16_f32 v156, v148, v149
    v_cvt_pk_bf16_f32 v157, v150, v151
    v_cvt_pk_bf16_f32 v158, v152, v153
    v_cvt_pk_bf16_f32 v159, v154, v155
    v_lshlrev_b32 v148, 16, v156
    v_and_b32 v149, 0xffff0000, v156
    v_lshlrev_b32 v150, 16, v158
    v_and_b32 v151, 0xffff0000, v158
    v_pk_mul_f32 v[148:149], v[148:149], v[150:151]
    v_cvt_pk_bf16_f32 v166, v148, v149
    v_lshlrev_b32 v148, 16, v157
    v_and_b32 v149, 0xffff0000, v157
    v_lshlrev_b32 v150, 16, v159
    v_and_b32 v151, 0xffff0000, v159
    v_pk_mul_f32 v[148:149], v[148:149], v[150:151]
    v_cvt_pk_bf16_f32 v167, v148, v149
    s_mov_b32 s41, 445440
    buffer_store_dwordx4 v[164:167], v3, s[28:31], s41 offen sc1
    v_cvt_pk_bf16_f32 v156, v128, v129
    v_cvt_pk_bf16_f32 v157, v130, v131
    v_cvt_pk_bf16_f32 v158, v144, v145
    v_cvt_pk_bf16_f32 v159, v146, v147
    v_lshlrev_b32 v148, 16, v156
    v_and_b32 v149, 0xffff0000, v156
    v_lshlrev_b32 v150, 16, v158
    v_and_b32 v151, 0xffff0000, v158
    v_pk_mul_f32 v[148:149], v[148:149], v[150:151]
    v_cvt_pk_bf16_f32 v168, v148, v149
    v_lshlrev_b32 v148, 16, v157
    v_and_b32 v149, 0xffff0000, v157
    v_lshlrev_b32 v150, 16, v159
    v_and_b32 v151, 0xffff0000, v159
    v_pk_mul_f32 v[148:149], v[148:149], v[150:151]
    v_cvt_pk_bf16_f32 v169, v148, v149
    s_mov_b32 s41, 446464
    buffer_store_dwordx2 v[168:169], v3, s[28:31], s41 offen sc1
    s_endpgm
L_gemm1_kernel_odd:
    v_accvgpr_read_b32 v148, a0
    v_accvgpr_read_b32 v149, a1
    v_accvgpr_read_b32 v150, a2
    v_accvgpr_read_b32 v151, a3
    v_accvgpr_read_b32 v152, a16
    v_accvgpr_read_b32 v153, a17
    v_accvgpr_read_b32 v154, a18
    v_accvgpr_read_b32 v155, a19
    v_cvt_pk_bf16_f32 v156, v148, v149
    v_cvt_pk_bf16_f32 v157, v150, v151
    v_cvt_pk_bf16_f32 v158, v152, v153
    v_cvt_pk_bf16_f32 v159, v154, v155
    v_lshlrev_b32 v148, 16, v156
    v_and_b32 v149, 0xffff0000, v156
    v_lshlrev_b32 v150, 16, v158
    v_and_b32 v151, 0xffff0000, v158
    v_pk_mul_f32 v[148:149], v[148:149], v[150:151]
    v_cvt_pk_bf16_f32 v166, v148, v149
    v_lshlrev_b32 v148, 16, v157
    v_and_b32 v149, 0xffff0000, v157
    v_lshlrev_b32 v150, 16, v159
    v_and_b32 v151, 0xffff0000, v159
    v_pk_mul_f32 v[148:149], v[148:149], v[150:151]
    v_cvt_pk_bf16_f32 v167, v148, v149
    s_mov_b32 s41, 0
    buffer_store_dwordx2 v[166:167], v3, s[28:31], s41 offen offset:8 sc1
    v_accvgpr_read_b32 v148, a32
    v_accvgpr_read_b32 v149, a33
    v_accvgpr_read_b32 v150, a34
    v_accvgpr_read_b32 v151, a35
    v_accvgpr_read_b32 v152, a48
    v_accvgpr_read_b32 v153, a49
    v_accvgpr_read_b32 v154, a50
    v_accvgpr_read_b32 v155, a51
    v_cvt_pk_bf16_f32 v156, v148, v149
    v_cvt_pk_bf16_f32 v157, v150, v151
    v_cvt_pk_bf16_f32 v158, v152, v153
    v_cvt_pk_bf16_f32 v159, v154, v155
    v_lshlrev_b32 v148, 16, v156
    v_and_b32 v149, 0xffff0000, v156
    v_lshlrev_b32 v150, 16, v158
    v_and_b32 v151, 0xffff0000, v158
    v_pk_mul_f32 v[148:149], v[148:149], v[150:151]
    v_cvt_pk_bf16_f32 v168, v148, v149
    v_lshlrev_b32 v148, 16, v157
    v_and_b32 v149, 0xffff0000, v157
    v_lshlrev_b32 v150, 16, v159
    v_and_b32 v151, 0xffff0000, v159
    v_pk_mul_f32 v[148:149], v[148:149], v[150:151]
    v_cvt_pk_bf16_f32 v169, v148, v149
    s_mov_b32 s41, 1024
    v_accvgpr_read_b32 v148, a64
    v_accvgpr_read_b32 v149, a65
    v_accvgpr_read_b32 v150, a66
    v_accvgpr_read_b32 v151, a67
    v_accvgpr_read_b32 v152, a80
    v_accvgpr_read_b32 v153, a81
    v_accvgpr_read_b32 v154, a82
    v_accvgpr_read_b32 v155, a83
    v_cvt_pk_bf16_f32 v156, v148, v149
    v_cvt_pk_bf16_f32 v157, v150, v151
    v_cvt_pk_bf16_f32 v158, v152, v153
    v_cvt_pk_bf16_f32 v159, v154, v155
    v_lshlrev_b32 v148, 16, v156
    v_and_b32 v149, 0xffff0000, v156
    v_lshlrev_b32 v150, 16, v158
    v_and_b32 v151, 0xffff0000, v158
    v_pk_mul_f32 v[148:149], v[148:149], v[150:151]
    v_cvt_pk_bf16_f32 v170, v148, v149
    v_lshlrev_b32 v148, 16, v157
    v_and_b32 v149, 0xffff0000, v157
    v_lshlrev_b32 v150, 16, v159
    v_and_b32 v151, 0xffff0000, v159
    v_pk_mul_f32 v[148:149], v[148:149], v[150:151]
    v_cvt_pk_bf16_f32 v171, v148, v149
    s_mov_b32 s41, 1024
    buffer_store_dwordx4 v[168:171], v3, s[28:31], s41 offen sc1
    v_accvgpr_read_b32 v148, a96
    v_accvgpr_read_b32 v149, a97
    v_accvgpr_read_b32 v150, a98
    v_accvgpr_read_b32 v151, a99
    v_accvgpr_read_b32 v152, a112
    v_accvgpr_read_b32 v153, a113
    v_accvgpr_read_b32 v154, a114
    v_accvgpr_read_b32 v155, a115
    v_cvt_pk_bf16_f32 v156, v148, v149
    v_cvt_pk_bf16_f32 v157, v150, v151
    v_cvt_pk_bf16_f32 v158, v152, v153
    v_cvt_pk_bf16_f32 v159, v154, v155
    v_lshlrev_b32 v148, 16, v156
    v_and_b32 v149, 0xffff0000, v156
    v_lshlrev_b32 v150, 16, v158
    v_and_b32 v151, 0xffff0000, v158
    v_pk_mul_f32 v[148:149], v[148:149], v[150:151]
    v_cvt_pk_bf16_f32 v164, v148, v149
    v_lshlrev_b32 v148, 16, v157
    v_and_b32 v149, 0xffff0000, v157
    v_lshlrev_b32 v150, 16, v159
    v_and_b32 v151, 0xffff0000, v159
    v_pk_mul_f32 v[148:149], v[148:149], v[150:151]
    v_cvt_pk_bf16_f32 v165, v148, v149
    s_mov_b32 s41, 2048
    v_accvgpr_read_b32 v148, a128
    v_accvgpr_read_b32 v149, a129
    v_accvgpr_read_b32 v150, a130
    v_accvgpr_read_b32 v151, a131
    v_accvgpr_read_b32 v152, a144
    v_accvgpr_read_b32 v153, a145
    v_accvgpr_read_b32 v154, a146
    v_accvgpr_read_b32 v155, a147
    v_cvt_pk_bf16_f32 v156, v148, v149
    v_cvt_pk_bf16_f32 v157, v150, v151
    v_cvt_pk_bf16_f32 v158, v152, v153
    v_cvt_pk_bf16_f32 v159, v154, v155
    v_lshlrev_b32 v148, 16, v156
    v_and_b32 v149, 0xffff0000, v156
    v_lshlrev_b32 v150, 16, v158
    v_and_b32 v151, 0xffff0000, v158
    v_pk_mul_f32 v[148:149], v[148:149], v[150:151]
    v_cvt_pk_bf16_f32 v166, v148, v149
    v_lshlrev_b32 v148, 16, v157
    v_and_b32 v149, 0xffff0000, v157
    v_lshlrev_b32 v150, 16, v159
    v_and_b32 v151, 0xffff0000, v159
    v_pk_mul_f32 v[148:149], v[148:149], v[150:151]
    v_cvt_pk_bf16_f32 v167, v148, v149
    s_mov_b32 s41, 2048
    buffer_store_dwordx4 v[164:167], v3, s[28:31], s41 offen sc1
    v_accvgpr_read_b32 v148, a160
    v_accvgpr_read_b32 v149, a161
    v_accvgpr_read_b32 v150, a162
    v_accvgpr_read_b32 v151, a163
    v_accvgpr_read_b32 v152, a176
    v_accvgpr_read_b32 v153, a177
    v_accvgpr_read_b32 v154, a178
    v_accvgpr_read_b32 v155, a179
    v_cvt_pk_bf16_f32 v156, v148, v149
    v_cvt_pk_bf16_f32 v157, v150, v151
    v_cvt_pk_bf16_f32 v158, v152, v153
    v_cvt_pk_bf16_f32 v159, v154, v155
    v_lshlrev_b32 v148, 16, v156
    v_and_b32 v149, 0xffff0000, v156
    v_lshlrev_b32 v150, 16, v158
    v_and_b32 v151, 0xffff0000, v158
    v_pk_mul_f32 v[148:149], v[148:149], v[150:151]
    v_cvt_pk_bf16_f32 v168, v148, v149
    v_lshlrev_b32 v148, 16, v157
    v_and_b32 v149, 0xffff0000, v157
    v_lshlrev_b32 v150, 16, v159
    v_and_b32 v151, 0xffff0000, v159
    v_pk_mul_f32 v[148:149], v[148:149], v[150:151]
    v_cvt_pk_bf16_f32 v169, v148, v149
    s_mov_b32 s41, 3072
    v_accvgpr_read_b32 v148, a192
    v_accvgpr_read_b32 v149, a193
    v_accvgpr_read_b32 v150, a194
    v_accvgpr_read_b32 v151, a195
    v_accvgpr_read_b32 v152, a208
    v_accvgpr_read_b32 v153, a209
    v_accvgpr_read_b32 v154, a210
    v_accvgpr_read_b32 v155, a211
    v_cvt_pk_bf16_f32 v156, v148, v149
    v_cvt_pk_bf16_f32 v157, v150, v151
    v_cvt_pk_bf16_f32 v158, v152, v153
    v_cvt_pk_bf16_f32 v159, v154, v155
    v_lshlrev_b32 v148, 16, v156
    v_and_b32 v149, 0xffff0000, v156
    v_lshlrev_b32 v150, 16, v158
    v_and_b32 v151, 0xffff0000, v158
    v_pk_mul_f32 v[148:149], v[148:149], v[150:151]
    v_cvt_pk_bf16_f32 v170, v148, v149
    v_lshlrev_b32 v148, 16, v157
    v_and_b32 v149, 0xffff0000, v157
    v_lshlrev_b32 v150, 16, v159
    v_and_b32 v151, 0xffff0000, v159
    v_pk_mul_f32 v[148:149], v[148:149], v[150:151]
    v_cvt_pk_bf16_f32 v171, v148, v149
    s_mov_b32 s41, 3072
    buffer_store_dwordx4 v[168:171], v3, s[28:31], s41 offen sc1
    v_accvgpr_read_b32 v148, a224
    v_accvgpr_read_b32 v149, a225
    v_accvgpr_read_b32 v150, a226
    v_accvgpr_read_b32 v151, a227
    v_accvgpr_read_b32 v152, a240
    v_accvgpr_read_b32 v153, a241
    v_accvgpr_read_b32 v154, a242
    v_accvgpr_read_b32 v155, a243
    v_cvt_pk_bf16_f32 v156, v148, v149
    v_cvt_pk_bf16_f32 v157, v150, v151
    v_cvt_pk_bf16_f32 v158, v152, v153
    v_cvt_pk_bf16_f32 v159, v154, v155
    v_lshlrev_b32 v148, 16, v156
    v_and_b32 v149, 0xffff0000, v156
    v_lshlrev_b32 v150, 16, v158
    v_and_b32 v151, 0xffff0000, v158
    v_pk_mul_f32 v[148:149], v[148:149], v[150:151]
    v_cvt_pk_bf16_f32 v164, v148, v149
    v_lshlrev_b32 v148, 16, v157
    v_and_b32 v149, 0xffff0000, v157
    v_lshlrev_b32 v150, 16, v159
    v_and_b32 v151, 0xffff0000, v159
    v_pk_mul_f32 v[148:149], v[148:149], v[150:151]
    v_cvt_pk_bf16_f32 v165, v148, v149
    s_mov_b32 s41, 4096
    v_cvt_pk_bf16_f32 v156, v116, v117
    v_cvt_pk_bf16_f32 v157, v118, v119
    v_cvt_pk_bf16_f32 v158, v132, v133
    v_cvt_pk_bf16_f32 v159, v134, v135
    v_lshlrev_b32 v148, 16, v156
    v_and_b32 v149, 0xffff0000, v156
    v_lshlrev_b32 v150, 16, v158
    v_and_b32 v151, 0xffff0000, v158
    v_pk_mul_f32 v[148:149], v[148:149], v[150:151]
    v_cvt_pk_bf16_f32 v166, v148, v149
    v_lshlrev_b32 v148, 16, v157
    v_and_b32 v149, 0xffff0000, v157
    v_lshlrev_b32 v150, 16, v159
    v_and_b32 v151, 0xffff0000, v159
    v_pk_mul_f32 v[148:149], v[148:149], v[150:151]
    v_cvt_pk_bf16_f32 v167, v148, v149
    s_mov_b32 s41, 4096
    buffer_store_dwordx4 v[164:167], v3, s[28:31], s41 offen sc1
    v_accvgpr_read_b32 v148, a4
    v_accvgpr_read_b32 v149, a5
    v_accvgpr_read_b32 v150, a6
    v_accvgpr_read_b32 v151, a7
    v_accvgpr_read_b32 v152, a20
    v_accvgpr_read_b32 v153, a21
    v_accvgpr_read_b32 v154, a22
    v_accvgpr_read_b32 v155, a23
    v_cvt_pk_bf16_f32 v156, v148, v149
    v_cvt_pk_bf16_f32 v157, v150, v151
    v_cvt_pk_bf16_f32 v158, v152, v153
    v_cvt_pk_bf16_f32 v159, v154, v155
    v_lshlrev_b32 v148, 16, v156
    v_and_b32 v149, 0xffff0000, v156
    v_lshlrev_b32 v150, 16, v158
    v_and_b32 v151, 0xffff0000, v158
    v_pk_mul_f32 v[148:149], v[148:149], v[150:151]
    v_cvt_pk_bf16_f32 v170, v148, v149
    v_lshlrev_b32 v148, 16, v157
    v_and_b32 v149, 0xffff0000, v157
    v_lshlrev_b32 v150, 16, v159
    v_and_b32 v151, 0xffff0000, v159
    v_pk_mul_f32 v[148:149], v[148:149], v[150:151]
    v_cvt_pk_bf16_f32 v171, v148, v149
    s_mov_b32 s41, 147456
    buffer_store_dwordx2 v[170:171], v3, s[28:31], s41 offen offset:8 sc1
    v_accvgpr_read_b32 v148, a36
    v_accvgpr_read_b32 v149, a37
    v_accvgpr_read_b32 v150, a38
    v_accvgpr_read_b32 v151, a39
    v_accvgpr_read_b32 v152, a52
    v_accvgpr_read_b32 v153, a53
    v_accvgpr_read_b32 v154, a54
    v_accvgpr_read_b32 v155, a55
    v_cvt_pk_bf16_f32 v156, v148, v149
    v_cvt_pk_bf16_f32 v157, v150, v151
    v_cvt_pk_bf16_f32 v158, v152, v153
    v_cvt_pk_bf16_f32 v159, v154, v155
    v_lshlrev_b32 v148, 16, v156
    v_and_b32 v149, 0xffff0000, v156
    v_lshlrev_b32 v150, 16, v158
    v_and_b32 v151, 0xffff0000, v158
    v_pk_mul_f32 v[148:149], v[148:149], v[150:151]
    v_cvt_pk_bf16_f32 v164, v148, v149
    v_lshlrev_b32 v148, 16, v157
    v_and_b32 v149, 0xffff0000, v157
    v_lshlrev_b32 v150, 16, v159
    v_and_b32 v151, 0xffff0000, v159
    v_pk_mul_f32 v[148:149], v[148:149], v[150:151]
    v_cvt_pk_bf16_f32 v165, v148, v149
    s_mov_b32 s41, 148480
    v_accvgpr_read_b32 v148, a68
    v_accvgpr_read_b32 v149, a69
    v_accvgpr_read_b32 v150, a70
    v_accvgpr_read_b32 v151, a71
    v_accvgpr_read_b32 v152, a84
    v_accvgpr_read_b32 v153, a85
    v_accvgpr_read_b32 v154, a86
    v_accvgpr_read_b32 v155, a87
    v_cvt_pk_bf16_f32 v156, v148, v149
    v_cvt_pk_bf16_f32 v157, v150, v151
    v_cvt_pk_bf16_f32 v158, v152, v153
    v_cvt_pk_bf16_f32 v159, v154, v155
    v_lshlrev_b32 v148, 16, v156
    v_and_b32 v149, 0xffff0000, v156
    v_lshlrev_b32 v150, 16, v158
    v_and_b32 v151, 0xffff0000, v158
    v_pk_mul_f32 v[148:149], v[148:149], v[150:151]
    v_cvt_pk_bf16_f32 v166, v148, v149
    v_lshlrev_b32 v148, 16, v157
    v_and_b32 v149, 0xffff0000, v157
    v_lshlrev_b32 v150, 16, v159
    v_and_b32 v151, 0xffff0000, v159
    v_pk_mul_f32 v[148:149], v[148:149], v[150:151]
    v_cvt_pk_bf16_f32 v167, v148, v149
    s_mov_b32 s41, 148480
    buffer_store_dwordx4 v[164:167], v3, s[28:31], s41 offen sc1
    v_accvgpr_read_b32 v148, a100
    v_accvgpr_read_b32 v149, a101
    v_accvgpr_read_b32 v150, a102
    v_accvgpr_read_b32 v151, a103
    v_accvgpr_read_b32 v152, a116
    v_accvgpr_read_b32 v153, a117
    v_accvgpr_read_b32 v154, a118
    v_accvgpr_read_b32 v155, a119
    v_cvt_pk_bf16_f32 v156, v148, v149
    v_cvt_pk_bf16_f32 v157, v150, v151
    v_cvt_pk_bf16_f32 v158, v152, v153
    v_cvt_pk_bf16_f32 v159, v154, v155
    v_lshlrev_b32 v148, 16, v156
    v_and_b32 v149, 0xffff0000, v156
    v_lshlrev_b32 v150, 16, v158
    v_and_b32 v151, 0xffff0000, v158
    v_pk_mul_f32 v[148:149], v[148:149], v[150:151]
    v_cvt_pk_bf16_f32 v168, v148, v149
    v_lshlrev_b32 v148, 16, v157
    v_and_b32 v149, 0xffff0000, v157
    v_lshlrev_b32 v150, 16, v159
    v_and_b32 v151, 0xffff0000, v159
    v_pk_mul_f32 v[148:149], v[148:149], v[150:151]
    v_cvt_pk_bf16_f32 v169, v148, v149
    s_mov_b32 s41, 149504
    v_accvgpr_read_b32 v148, a132
    v_accvgpr_read_b32 v149, a133
    v_accvgpr_read_b32 v150, a134
    v_accvgpr_read_b32 v151, a135
    v_accvgpr_read_b32 v152, a148
    v_accvgpr_read_b32 v153, a149
    v_accvgpr_read_b32 v154, a150
    v_accvgpr_read_b32 v155, a151
    v_cvt_pk_bf16_f32 v156, v148, v149
    v_cvt_pk_bf16_f32 v157, v150, v151
    v_cvt_pk_bf16_f32 v158, v152, v153
    v_cvt_pk_bf16_f32 v159, v154, v155
    v_lshlrev_b32 v148, 16, v156
    v_and_b32 v149, 0xffff0000, v156
    v_lshlrev_b32 v150, 16, v158
    v_and_b32 v151, 0xffff0000, v158
    v_pk_mul_f32 v[148:149], v[148:149], v[150:151]
    v_cvt_pk_bf16_f32 v170, v148, v149
    v_lshlrev_b32 v148, 16, v157
    v_and_b32 v149, 0xffff0000, v157
    v_lshlrev_b32 v150, 16, v159
    v_and_b32 v151, 0xffff0000, v159
    v_pk_mul_f32 v[148:149], v[148:149], v[150:151]
    v_cvt_pk_bf16_f32 v171, v148, v149
    s_mov_b32 s41, 149504
    buffer_store_dwordx4 v[168:171], v3, s[28:31], s41 offen sc1
    v_accvgpr_read_b32 v148, a164
    v_accvgpr_read_b32 v149, a165
    v_accvgpr_read_b32 v150, a166
    v_accvgpr_read_b32 v151, a167
    v_accvgpr_read_b32 v152, a180
    v_accvgpr_read_b32 v153, a181
    v_accvgpr_read_b32 v154, a182
    v_accvgpr_read_b32 v155, a183
    v_cvt_pk_bf16_f32 v156, v148, v149
    v_cvt_pk_bf16_f32 v157, v150, v151
    v_cvt_pk_bf16_f32 v158, v152, v153
    v_cvt_pk_bf16_f32 v159, v154, v155
    v_lshlrev_b32 v148, 16, v156
    v_and_b32 v149, 0xffff0000, v156
    v_lshlrev_b32 v150, 16, v158
    v_and_b32 v151, 0xffff0000, v158
    v_pk_mul_f32 v[148:149], v[148:149], v[150:151]
    v_cvt_pk_bf16_f32 v164, v148, v149
    v_lshlrev_b32 v148, 16, v157
    v_and_b32 v149, 0xffff0000, v157
    v_lshlrev_b32 v150, 16, v159
    v_and_b32 v151, 0xffff0000, v159
    v_pk_mul_f32 v[148:149], v[148:149], v[150:151]
    v_cvt_pk_bf16_f32 v165, v148, v149
    s_mov_b32 s41, 150528
    v_accvgpr_read_b32 v148, a196
    v_accvgpr_read_b32 v149, a197
    v_accvgpr_read_b32 v150, a198
    v_accvgpr_read_b32 v151, a199
    v_accvgpr_read_b32 v152, a212
    v_accvgpr_read_b32 v153, a213
    v_accvgpr_read_b32 v154, a214
    v_accvgpr_read_b32 v155, a215
    v_cvt_pk_bf16_f32 v156, v148, v149
    v_cvt_pk_bf16_f32 v157, v150, v151
    v_cvt_pk_bf16_f32 v158, v152, v153
    v_cvt_pk_bf16_f32 v159, v154, v155
    v_lshlrev_b32 v148, 16, v156
    v_and_b32 v149, 0xffff0000, v156
    v_lshlrev_b32 v150, 16, v158
    v_and_b32 v151, 0xffff0000, v158
    v_pk_mul_f32 v[148:149], v[148:149], v[150:151]
    v_cvt_pk_bf16_f32 v166, v148, v149
    v_lshlrev_b32 v148, 16, v157
    v_and_b32 v149, 0xffff0000, v157
    v_lshlrev_b32 v150, 16, v159
    v_and_b32 v151, 0xffff0000, v159
    v_pk_mul_f32 v[148:149], v[148:149], v[150:151]
    v_cvt_pk_bf16_f32 v167, v148, v149
    s_mov_b32 s41, 150528
    buffer_store_dwordx4 v[164:167], v3, s[28:31], s41 offen sc1
    v_accvgpr_read_b32 v148, a228
    v_accvgpr_read_b32 v149, a229
    v_accvgpr_read_b32 v150, a230
    v_accvgpr_read_b32 v151, a231
    v_accvgpr_read_b32 v152, a244
    v_accvgpr_read_b32 v153, a245
    v_accvgpr_read_b32 v154, a246
    v_accvgpr_read_b32 v155, a247
    v_cvt_pk_bf16_f32 v156, v148, v149
    v_cvt_pk_bf16_f32 v157, v150, v151
    v_cvt_pk_bf16_f32 v158, v152, v153
    v_cvt_pk_bf16_f32 v159, v154, v155
    v_lshlrev_b32 v148, 16, v156
    v_and_b32 v149, 0xffff0000, v156
    v_lshlrev_b32 v150, 16, v158
    v_and_b32 v151, 0xffff0000, v158
    v_pk_mul_f32 v[148:149], v[148:149], v[150:151]
    v_cvt_pk_bf16_f32 v168, v148, v149
    v_lshlrev_b32 v148, 16, v157
    v_and_b32 v149, 0xffff0000, v157
    v_lshlrev_b32 v150, 16, v159
    v_and_b32 v151, 0xffff0000, v159
    v_pk_mul_f32 v[148:149], v[148:149], v[150:151]
    v_cvt_pk_bf16_f32 v169, v148, v149
    s_mov_b32 s41, 151552
    v_cvt_pk_bf16_f32 v156, v120, v121
    v_cvt_pk_bf16_f32 v157, v122, v123
    v_cvt_pk_bf16_f32 v158, v136, v137
    v_cvt_pk_bf16_f32 v159, v138, v139
    v_lshlrev_b32 v148, 16, v156
    v_and_b32 v149, 0xffff0000, v156
    v_lshlrev_b32 v150, 16, v158
    v_and_b32 v151, 0xffff0000, v158
    v_pk_mul_f32 v[148:149], v[148:149], v[150:151]
    v_cvt_pk_bf16_f32 v170, v148, v149
    v_lshlrev_b32 v148, 16, v157
    v_and_b32 v149, 0xffff0000, v157
    v_lshlrev_b32 v150, 16, v159
    v_and_b32 v151, 0xffff0000, v159
    v_pk_mul_f32 v[148:149], v[148:149], v[150:151]
    v_cvt_pk_bf16_f32 v171, v148, v149
    s_mov_b32 s41, 151552
    buffer_store_dwordx4 v[168:171], v3, s[28:31], s41 offen sc1
    v_accvgpr_read_b32 v148, a8
    v_accvgpr_read_b32 v149, a9
    v_accvgpr_read_b32 v150, a10
    v_accvgpr_read_b32 v151, a11
    v_accvgpr_read_b32 v152, a24
    v_accvgpr_read_b32 v153, a25
    v_accvgpr_read_b32 v154, a26
    v_accvgpr_read_b32 v155, a27
    v_cvt_pk_bf16_f32 v156, v148, v149
    v_cvt_pk_bf16_f32 v157, v150, v151
    v_cvt_pk_bf16_f32 v158, v152, v153
    v_cvt_pk_bf16_f32 v159, v154, v155
    v_lshlrev_b32 v148, 16, v156
    v_and_b32 v149, 0xffff0000, v156
    v_lshlrev_b32 v150, 16, v158
    v_and_b32 v151, 0xffff0000, v158
    v_pk_mul_f32 v[148:149], v[148:149], v[150:151]
    v_cvt_pk_bf16_f32 v166, v148, v149
    v_lshlrev_b32 v148, 16, v157
    v_and_b32 v149, 0xffff0000, v157
    v_lshlrev_b32 v150, 16, v159
    v_and_b32 v151, 0xffff0000, v159
    v_pk_mul_f32 v[148:149], v[148:149], v[150:151]
    v_cvt_pk_bf16_f32 v167, v148, v149
    s_mov_b32 s41, 294912
    buffer_store_dwordx2 v[166:167], v3, s[28:31], s41 offen offset:8 sc1
    v_accvgpr_read_b32 v148, a40
    v_accvgpr_read_b32 v149, a41
    v_accvgpr_read_b32 v150, a42
    v_accvgpr_read_b32 v151, a43
    v_accvgpr_read_b32 v152, a56
    v_accvgpr_read_b32 v153, a57
    v_accvgpr_read_b32 v154, a58
    v_accvgpr_read_b32 v155, a59
    v_cvt_pk_bf16_f32 v156, v148, v149
    v_cvt_pk_bf16_f32 v157, v150, v151
    v_cvt_pk_bf16_f32 v158, v152, v153
    v_cvt_pk_bf16_f32 v159, v154, v155
    v_lshlrev_b32 v148, 16, v156
    v_and_b32 v149, 0xffff0000, v156
    v_lshlrev_b32 v150, 16, v158
    v_and_b32 v151, 0xffff0000, v158
    v_pk_mul_f32 v[148:149], v[148:149], v[150:151]
    v_cvt_pk_bf16_f32 v168, v148, v149
    v_lshlrev_b32 v148, 16, v157
    v_and_b32 v149, 0xffff0000, v157
    v_lshlrev_b32 v150, 16, v159
    v_and_b32 v151, 0xffff0000, v159
    v_pk_mul_f32 v[148:149], v[148:149], v[150:151]
    v_cvt_pk_bf16_f32 v169, v148, v149
    s_mov_b32 s41, 295936
    v_accvgpr_read_b32 v148, a72
    v_accvgpr_read_b32 v149, a73
    v_accvgpr_read_b32 v150, a74
    v_accvgpr_read_b32 v151, a75
    v_accvgpr_read_b32 v152, a88
    v_accvgpr_read_b32 v153, a89
    v_accvgpr_read_b32 v154, a90
    v_accvgpr_read_b32 v155, a91
    v_cvt_pk_bf16_f32 v156, v148, v149
    v_cvt_pk_bf16_f32 v157, v150, v151
    v_cvt_pk_bf16_f32 v158, v152, v153
    v_cvt_pk_bf16_f32 v159, v154, v155
    v_lshlrev_b32 v148, 16, v156
    v_and_b32 v149, 0xffff0000, v156
    v_lshlrev_b32 v150, 16, v158
    v_and_b32 v151, 0xffff0000, v158
    v_pk_mul_f32 v[148:149], v[148:149], v[150:151]
    v_cvt_pk_bf16_f32 v170, v148, v149
    v_lshlrev_b32 v148, 16, v157
    v_and_b32 v149, 0xffff0000, v157
    v_lshlrev_b32 v150, 16, v159
    v_and_b32 v151, 0xffff0000, v159
    v_pk_mul_f32 v[148:149], v[148:149], v[150:151]
    v_cvt_pk_bf16_f32 v171, v148, v149
    s_mov_b32 s41, 295936
    buffer_store_dwordx4 v[168:171], v3, s[28:31], s41 offen sc1
    v_accvgpr_read_b32 v148, a104
    v_accvgpr_read_b32 v149, a105
    v_accvgpr_read_b32 v150, a106
    v_accvgpr_read_b32 v151, a107
    v_accvgpr_read_b32 v152, a120
    v_accvgpr_read_b32 v153, a121
    v_accvgpr_read_b32 v154, a122
    v_accvgpr_read_b32 v155, a123
    v_cvt_pk_bf16_f32 v156, v148, v149
    v_cvt_pk_bf16_f32 v157, v150, v151
    v_cvt_pk_bf16_f32 v158, v152, v153
    v_cvt_pk_bf16_f32 v159, v154, v155
    v_lshlrev_b32 v148, 16, v156
    v_and_b32 v149, 0xffff0000, v156
    v_lshlrev_b32 v150, 16, v158
    v_and_b32 v151, 0xffff0000, v158
    v_pk_mul_f32 v[148:149], v[148:149], v[150:151]
    v_cvt_pk_bf16_f32 v164, v148, v149
    v_lshlrev_b32 v148, 16, v157
    v_and_b32 v149, 0xffff0000, v157
    v_lshlrev_b32 v150, 16, v159
    v_and_b32 v151, 0xffff0000, v159
    v_pk_mul_f32 v[148:149], v[148:149], v[150:151]
    v_cvt_pk_bf16_f32 v165, v148, v149
    s_mov_b32 s41, 296960
    v_accvgpr_read_b32 v148, a136
    v_accvgpr_read_b32 v149, a137
    v_accvgpr_read_b32 v150, a138
    v_accvgpr_read_b32 v151, a139
    v_accvgpr_read_b32 v152, a152
    v_accvgpr_read_b32 v153, a153
    v_accvgpr_read_b32 v154, a154
    v_accvgpr_read_b32 v155, a155
    v_cvt_pk_bf16_f32 v156, v148, v149
    v_cvt_pk_bf16_f32 v157, v150, v151
    v_cvt_pk_bf16_f32 v158, v152, v153
    v_cvt_pk_bf16_f32 v159, v154, v155
    v_lshlrev_b32 v148, 16, v156
    v_and_b32 v149, 0xffff0000, v156
    v_lshlrev_b32 v150, 16, v158
    v_and_b32 v151, 0xffff0000, v158
    v_pk_mul_f32 v[148:149], v[148:149], v[150:151]
    v_cvt_pk_bf16_f32 v166, v148, v149
    v_lshlrev_b32 v148, 16, v157
    v_and_b32 v149, 0xffff0000, v157
    v_lshlrev_b32 v150, 16, v159
    v_and_b32 v151, 0xffff0000, v159
    v_pk_mul_f32 v[148:149], v[148:149], v[150:151]
    v_cvt_pk_bf16_f32 v167, v148, v149
    s_mov_b32 s41, 296960
    buffer_store_dwordx4 v[164:167], v3, s[28:31], s41 offen sc1
    v_accvgpr_read_b32 v148, a168
    v_accvgpr_read_b32 v149, a169
    v_accvgpr_read_b32 v150, a170
    v_accvgpr_read_b32 v151, a171
    v_accvgpr_read_b32 v152, a184
    v_accvgpr_read_b32 v153, a185
    v_accvgpr_read_b32 v154, a186
    v_accvgpr_read_b32 v155, a187
    v_cvt_pk_bf16_f32 v156, v148, v149
    v_cvt_pk_bf16_f32 v157, v150, v151
    v_cvt_pk_bf16_f32 v158, v152, v153
    v_cvt_pk_bf16_f32 v159, v154, v155
    v_lshlrev_b32 v148, 16, v156
    v_and_b32 v149, 0xffff0000, v156
    v_lshlrev_b32 v150, 16, v158
    v_and_b32 v151, 0xffff0000, v158
    v_pk_mul_f32 v[148:149], v[148:149], v[150:151]
    v_cvt_pk_bf16_f32 v168, v148, v149
    v_lshlrev_b32 v148, 16, v157
    v_and_b32 v149, 0xffff0000, v157
    v_lshlrev_b32 v150, 16, v159
    v_and_b32 v151, 0xffff0000, v159
    v_pk_mul_f32 v[148:149], v[148:149], v[150:151]
    v_cvt_pk_bf16_f32 v169, v148, v149
    s_mov_b32 s41, 297984
    v_accvgpr_read_b32 v148, a200
    v_accvgpr_read_b32 v149, a201
    v_accvgpr_read_b32 v150, a202
    v_accvgpr_read_b32 v151, a203
    v_accvgpr_read_b32 v152, a216
    v_accvgpr_read_b32 v153, a217
    v_accvgpr_read_b32 v154, a218
    v_accvgpr_read_b32 v155, a219
    v_cvt_pk_bf16_f32 v156, v148, v149
    v_cvt_pk_bf16_f32 v157, v150, v151
    v_cvt_pk_bf16_f32 v158, v152, v153
    v_cvt_pk_bf16_f32 v159, v154, v155
    v_lshlrev_b32 v148, 16, v156
    v_and_b32 v149, 0xffff0000, v156
    v_lshlrev_b32 v150, 16, v158
    v_and_b32 v151, 0xffff0000, v158
    v_pk_mul_f32 v[148:149], v[148:149], v[150:151]
    v_cvt_pk_bf16_f32 v170, v148, v149
    v_lshlrev_b32 v148, 16, v157
    v_and_b32 v149, 0xffff0000, v157
    v_lshlrev_b32 v150, 16, v159
    v_and_b32 v151, 0xffff0000, v159
    v_pk_mul_f32 v[148:149], v[148:149], v[150:151]
    v_cvt_pk_bf16_f32 v171, v148, v149
    s_mov_b32 s41, 297984
    buffer_store_dwordx4 v[168:171], v3, s[28:31], s41 offen sc1
    v_accvgpr_read_b32 v148, a232
    v_accvgpr_read_b32 v149, a233
    v_accvgpr_read_b32 v150, a234
    v_accvgpr_read_b32 v151, a235
    v_accvgpr_read_b32 v152, a248
    v_accvgpr_read_b32 v153, a249
    v_accvgpr_read_b32 v154, a250
    v_accvgpr_read_b32 v155, a251
    v_cvt_pk_bf16_f32 v156, v148, v149
    v_cvt_pk_bf16_f32 v157, v150, v151
    v_cvt_pk_bf16_f32 v158, v152, v153
    v_cvt_pk_bf16_f32 v159, v154, v155
    v_lshlrev_b32 v148, 16, v156
    v_and_b32 v149, 0xffff0000, v156
    v_lshlrev_b32 v150, 16, v158
    v_and_b32 v151, 0xffff0000, v158
    v_pk_mul_f32 v[148:149], v[148:149], v[150:151]
    v_cvt_pk_bf16_f32 v164, v148, v149
    v_lshlrev_b32 v148, 16, v157
    v_and_b32 v149, 0xffff0000, v157
    v_lshlrev_b32 v150, 16, v159
    v_and_b32 v151, 0xffff0000, v159
    v_pk_mul_f32 v[148:149], v[148:149], v[150:151]
    v_cvt_pk_bf16_f32 v165, v148, v149
    s_mov_b32 s41, 299008
    v_cvt_pk_bf16_f32 v156, v124, v125
    v_cvt_pk_bf16_f32 v157, v126, v127
    v_cvt_pk_bf16_f32 v158, v140, v141
    v_cvt_pk_bf16_f32 v159, v142, v143
    v_lshlrev_b32 v148, 16, v156
    v_and_b32 v149, 0xffff0000, v156
    v_lshlrev_b32 v150, 16, v158
    v_and_b32 v151, 0xffff0000, v158
    v_pk_mul_f32 v[148:149], v[148:149], v[150:151]
    v_cvt_pk_bf16_f32 v166, v148, v149
    v_lshlrev_b32 v148, 16, v157
    v_and_b32 v149, 0xffff0000, v157
    v_lshlrev_b32 v150, 16, v159
    v_and_b32 v151, 0xffff0000, v159
    v_pk_mul_f32 v[148:149], v[148:149], v[150:151]
    v_cvt_pk_bf16_f32 v167, v148, v149
    s_mov_b32 s41, 299008
    buffer_store_dwordx4 v[164:167], v3, s[28:31], s41 offen sc1
    v_accvgpr_read_b32 v148, a12
    v_accvgpr_read_b32 v149, a13
    v_accvgpr_read_b32 v150, a14
    v_accvgpr_read_b32 v151, a15
    v_accvgpr_read_b32 v152, a28
    v_accvgpr_read_b32 v153, a29
    v_accvgpr_read_b32 v154, a30
    v_accvgpr_read_b32 v155, a31
    v_cvt_pk_bf16_f32 v156, v148, v149
    v_cvt_pk_bf16_f32 v157, v150, v151
    v_cvt_pk_bf16_f32 v158, v152, v153
    v_cvt_pk_bf16_f32 v159, v154, v155
    v_lshlrev_b32 v148, 16, v156
    v_and_b32 v149, 0xffff0000, v156
    v_lshlrev_b32 v150, 16, v158
    v_and_b32 v151, 0xffff0000, v158
    v_pk_mul_f32 v[148:149], v[148:149], v[150:151]
    v_cvt_pk_bf16_f32 v170, v148, v149
    v_lshlrev_b32 v148, 16, v157
    v_and_b32 v149, 0xffff0000, v157
    v_lshlrev_b32 v150, 16, v159
    v_and_b32 v151, 0xffff0000, v159
    v_pk_mul_f32 v[148:149], v[148:149], v[150:151]
    v_cvt_pk_bf16_f32 v171, v148, v149
    s_mov_b32 s41, 442368
    buffer_store_dwordx2 v[170:171], v3, s[28:31], s41 offen offset:8 sc1
    v_accvgpr_read_b32 v148, a44
    v_accvgpr_read_b32 v149, a45
    v_accvgpr_read_b32 v150, a46
    v_accvgpr_read_b32 v151, a47
    v_accvgpr_read_b32 v152, a60
    v_accvgpr_read_b32 v153, a61
    v_accvgpr_read_b32 v154, a62
    v_accvgpr_read_b32 v155, a63
    v_cvt_pk_bf16_f32 v156, v148, v149
    v_cvt_pk_bf16_f32 v157, v150, v151
    v_cvt_pk_bf16_f32 v158, v152, v153
    v_cvt_pk_bf16_f32 v159, v154, v155
    v_lshlrev_b32 v148, 16, v156
    v_and_b32 v149, 0xffff0000, v156
    v_lshlrev_b32 v150, 16, v158
    v_and_b32 v151, 0xffff0000, v158
    v_pk_mul_f32 v[148:149], v[148:149], v[150:151]
    v_cvt_pk_bf16_f32 v164, v148, v149
    v_lshlrev_b32 v148, 16, v157
    v_and_b32 v149, 0xffff0000, v157
    v_lshlrev_b32 v150, 16, v159
    v_and_b32 v151, 0xffff0000, v159
    v_pk_mul_f32 v[148:149], v[148:149], v[150:151]
    v_cvt_pk_bf16_f32 v165, v148, v149
    s_mov_b32 s41, 443392
    v_accvgpr_read_b32 v148, a76
    v_accvgpr_read_b32 v149, a77
    v_accvgpr_read_b32 v150, a78
    v_accvgpr_read_b32 v151, a79
    v_accvgpr_read_b32 v152, a92
    v_accvgpr_read_b32 v153, a93
    v_accvgpr_read_b32 v154, a94
    v_accvgpr_read_b32 v155, a95
    v_cvt_pk_bf16_f32 v156, v148, v149
    v_cvt_pk_bf16_f32 v157, v150, v151
    v_cvt_pk_bf16_f32 v158, v152, v153
    v_cvt_pk_bf16_f32 v159, v154, v155
    v_lshlrev_b32 v148, 16, v156
    v_and_b32 v149, 0xffff0000, v156
    v_lshlrev_b32 v150, 16, v158
    v_and_b32 v151, 0xffff0000, v158
    v_pk_mul_f32 v[148:149], v[148:149], v[150:151]
    v_cvt_pk_bf16_f32 v166, v148, v149
    v_lshlrev_b32 v148, 16, v157
    v_and_b32 v149, 0xffff0000, v157
    v_lshlrev_b32 v150, 16, v159
    v_and_b32 v151, 0xffff0000, v159
    v_pk_mul_f32 v[148:149], v[148:149], v[150:151]
    v_cvt_pk_bf16_f32 v167, v148, v149
    s_mov_b32 s41, 443392
    buffer_store_dwordx4 v[164:167], v3, s[28:31], s41 offen sc1
    v_accvgpr_read_b32 v148, a108
    v_accvgpr_read_b32 v149, a109
    v_accvgpr_read_b32 v150, a110
    v_accvgpr_read_b32 v151, a111
    v_accvgpr_read_b32 v152, a124
    v_accvgpr_read_b32 v153, a125
    v_accvgpr_read_b32 v154, a126
    v_accvgpr_read_b32 v155, a127
    v_cvt_pk_bf16_f32 v156, v148, v149
    v_cvt_pk_bf16_f32 v157, v150, v151
    v_cvt_pk_bf16_f32 v158, v152, v153
    v_cvt_pk_bf16_f32 v159, v154, v155
    v_lshlrev_b32 v148, 16, v156
    v_and_b32 v149, 0xffff0000, v156
    v_lshlrev_b32 v150, 16, v158
    v_and_b32 v151, 0xffff0000, v158
    v_pk_mul_f32 v[148:149], v[148:149], v[150:151]
    v_cvt_pk_bf16_f32 v168, v148, v149
    v_lshlrev_b32 v148, 16, v157
    v_and_b32 v149, 0xffff0000, v157
    v_lshlrev_b32 v150, 16, v159
    v_and_b32 v151, 0xffff0000, v159
    v_pk_mul_f32 v[148:149], v[148:149], v[150:151]
    v_cvt_pk_bf16_f32 v169, v148, v149
    s_mov_b32 s41, 444416
    v_accvgpr_read_b32 v148, a140
    v_accvgpr_read_b32 v149, a141
    v_accvgpr_read_b32 v150, a142
    v_accvgpr_read_b32 v151, a143
    v_accvgpr_read_b32 v152, a156
    v_accvgpr_read_b32 v153, a157
    v_accvgpr_read_b32 v154, a158
    v_accvgpr_read_b32 v155, a159
    v_cvt_pk_bf16_f32 v156, v148, v149
    v_cvt_pk_bf16_f32 v157, v150, v151
    v_cvt_pk_bf16_f32 v158, v152, v153
    v_cvt_pk_bf16_f32 v159, v154, v155
    v_lshlrev_b32 v148, 16, v156
    v_and_b32 v149, 0xffff0000, v156
    v_lshlrev_b32 v150, 16, v158
    v_and_b32 v151, 0xffff0000, v158
    v_pk_mul_f32 v[148:149], v[148:149], v[150:151]
    v_cvt_pk_bf16_f32 v170, v148, v149
    v_lshlrev_b32 v148, 16, v157
    v_and_b32 v149, 0xffff0000, v157
    v_lshlrev_b32 v150, 16, v159
    v_and_b32 v151, 0xffff0000, v159
    v_pk_mul_f32 v[148:149], v[148:149], v[150:151]
    v_cvt_pk_bf16_f32 v171, v148, v149
    s_mov_b32 s41, 444416
    buffer_store_dwordx4 v[168:171], v3, s[28:31], s41 offen sc1
    v_accvgpr_read_b32 v148, a172
    v_accvgpr_read_b32 v149, a173
    v_accvgpr_read_b32 v150, a174
    v_accvgpr_read_b32 v151, a175
    v_accvgpr_read_b32 v152, a188
    v_accvgpr_read_b32 v153, a189
    v_accvgpr_read_b32 v154, a190
    v_accvgpr_read_b32 v155, a191
    v_cvt_pk_bf16_f32 v156, v148, v149
    v_cvt_pk_bf16_f32 v157, v150, v151
    v_cvt_pk_bf16_f32 v158, v152, v153
    v_cvt_pk_bf16_f32 v159, v154, v155
    v_lshlrev_b32 v148, 16, v156
    v_and_b32 v149, 0xffff0000, v156
    v_lshlrev_b32 v150, 16, v158
    v_and_b32 v151, 0xffff0000, v158
    v_pk_mul_f32 v[148:149], v[148:149], v[150:151]
    v_cvt_pk_bf16_f32 v164, v148, v149
    v_lshlrev_b32 v148, 16, v157
    v_and_b32 v149, 0xffff0000, v157
    v_lshlrev_b32 v150, 16, v159
    v_and_b32 v151, 0xffff0000, v159
    v_pk_mul_f32 v[148:149], v[148:149], v[150:151]
    v_cvt_pk_bf16_f32 v165, v148, v149
    s_mov_b32 s41, 445440
    v_accvgpr_read_b32 v148, a204
    v_accvgpr_read_b32 v149, a205
    v_accvgpr_read_b32 v150, a206
    v_accvgpr_read_b32 v151, a207
    v_accvgpr_read_b32 v152, a220
    v_accvgpr_read_b32 v153, a221
    v_accvgpr_read_b32 v154, a222
    v_accvgpr_read_b32 v155, a223
    v_cvt_pk_bf16_f32 v156, v148, v149
    v_cvt_pk_bf16_f32 v157, v150, v151
    v_cvt_pk_bf16_f32 v158, v152, v153
    v_cvt_pk_bf16_f32 v159, v154, v155
    v_lshlrev_b32 v148, 16, v156
    v_and_b32 v149, 0xffff0000, v156
    v_lshlrev_b32 v150, 16, v158
    v_and_b32 v151, 0xffff0000, v158
    v_pk_mul_f32 v[148:149], v[148:149], v[150:151]
    v_cvt_pk_bf16_f32 v166, v148, v149
    v_lshlrev_b32 v148, 16, v157
    v_and_b32 v149, 0xffff0000, v157
    v_lshlrev_b32 v150, 16, v159
    v_and_b32 v151, 0xffff0000, v159
    v_pk_mul_f32 v[148:149], v[148:149], v[150:151]
    v_cvt_pk_bf16_f32 v167, v148, v149
    s_mov_b32 s41, 445440
    buffer_store_dwordx4 v[164:167], v3, s[28:31], s41 offen sc1
    v_accvgpr_read_b32 v148, a236
    v_accvgpr_read_b32 v149, a237
    v_accvgpr_read_b32 v150, a238
    v_accvgpr_read_b32 v151, a239
    v_accvgpr_read_b32 v152, a252
    v_accvgpr_read_b32 v153, a253
    v_accvgpr_read_b32 v154, a254
    v_accvgpr_read_b32 v155, a255
    v_cvt_pk_bf16_f32 v156, v148, v149
    v_cvt_pk_bf16_f32 v157, v150, v151
    v_cvt_pk_bf16_f32 v158, v152, v153
    v_cvt_pk_bf16_f32 v159, v154, v155
    v_lshlrev_b32 v148, 16, v156
    v_and_b32 v149, 0xffff0000, v156
    v_lshlrev_b32 v150, 16, v158
    v_and_b32 v151, 0xffff0000, v158
    v_pk_mul_f32 v[148:149], v[148:149], v[150:151]
    v_cvt_pk_bf16_f32 v168, v148, v149
    v_lshlrev_b32 v148, 16, v157
    v_and_b32 v149, 0xffff0000, v157
    v_lshlrev_b32 v150, 16, v159
    v_and_b32 v151, 0xffff0000, v159
    v_pk_mul_f32 v[148:149], v[148:149], v[150:151]
    v_cvt_pk_bf16_f32 v169, v148, v149
    s_mov_b32 s41, 446464
    v_cvt_pk_bf16_f32 v156, v128, v129
    v_cvt_pk_bf16_f32 v157, v130, v131
    v_cvt_pk_bf16_f32 v158, v144, v145
    v_cvt_pk_bf16_f32 v159, v146, v147
    v_lshlrev_b32 v148, 16, v156
    v_and_b32 v149, 0xffff0000, v156
    v_lshlrev_b32 v150, 16, v158
    v_and_b32 v151, 0xffff0000, v158
    v_pk_mul_f32 v[148:149], v[148:149], v[150:151]
    v_cvt_pk_bf16_f32 v170, v148, v149
    v_lshlrev_b32 v148, 16, v157
    v_and_b32 v149, 0xffff0000, v157
    v_lshlrev_b32 v150, 16, v159
    v_and_b32 v151, 0xffff0000, v159
    v_pk_mul_f32 v[148:149], v[148:149], v[150:151]
    v_cvt_pk_bf16_f32 v171, v148, v149
    s_mov_b32 s41, 446464
    buffer_store_dwordx4 v[168:171], v3, s[28:31], s41 offen sc1
    s_endpgm
L_gemm1_kernel_exit:
    s_endpgm
.globl gemm2_kernel
.p2align 8
.type gemm2_kernel,@function
gemm2_kernel:

    s_cmp_ge_u32 s2, 256
    s_cbranch_scc1 L_gemm2_kernel_exit
    s_load_dwordx4 s[4:7], s[0:1], 56
    s_load_dwordx2 s[8:9], s[0:1], 72
    s_load_dwordx2 s[10:11], s[0:1], 96
    s_load_dwordx4 s[44:47], s[0:1], 32
    s_and_b32 s12, s2, 7
    s_lshr_b32 s13, s2, 3
    s_and_b32 s14, s13, 3
    s_and_b32 s15, s12, 1
    s_lshl_b32 s15, s15, 3
    s_lshr_b32 s16, s13, 2
    s_add_u32 s15, s15, s16
    s_lshr_b32 s16, s12, 1
    v_lshrrev_b32 v1, 6, v0
    v_and_b32 v2, 63, v0
    v_readfirstlane_b32 s17, v1
    s_mul_i32 s18, s14, 288
    s_mul_i32 s19, s16, 1327104
    s_add_u32 s18, s18, s19
    s_mov_b32 s19, s17
    s_mul_i32 s19, s19, 576
    s_movk_i32 s32, 3641
    s_movk_i32 s33, 18
    s_mov_b32 s34, 1152
    v_add_u32 v3, s19, v2
    v_mul_lo_u32 v4, v3, s32
    v_lshrrev_b32 v4, 16, v4
    v_mul_lo_u32 v5, v4, s33
    v_sub_u32 v5, v3, v5
    v_mul_lo_u32 v4, v4, s34
    v_lshl_add_u32 v4, v5, 4, v4
    v_add_u32 v8, s18, v4
    v_add_u32 v3, s19, v2
    v_add_u32 v3, 64, v3
    v_mul_lo_u32 v4, v3, s32
    v_lshrrev_b32 v4, 16, v4
    v_mul_lo_u32 v5, v4, s33
    v_sub_u32 v5, v3, v5
    v_mul_lo_u32 v4, v4, s34
    v_lshl_add_u32 v4, v5, 4, v4
    v_add_u32 v9, s18, v4
    v_add_u32 v3, s19, v2
    v_add_u32 v3, 128, v3
    v_mul_lo_u32 v4, v3, s32
    v_lshrrev_b32 v4, 16, v4
    v_mul_lo_u32 v5, v4, s33
    v_sub_u32 v5, v3, v5
    v_mul_lo_u32 v4, v4, s34
    v_lshl_add_u32 v4, v5, 4, v4
    v_add_u32 v10, s18, v4
    v_add_u32 v3, s19, v2
    v_add_u32 v3, 192, v3
    v_mul_lo_u32 v4, v3, s32
    v_lshrrev_b32 v4, 16, v4
    v_mul_lo_u32 v5, v4, s33
    v_sub_u32 v5, v3, v5
    v_mul_lo_u32 v4, v4, s34
    v_lshl_add_u32 v4, v5, 4, v4
    v_add_u32 v11, s18, v4
    v_add_u32 v3, s19, v2
    v_add_u32 v3, 256, v3
    v_mul_lo_u32 v4, v3, s32
    v_lshrrev_b32 v4, 16, v4
    v_mul_lo_u32 v5, v4, s33
    v_sub_u32 v5, v3, v5
    v_mul_lo_u32 v4, v4, s34
    v_lshl_add_u32 v4, v5, 4, v4
    v_add_u32 v12, s18, v4
    v_add_u32 v3, s19, v2
    v_add_u32 v3, 320, v3
    v_mul_lo_u32 v4, v3, s32
    v_lshrrev_b32 v4, 16, v4
    v_mul_lo_u32 v5, v4, s33
    v_sub_u32 v5, v3, v5
    v_mul_lo_u32 v4, v4, s34
    v_lshl_add_u32 v4, v5, 4, v4
    v_add_u32 v13, s18, v4
    v_add_u32 v3, s19, v2
    v_add_u32 v3, 384, v3
    v_mul_lo_u32 v4, v3, s32
    v_lshrrev_b32 v4, 16, v4
    v_mul_lo_u32 v5, v4, s33
    v_sub_u32 v5, v3, v5
    v_mul_lo_u32 v4, v4, s34
    v_lshl_add_u32 v4, v5, 4, v4
    v_add_u32 v14, s18, v4
    v_add_u32 v3, s19, v2
    v_add_u32 v3, 448, v3
    v_mul_lo_u32 v4, v3, s32
    v_lshrrev_b32 v4, 16, v4
    v_mul_lo_u32 v5, v4, s33
    v_sub_u32 v5, v3, v5
    v_mul_lo_u32 v4, v4, s34
    v_lshl_add_u32 v4, v5, 4, v4
    v_add_u32 v15, s18, v4
    v_add_u32 v3, s19, v2
    v_add_u32 v3, 512, v3
    v_mul_lo_u32 v4, v3, s32
    v_lshrrev_b32 v4, 16, v4
    v_mul_lo_u32 v5, v4, s33
    v_sub_u32 v5, v3, v5
    v_mul_lo_u32 v4, v4, s34
    v_lshl_add_u32 v4, v5, 4, v4
    v_add_u32 v16, s18, v4
    s_mul_i32 s35, s17, 9216
    s_lshl_b32 s36, s15, 3
    s_lshl_b32 s37, s17, 1
    s_add_u32 s36, s36, s37
    s_mul_i32 s36, s36, 147456
    s_mul_i32 s37, s16, 36864
    s_add_u32 s36, s36, s37
    v_lshlrev_b32 v3, 4, v2
    v_add_u32 v17, s36, v3
    v_add_u32 v18, 147456, v17
    v_lshrrev_b32 v3, 4, v2
    v_bfe_u32 v4, v2, 2, 2
    v_lshl_add_u32 v3, v3, 2, v4
    s_movk_i32 s37, 288
    v_mul_lo_u32 v3, v3, s37
    v_and_b32 v4, 3, v2
    v_lshl_add_u32 v21, v4, 3, v3
    v_add_u32 v22, 36864, v21
    v_add_u32 v23, 73728, v21
    s_waitcnt lgkmcnt(0)
    s_cmp_ge_u32 s17, 4
    s_cbranch_scc1 L_gemm2_kernel_conv
    s_mov_b32 s20, s8
    s_mov_b32 s21, s9
    s_mov_b32 s22, 5308416
    s_mov_b32 s23, 0x00020000
    s_add_u32 s24, s10, 7077888
    s_addc_u32 s25, s11, 0
    s_mov_b32 s26, 18874368
    s_mov_b32 s27, 0x00020000
    s_add_u32 s28, s10, 25952256
    s_addc_u32 s29, s11, 0
    s_mov_b32 s30, 18874368
    s_mov_b32 s31, 0x00020000
    s_add_u32 m0, s35, 0
    s_mov_b32 s38, 0
    buffer_load_dwordx4 v8, s[20:23], s38 offen lds
    s_add_u32 m0, s35, 1024
    s_mov_b32 s38, 0
    buffer_load_dwordx4 v9, s[20:23], s38 offen lds
    s_add_u32 m0, s35, 2048
    s_mov_b32 s38, 0
    buffer_load_dwordx4 v10, s[20:23], s38 offen lds
    s_add_u32 m0, s35, 3072
    s_mov_b32 s38, 0
    buffer_load_dwordx4 v11, s[20:23], s38 offen lds
    s_add_u32 m0, s35, 4096
    s_mov_b32 s38, 0
    buffer_load_dwordx4 v12, s[20:23], s38 offen lds
    s_add_u32 m0, s35, 5120
    s_mov_b32 s38, 0
    buffer_load_dwordx4 v13, s[20:23], s38 offen lds
    s_add_u32 m0, s35, 6144
    s_mov_b32 s38, 0
    buffer_load_dwordx4 v14, s[20:23], s38 offen lds
    s_add_u32 m0, s35, 7168
    s_mov_b32 s38, 0
    buffer_load_dwordx4 v15, s[20:23], s38 offen lds
    s_add_u32 m0, s35, 8192
    s_mov_b32 s38, 0
    buffer_load_dwordx4 v16, s[20:23], s38 offen lds
    s_mov_b32 s39, 0
    buffer_load_dwordx4 v[28:31], v17, s[24:27], s39 offen
    s_mov_b32 s39, 0
    buffer_load_dwordx4 v[32:35], v18, s[24:27], s39 offen
    s_mov_b32 s39, 1024
    buffer_load_dwordx4 v[36:39], v17, s[24:27], s39 offen
    s_mov_b32 s39, 1024
    buffer_load_dwordx4 v[40:43], v18, s[24:27], s39 offen
    s_mov_b32 s39, 2048
    buffer_load_dwordx4 v[44:47], v17, s[24:27], s39 offen
    s_mov_b32 s39, 2048
    buffer_load_dwordx4 v[48:51], v18, s[24:27], s39 offen
    s_mov_b32 s39, 3072
    buffer_load_dwordx4 v[52:55], v17, s[24:27], s39 offen
    s_mov_b32 s39, 3072
    buffer_load_dwordx4 v[56:59], v18, s[24:27], s39 offen
    s_add_u32 m0, s35, 36864
    s_mov_b32 s38, 147456
    buffer_load_dwordx4 v8, s[20:23], s38 offen lds
    s_add_u32 m0, s35, 37888
    s_mov_b32 s38, 147456
    buffer_load_dwordx4 v9, s[20:23], s38 offen lds
    s_add_u32 m0, s35, 38912
    s_mov_b32 s38, 147456
    buffer_load_dwordx4 v10, s[20:23], s38 offen lds
    s_add_u32 m0, s35, 39936
    s_mov_b32 s38, 147456
    buffer_load_dwordx4 v11, s[20:23], s38 offen lds
    s_add_u32 m0, s35, 40960
    s_mov_b32 s38, 147456
    buffer_load_dwordx4 v12, s[20:23], s38 offen lds
    s_add_u32 m0, s35, 41984
    s_mov_b32 s38, 147456
    buffer_load_dwordx4 v13, s[20:23], s38 offen lds
    s_add_u32 m0, s35, 43008
    s_mov_b32 s38, 147456
    buffer_load_dwordx4 v14, s[20:23], s38 offen lds
    s_add_u32 m0, s35, 44032
    s_mov_b32 s38, 147456
    buffer_load_dwordx4 v15, s[20:23], s38 offen lds
    s_add_u32 m0, s35, 45056
    s_mov_b32 s38, 147456
    buffer_load_dwordx4 v16, s[20:23], s38 offen lds
    s_mov_b32 s39, 4096
    buffer_load_dwordx4 v[60:63], v17, s[24:27], s39 offen
    s_mov_b32 s39, 4096
    buffer_load_dwordx4 v[64:67], v18, s[24:27], s39 offen
    s_mov_b32 s39, 5120
    buffer_load_dwordx4 v[68:71], v17, s[24:27], s39 offen
    s_mov_b32 s39, 5120
    buffer_load_dwordx4 v[72:75], v18, s[24:27], s39 offen
    s_mov_b32 s39, 6144
    buffer_load_dwordx4 v[76:79], v17, s[24:27], s39 offen
    s_mov_b32 s39, 6144
    buffer_load_dwordx4 v[80:83], v18, s[24:27], s39 offen
    s_mov_b32 s39, 7168
    buffer_load_dwordx4 v[84:87], v17, s[24:27], s39 offen
    s_mov_b32 s39, 7168
    buffer_load_dwordx4 v[88:91], v18, s[24:27], s39 offen
    s_mov_b32 s39, 8192
    buffer_load_dwordx4 v[92:95], v17, s[24:27], s39 offen
    s_mov_b32 s39, 8192
    buffer_load_dwordx4 v[96:99], v18, s[24:27], s39 offen
    s_mov_b32 s39, 9216
    buffer_load_dwordx4 v[100:103], v17, s[24:27], s39 offen
    s_mov_b32 s39, 9216
    buffer_load_dwordx4 v[104:107], v18, s[24:27], s39 offen
    s_mov_b32 s39, 10240
    buffer_load_dwordx4 v[108:111], v17, s[24:27], s39 offen
    s_mov_b32 s39, 10240
    buffer_load_dwordx4 v[112:115], v18, s[24:27], s39 offen
    s_waitcnt vmcnt(31)
    s_barrier
    ds_read_b64_tr_b16 v[124:125], v21 offset:0
    ds_read_b64_tr_b16 v[126:127], v21 offset:4608
    ds_read_b64_tr_b16 v[128:129], v21 offset:32
    ds_read_b64_tr_b16 v[130:131], v21 offset:4640
    ds_read_b64_tr_b16 v[132:133], v21 offset:64
    ds_read_b64_tr_b16 v[134:135], v21 offset:4672
    ds_read_b64_tr_b16 v[136:137], v21 offset:96
    ds_read_b64_tr_b16 v[138:139], v21 offset:4704
    ds_read_b64_tr_b16 v[140:141], v21 offset:128
    ds_read_b64_tr_b16 v[142:143], v21 offset:4736
    ds_read_b64_tr_b16 v[144:145], v21 offset:160
    ds_read_b64_tr_b16 v[146:147], v21 offset:4768
    s_waitcnt vmcnt(29)
    s_waitcnt lgkmcnt(10)
    v_mfma_f32_16x16x32_bf16 a[0:3], v[124:127], v[28:31], 0
    ds_read_b64_tr_b16 v[148:149], v21 offset:192
    ds_read_b64_tr_b16 v[150:151], v21 offset:4800
    v_mfma_f32_16x16x32_bf16 a[4:7], v[124:127], v[32:35], 0
    s_mov_b32 s39, 11264
    buffer_load_dwordx4 v[116:119], v17, s[24:27], s39 offen
    s_waitcnt lgkmcnt(10)
    v_mfma_f32_16x16x32_bf16 a[8:11], v[128:131], v[28:31], 0
    ds_read_b64_tr_b16 v[124:125], v21 offset:224
    ds_read_b64_tr_b16 v[126:127], v21 offset:4832
    v_mfma_f32_16x16x32_bf16 a[12:15], v[128:131], v[32:35], 0
    s_mov_b32 s39, 11264
    buffer_load_dwordx4 v[120:123], v18, s[24:27], s39 offen
    s_waitcnt lgkmcnt(10)
    v_mfma_f32_16x16x32_bf16 a[16:19], v[132:135], v[28:31], 0
    ds_read_b64_tr_b16 v[128:129], v21 offset:256
    v_mfma_f32_16x16x32_bf16 a[20:23], v[132:135], v[32:35], 0
    ds_read_b64_tr_b16 v[130:131], v21 offset:4864
    s_waitcnt lgkmcnt(10)
    v_mfma_f32_16x16x32_bf16 a[24:27], v[136:139], v[28:31], 0
    ds_read_b64_tr_b16 v[132:133], v21 offset:9216
    v_mfma_f32_16x16x32_bf16 a[28:31], v[136:139], v[32:35], 0
    ds_read_b64_tr_b16 v[134:135], v21 offset:13824
    s_waitcnt lgkmcnt(10)
    v_mfma_f32_16x16x32_bf16 a[32:35], v[140:143], v[28:31], 0
    ds_read_b64_tr_b16 v[136:137], v21 offset:9248
    v_mfma_f32_16x16x32_bf16 a[36:39], v[140:143], v[32:35], 0
    ds_read_b64_tr_b16 v[138:139], v21 offset:13856
    s_waitcnt lgkmcnt(10)
    v_mfma_f32_16x16x32_bf16 a[40:43], v[144:147], v[28:31], 0
    ds_read_b64_tr_b16 v[140:141], v21 offset:9280
    v_mfma_f32_16x16x32_bf16 a[44:47], v[144:147], v[32:35], 0
    ds_read_b64_tr_b16 v[142:143], v21 offset:13888
    s_waitcnt lgkmcnt(10)
    v_mfma_f32_16x16x32_bf16 a[48:51], v[148:151], v[28:31], 0
    ds_read_b64_tr_b16 v[144:145], v21 offset:9312
    v_mfma_f32_16x16x32_bf16 a[52:55], v[148:151], v[32:35], 0
    ds_read_b64_tr_b16 v[146:147], v21 offset:13920
    s_waitcnt lgkmcnt(10)
    v_mfma_f32_16x16x32_bf16 a[56:59], v[124:127], v[28:31], 0
    ds_read_b64_tr_b16 v[148:149], v21 offset:9344
    v_mfma_f32_16x16x32_bf16 a[60:63], v[124:127], v[32:35], 0
    ds_read_b64_tr_b16 v[150:151], v21 offset:13952
    s_waitcnt lgkmcnt(10)
    v_mfma_f32_16x16x32_bf16 a[64:67], v[128:131], v[28:31], 0
    ds_read_b64_tr_b16 v[124:125], v21 offset:9376
    v_mfma_f32_16x16x32_bf16 a[68:71], v[128:131], v[32:35], 0
    ds_read_b64_tr_b16 v[126:127], v21 offset:13984
    s_waitcnt vmcnt(29)
    s_waitcnt lgkmcnt(10)
    v_mfma_f32_16x16x32_bf16 a[0:3], v[132:135], v[36:39], a[0:3]
    ds_read_b64_tr_b16 v[128:129], v21 offset:9408
    ds_read_b64_tr_b16 v[130:131], v21 offset:14016
    v_mfma_f32_16x16x32_bf16 a[4:7], v[132:135], v[40:43], a[4:7]
    s_mov_b32 s39, 12288
    buffer_load_dwordx4 v[28:31], v17, s[24:27], s39 offen
    s_waitcnt lgkmcnt(10)
    v_mfma_f32_16x16x32_bf16 a[8:11], v[136:139], v[36:39], a[8:11]
    ds_read_b64_tr_b16 v[132:133], v21 offset:9440
    ds_read_b64_tr_b16 v[134:135], v21 offset:14048
    v_mfma_f32_16x16x32_bf16 a[12:15], v[136:139], v[40:43], a[12:15]
    s_mov_b32 s39, 12288
    buffer_load_dwordx4 v[32:35], v18, s[24:27], s39 offen
    s_waitcnt lgkmcnt(10)
    v_mfma_f32_16x16x32_bf16 a[16:19], v[140:143], v[36:39], a[16:19]
    ds_read_b64_tr_b16 v[136:137], v21 offset:9472
    v_mfma_f32_16x16x32_bf16 a[20:23], v[140:143], v[40:43], a[20:23]
    ds_read_b64_tr_b16 v[138:139], v21 offset:14080
    s_waitcnt lgkmcnt(10)
    v_mfma_f32_16x16x32_bf16 a[24:27], v[144:147], v[36:39], a[24:27]
    ds_read_b64_tr_b16 v[140:141], v21 offset:18432
    v_mfma_f32_16x16x32_bf16 a[28:31], v[144:147], v[40:43], a[28:31]
    ds_read_b64_tr_b16 v[142:143], v21 offset:23040
    s_waitcnt lgkmcnt(10)
    v_mfma_f32_16x16x32_bf16 a[32:35], v[148:151], v[36:39], a[32:35]
    ds_read_b64_tr_b16 v[144:145], v21 offset:18464
    v_mfma_f32_16x16x32_bf16 a[36:39], v[148:151], v[40:43], a[36:39]
    ds_read_b64_tr_b16 v[146:147], v21 offset:23072
    s_waitcnt lgkmcnt(10)
    v_mfma_f32_16x16x32_bf16 a[40:43], v[124:127], v[36:39], a[40:43]
    ds_read_b64_tr_b16 v[148:149], v21 offset:18496
    v_mfma_f32_16x16x32_bf16 a[44:47], v[124:127], v[40:43], a[44:47]
    ds_read_b64_tr_b16 v[150:151], v21 offset:23104
    s_waitcnt lgkmcnt(10)
    v_mfma_f32_16x16x32_bf16 a[48:51], v[128:131], v[36:39], a[48:51]
    ds_read_b64_tr_b16 v[124:125], v21 offset:18528
    v_mfma_f32_16x16x32_bf16 a[52:55], v[128:131], v[40:43], a[52:55]
    ds_read_b64_tr_b16 v[126:127], v21 offset:23136
    s_waitcnt lgkmcnt(10)
    v_mfma_f32_16x16x32_bf16 a[56:59], v[132:135], v[36:39], a[56:59]
    ds_read_b64_tr_b16 v[128:129], v21 offset:18560
    v_mfma_f32_16x16x32_bf16 a[60:63], v[132:135], v[40:43], a[60:63]
    ds_read_b64_tr_b16 v[130:131], v21 offset:23168
    s_waitcnt lgkmcnt(10)
    v_mfma_f32_16x16x32_bf16 a[64:67], v[136:139], v[36:39], a[64:67]
    ds_read_b64_tr_b16 v[132:133], v21 offset:18592
    v_mfma_f32_16x16x32_bf16 a[68:71], v[136:139], v[40:43], a[68:71]
    ds_read_b64_tr_b16 v[134:135], v21 offset:23200
    s_waitcnt vmcnt(29)
    s_waitcnt lgkmcnt(10)
    v_mfma_f32_16x16x32_bf16 a[0:3], v[140:143], v[44:47], a[0:3]
    ds_read_b64_tr_b16 v[136:137], v21 offset:18624
    ds_read_b64_tr_b16 v[138:139], v21 offset:23232
    v_mfma_f32_16x16x32_bf16 a[4:7], v[140:143], v[48:51], a[4:7]
    s_mov_b32 s39, 13312
    buffer_load_dwordx4 v[36:39], v17, s[24:27], s39 offen
    s_waitcnt lgkmcnt(10)
    v_mfma_f32_16x16x32_bf16 a[8:11], v[144:147], v[44:47], a[8:11]
    ds_read_b64_tr_b16 v[140:141], v21 offset:18656
    ds_read_b64_tr_b16 v[142:143], v21 offset:23264
    v_mfma_f32_16x16x32_bf16 a[12:15], v[144:147], v[48:51], a[12:15]
    s_mov_b32 s39, 13312
    buffer_load_dwordx4 v[40:43], v18, s[24:27], s39 offen
    s_waitcnt lgkmcnt(10)
    v_mfma_f32_16x16x32_bf16 a[16:19], v[148:151], v[44:47], a[16:19]
    ds_read_b64_tr_b16 v[144:145], v21 offset:18688
    v_mfma_f32_16x16x32_bf16 a[20:23], v[148:151], v[48:51], a[20:23]
    ds_read_b64_tr_b16 v[146:147], v21 offset:23296
    s_waitcnt lgkmcnt(10)
    v_mfma_f32_16x16x32_bf16 a[24:27], v[124:127], v[44:47], a[24:27]
    ds_read_b64_tr_b16 v[148:149], v21 offset:27648
    v_mfma_f32_16x16x32_bf16 a[28:31], v[124:127], v[48:51], a[28:31]
    ds_read_b64_tr_b16 v[150:151], v21 offset:32256
    s_waitcnt lgkmcnt(10)
    v_mfma_f32_16x16x32_bf16 a[32:35], v[128:131], v[44:47], a[32:35]
    ds_read_b64_tr_b16 v[124:125], v21 offset:27680
    v_mfma_f32_16x16x32_bf16 a[36:39], v[128:131], v[48:51], a[36:39]
    ds_read_b64_tr_b16 v[126:127], v21 offset:32288
    s_waitcnt lgkmcnt(10)
    v_mfma_f32_16x16x32_bf16 a[40:43], v[132:135], v[44:47], a[40:43]
    ds_read_b64_tr_b16 v[128:129], v21 offset:27712
    v_mfma_f32_16x16x32_bf16 a[44:47], v[132:135], v[48:51], a[44:47]
    ds_read_b64_tr_b16 v[130:131], v21 offset:32320
    s_waitcnt lgkmcnt(10)
    v_mfma_f32_16x16x32_bf16 a[48:51], v[136:139], v[44:47], a[48:51]
    ds_read_b64_tr_b16 v[132:133], v21 offset:27744
    v_mfma_f32_16x16x32_bf16 a[52:55], v[136:139], v[48:51], a[52:55]
    ds_read_b64_tr_b16 v[134:135], v21 offset:32352
    s_waitcnt lgkmcnt(10)
    v_mfma_f32_16x16x32_bf16 a[56:59], v[140:143], v[44:47], a[56:59]
    ds_read_b64_tr_b16 v[136:137], v21 offset:27776
    v_mfma_f32_16x16x32_bf16 a[60:63], v[140:143], v[48:51], a[60:63]
    ds_read_b64_tr_b16 v[138:139], v21 offset:32384
    s_waitcnt lgkmcnt(10)
    v_mfma_f32_16x16x32_bf16 a[64:67], v[144:147], v[44:47], a[64:67]
    ds_read_b64_tr_b16 v[140:141], v21 offset:27808
    v_mfma_f32_16x16x32_bf16 a[68:71], v[144:147], v[48:51], a[68:71]
    ds_read_b64_tr_b16 v[142:143], v21 offset:32416
    s_waitcnt vmcnt(29)
    s_waitcnt lgkmcnt(10)
    v_mfma_f32_16x16x32_bf16 a[0:3], v[148:151], v[52:55], a[0:3]
    ds_read_b64_tr_b16 v[144:145], v21 offset:27840
    ds_read_b64_tr_b16 v[146:147], v21 offset:32448
    v_mfma_f32_16x16x32_bf16 a[4:7], v[148:151], v[56:59], a[4:7]
    s_mov_b32 s39, 14336
    buffer_load_dwordx4 v[44:47], v17, s[24:27], s39 offen
    s_waitcnt lgkmcnt(10)
    v_mfma_f32_16x16x32_bf16 a[8:11], v[124:127], v[52:55], a[8:11]
    ds_read_b64_tr_b16 v[148:149], v21 offset:27872
    ds_read_b64_tr_b16 v[150:151], v21 offset:32480
    v_mfma_f32_16x16x32_bf16 a[12:15], v[124:127], v[56:59], a[12:15]
    s_mov_b32 s39, 14336
    buffer_load_dwordx4 v[48:51], v18, s[24:27], s39 offen
    s_waitcnt vmcnt(22)
    s_barrier
    s_waitcnt lgkmcnt(10)
    v_mfma_f32_16x16x32_bf16 a[16:19], v[128:131], v[52:55], a[16:19]
    ds_read_b64_tr_b16 v[124:125], v21 offset:27904
    ds_read_b64_tr_b16 v[126:127], v21 offset:32512
    v_mfma_f32_16x16x32_bf16 a[20:23], v[128:131], v[56:59], a[20:23]
    s_add_u32 m0, s35, 73728
    s_mov_b32 s38, 294912
    buffer_load_dwordx4 v8, s[20:23], s38 offen lds
    s_waitcnt lgkmcnt(10)
    v_mfma_f32_16x16x32_bf16 a[24:27], v[132:135], v[52:55], a[24:27]
    ds_read_b64_tr_b16 v[128:129], v22 offset:0
    ds_read_b64_tr_b16 v[130:131], v22 offset:4608
    v_mfma_f32_16x16x32_bf16 a[28:31], v[132:135], v[56:59], a[28:31]
    s_add_u32 m0, s35, 74752
    s_mov_b32 s38, 294912
    buffer_load_dwordx4 v9, s[20:23], s38 offen lds
    s_waitcnt lgkmcnt(10)
    v_mfma_f32_16x16x32_bf16 a[32:35], v[136:139], v[52:55], a[32:35]
    ds_read_b64_tr_b16 v[132:133], v22 offset:32
    ds_read_b64_tr_b16 v[134:135], v22 offset:4640
    v_mfma_f32_16x16x32_bf16 a[36:39], v[136:139], v[56:59], a[36:39]
    s_add_u32 m0, s35, 75776
    s_mov_b32 s38, 294912
    buffer_load_dwordx4 v10, s[20:23], s38 offen lds
    s_waitcnt lgkmcnt(10)
    v_mfma_f32_16x16x32_bf16 a[40:43], v[140:143], v[52:55], a[40:43]
    ds_read_b64_tr_b16 v[136:137], v22 offset:64
    ds_read_b64_tr_b16 v[138:139], v22 offset:4672
    v_mfma_f32_16x16x32_bf16 a[44:47], v[140:143], v[56:59], a[44:47]
    s_add_u32 m0, s35, 76800
    s_mov_b32 s38, 294912
    buffer_load_dwordx4 v11, s[20:23], s38 offen lds
    s_waitcnt lgkmcnt(10)
    v_mfma_f32_16x16x32_bf16 a[48:51], v[144:147], v[52:55], a[48:51]
    ds_read_b64_tr_b16 v[140:141], v22 offset:96
    ds_read_b64_tr_b16 v[142:143], v22 offset:4704
    v_mfma_f32_16x16x32_bf16 a[52:55], v[144:147], v[56:59], a[52:55]
    s_add_u32 m0, s35, 77824
    s_mov_b32 s38, 294912
    buffer_load_dwordx4 v12, s[20:23], s38 offen lds
    s_waitcnt lgkmcnt(10)
    v_mfma_f32_16x16x32_bf16 a[56:59], v[148:151], v[52:55], a[56:59]
    ds_read_b64_tr_b16 v[144:145], v22 offset:128
    ds_read_b64_tr_b16 v[146:147], v22 offset:4736
    v_mfma_f32_16x16x32_bf16 a[60:63], v[148:151], v[56:59], a[60:63]
    s_add_u32 m0, s35, 78848
    s_mov_b32 s38, 294912
    buffer_load_dwordx4 v13, s[20:23], s38 offen lds
    s_waitcnt lgkmcnt(10)
    v_mfma_f32_16x16x32_bf16 a[64:67], v[124:127], v[52:55], a[64:67]
    ds_read_b64_tr_b16 v[148:149], v22 offset:160
    ds_read_b64_tr_b16 v[150:151], v22 offset:4768
    v_mfma_f32_16x16x32_bf16 a[68:71], v[124:127], v[56:59], a[68:71]
    s_add_u32 m0, s35, 79872
    s_mov_b32 s38, 294912
    buffer_load_dwordx4 v14, s[20:23], s38 offen lds
    s_waitcnt vmcnt(27)
    s_waitcnt lgkmcnt(10)
    v_mfma_f32_16x16x32_bf16 a[0:3], v[128:131], v[60:63], a[0:3]
    ds_read_b64_tr_b16 v[124:125], v22 offset:192
    ds_read_b64_tr_b16 v[126:127], v22 offset:4800
    v_mfma_f32_16x16x32_bf16 a[4:7], v[128:131], v[64:67], a[4:7]
    s_add_u32 m0, s35, 80896
    s_mov_b32 s38, 294912
    buffer_load_dwordx4 v15, s[20:23], s38 offen lds
    s_waitcnt lgkmcnt(10)
    v_mfma_f32_16x16x32_bf16 a[8:11], v[132:135], v[60:63], a[8:11]
    ds_read_b64_tr_b16 v[128:129], v22 offset:224
    ds_read_b64_tr_b16 v[130:131], v22 offset:4832
    v_mfma_f32_16x16x32_bf16 a[12:15], v[132:135], v[64:67], a[12:15]
    s_add_u32 m0, s35, 81920
    s_mov_b32 s38, 294912
    buffer_load_dwordx4 v16, s[20:23], s38 offen lds
    s_waitcnt lgkmcnt(10)
    v_mfma_f32_16x16x32_bf16 a[16:19], v[136:139], v[60:63], a[16:19]
    ds_read_b64_tr_b16 v[132:133], v22 offset:256
    ds_read_b64_tr_b16 v[134:135], v22 offset:4864
    v_mfma_f32_16x16x32_bf16 a[20:23], v[136:139], v[64:67], a[20:23]
    s_mov_b32 s39, 15360
    buffer_load_dwordx4 v[52:55], v17, s[24:27], s39 offen
    s_waitcnt lgkmcnt(10)
    v_mfma_f32_16x16x32_bf16 a[24:27], v[140:143], v[60:63], a[24:27]
    ds_read_b64_tr_b16 v[136:137], v22 offset:9216
    ds_read_b64_tr_b16 v[138:139], v22 offset:13824
    v_mfma_f32_16x16x32_bf16 a[28:31], v[140:143], v[64:67], a[28:31]
    s_mov_b32 s39, 15360
    buffer_load_dwordx4 v[56:59], v18, s[24:27], s39 offen
    s_waitcnt lgkmcnt(10)
    v_mfma_f32_16x16x32_bf16 a[32:35], v[144:147], v[60:63], a[32:35]
    ds_read_b64_tr_b16 v[140:141], v22 offset:9248
    v_mfma_f32_16x16x32_bf16 a[36:39], v[144:147], v[64:67], a[36:39]
    ds_read_b64_tr_b16 v[142:143], v22 offset:13856
    s_waitcnt lgkmcnt(10)
    v_mfma_f32_16x16x32_bf16 a[40:43], v[148:151], v[60:63], a[40:43]
    ds_read_b64_tr_b16 v[144:145], v22 offset:9280
    v_mfma_f32_16x16x32_bf16 a[44:47], v[148:151], v[64:67], a[44:47]
    ds_read_b64_tr_b16 v[146:147], v22 offset:13888
    s_waitcnt lgkmcnt(10)
    v_mfma_f32_16x16x32_bf16 a[48:51], v[124:127], v[60:63], a[48:51]
    ds_read_b64_tr_b16 v[148:149], v22 offset:9312
    v_mfma_f32_16x16x32_bf16 a[52:55], v[124:127], v[64:67], a[52:55]
    ds_read_b64_tr_b16 v[150:151], v22 offset:13920
    s_waitcnt lgkmcnt(10)
    v_mfma_f32_16x16x32_bf16 a[56:59], v[128:131], v[60:63], a[56:59]
    ds_read_b64_tr_b16 v[124:125], v22 offset:9344
    v_mfma_f32_16x16x32_bf16 a[60:63], v[128:131], v[64:67], a[60:63]
    ds_read_b64_tr_b16 v[126:127], v22 offset:13952
    s_waitcnt lgkmcnt(10)
    v_mfma_f32_16x16x32_bf16 a[64:67], v[132:135], v[60:63], a[64:67]
    ds_read_b64_tr_b16 v[128:129], v22 offset:9376
    v_mfma_f32_16x16x32_bf16 a[68:71], v[132:135], v[64:67], a[68:71]
    ds_read_b64_tr_b16 v[130:131], v22 offset:13984
    s_waitcnt vmcnt(29)
    s_waitcnt lgkmcnt(10)
    v_mfma_f32_16x16x32_bf16 a[0:3], v[136:139], v[68:71], a[0:3]
    ds_read_b64_tr_b16 v[132:133], v22 offset:9408
    ds_read_b64_tr_b16 v[134:135], v22 offset:14016
    v_mfma_f32_16x16x32_bf16 a[4:7], v[136:139], v[72:75], a[4:7]
    s_mov_b32 s39, 16384
    buffer_load_dwordx4 v[60:63], v17, s[24:27], s39 offen
    s_waitcnt lgkmcnt(10)
    v_mfma_f32_16x16x32_bf16 a[8:11], v[140:143], v[68:71], a[8:11]
    ds_read_b64_tr_b16 v[136:137], v22 offset:9440
    ds_read_b64_tr_b16 v[138:139], v22 offset:14048
    v_mfma_f32_16x16x32_bf16 a[12:15], v[140:143], v[72:75], a[12:15]
    s_mov_b32 s39, 16384
    buffer_load_dwordx4 v[64:67], v18, s[24:27], s39 offen
    s_waitcnt lgkmcnt(10)
    v_mfma_f32_16x16x32_bf16 a[16:19], v[144:147], v[68:71], a[16:19]
    ds_read_b64_tr_b16 v[140:141], v22 offset:9472
    v_mfma_f32_16x16x32_bf16 a[20:23], v[144:147], v[72:75], a[20:23]
    ds_read_b64_tr_b16 v[142:143], v22 offset:14080
    s_waitcnt lgkmcnt(10)
    v_mfma_f32_16x16x32_bf16 a[24:27], v[148:151], v[68:71], a[24:27]
    ds_read_b64_tr_b16 v[144:145], v22 offset:18432
    v_mfma_f32_16x16x32_bf16 a[28:31], v[148:151], v[72:75], a[28:31]
    ds_read_b64_tr_b16 v[146:147], v22 offset:23040
    s_waitcnt lgkmcnt(10)
    v_mfma_f32_16x16x32_bf16 a[32:35], v[124:127], v[68:71], a[32:35]
    ds_read_b64_tr_b16 v[148:149], v22 offset:18464
    v_mfma_f32_16x16x32_bf16 a[36:39], v[124:127], v[72:75], a[36:39]
    ds_read_b64_tr_b16 v[150:151], v22 offset:23072
    s_waitcnt lgkmcnt(10)
    v_mfma_f32_16x16x32_bf16 a[40:43], v[128:131], v[68:71], a[40:43]
    ds_read_b64_tr_b16 v[124:125], v22 offset:18496
    v_mfma_f32_16x16x32_bf16 a[44:47], v[128:131], v[72:75], a[44:47]
    ds_read_b64_tr_b16 v[126:127], v22 offset:23104
    s_waitcnt lgkmcnt(10)
    v_mfma_f32_16x16x32_bf16 a[48:51], v[132:135], v[68:71], a[48:51]
    ds_read_b64_tr_b16 v[128:129], v22 offset:18528
    v_mfma_f32_16x16x32_bf16 a[52:55], v[132:135], v[72:75], a[52:55]
    ds_read_b64_tr_b16 v[130:131], v22 offset:23136
    s_waitcnt lgkmcnt(10)
    v_mfma_f32_16x16x32_bf16 a[56:59], v[136:139], v[68:71], a[56:59]
    ds_read_b64_tr_b16 v[132:133], v22 offset:18560
    v_mfma_f32_16x16x32_bf16 a[60:63], v[136:139], v[72:75], a[60:63]
    ds_read_b64_tr_b16 v[134:135], v22 offset:23168
    s_waitcnt lgkmcnt(10)
    v_mfma_f32_16x16x32_bf16 a[64:67], v[140:143], v[68:71], a[64:67]
    ds_read_b64_tr_b16 v[136:137], v22 offset:18592
    v_mfma_f32_16x16x32_bf16 a[68:71], v[140:143], v[72:75], a[68:71]
    ds_read_b64_tr_b16 v[138:139], v22 offset:23200
    s_waitcnt vmcnt(29)
    s_waitcnt lgkmcnt(10)
    v_mfma_f32_16x16x32_bf16 a[0:3], v[144:147], v[76:79], a[0:3]
    ds_read_b64_tr_b16 v[140:141], v22 offset:18624
    ds_read_b64_tr_b16 v[142:143], v22 offset:23232
    v_mfma_f32_16x16x32_bf16 a[4:7], v[144:147], v[80:83], a[4:7]
    s_mov_b32 s39, 17408
    buffer_load_dwordx4 v[68:71], v17, s[24:27], s39 offen
    s_waitcnt lgkmcnt(10)
    v_mfma_f32_16x16x32_bf16 a[8:11], v[148:151], v[76:79], a[8:11]
    ds_read_b64_tr_b16 v[144:145], v22 offset:18656
    ds_read_b64_tr_b16 v[146:147], v22 offset:23264
    v_mfma_f32_16x16x32_bf16 a[12:15], v[148:151], v[80:83], a[12:15]
    s_mov_b32 s39, 17408
    buffer_load_dwordx4 v[72:75], v18, s[24:27], s39 offen
    s_waitcnt lgkmcnt(10)
    v_mfma_f32_16x16x32_bf16 a[16:19], v[124:127], v[76:79], a[16:19]
    ds_read_b64_tr_b16 v[148:149], v22 offset:18688
    v_mfma_f32_16x16x32_bf16 a[20:23], v[124:127], v[80:83], a[20:23]
    ds_read_b64_tr_b16 v[150:151], v22 offset:23296
    s_waitcnt lgkmcnt(10)
    v_mfma_f32_16x16x32_bf16 a[24:27], v[128:131], v[76:79], a[24:27]
    ds_read_b64_tr_b16 v[124:125], v22 offset:27648
    v_mfma_f32_16x16x32_bf16 a[28:31], v[128:131], v[80:83], a[28:31]
    ds_read_b64_tr_b16 v[126:127], v22 offset:32256
    s_waitcnt lgkmcnt(10)
    v_mfma_f32_16x16x32_bf16 a[32:35], v[132:135], v[76:79], a[32:35]
    ds_read_b64_tr_b16 v[128:129], v22 offset:27680
    v_mfma_f32_16x16x32_bf16 a[36:39], v[132:135], v[80:83], a[36:39]
    ds_read_b64_tr_b16 v[130:131], v22 offset:32288
    s_waitcnt lgkmcnt(10)
    v_mfma_f32_16x16x32_bf16 a[40:43], v[136:139], v[76:79], a[40:43]
    ds_read_b64_tr_b16 v[132:133], v22 offset:27712
    v_mfma_f32_16x16x32_bf16 a[44:47], v[136:139], v[80:83], a[44:47]
    ds_read_b64_tr_b16 v[134:135], v22 offset:32320
    s_waitcnt lgkmcnt(10)
    v_mfma_f32_16x16x32_bf16 a[48:51], v[140:143], v[76:79], a[48:51]
    ds_read_b64_tr_b16 v[136:137], v22 offset:27744
    v_mfma_f32_16x16x32_bf16 a[52:55], v[140:143], v[80:83], a[52:55]
    ds_read_b64_tr_b16 v[138:139], v22 offset:32352
    s_waitcnt lgkmcnt(10)
    v_mfma_f32_16x16x32_bf16 a[56:59], v[144:147], v[76:79], a[56:59]
    ds_read_b64_tr_b16 v[140:141], v22 offset:27776
    v_mfma_f32_16x16x32_bf16 a[60:63], v[144:147], v[80:83], a[60:63]
    ds_read_b64_tr_b16 v[142:143], v22 offset:32384
    s_waitcnt lgkmcnt(10)
    v_mfma_f32_16x16x32_bf16 a[64:67], v[148:151], v[76:79], a[64:67]
    ds_read_b64_tr_b16 v[144:145], v22 offset:27808
    v_mfma_f32_16x16x32_bf16 a[68:71], v[148:151], v[80:83], a[68:71]
    ds_read_b64_tr_b16 v[146:147], v22 offset:32416
    s_waitcnt vmcnt(29)
    s_waitcnt lgkmcnt(10)
    v_mfma_f32_16x16x32_bf16 a[0:3], v[124:127], v[84:87], a[0:3]
    ds_read_b64_tr_b16 v[148:149], v22 offset:27840
    ds_read_b64_tr_b16 v[150:151], v22 offset:32448
    v_mfma_f32_16x16x32_bf16 a[4:7], v[124:127], v[88:91], a[4:7]
    s_mov_b32 s39, 18432
    buffer_load_dwordx4 v[76:79], v17, s[24:27], s39 offen
    s_waitcnt lgkmcnt(10)
    v_mfma_f32_16x16x32_bf16 a[8:11], v[128:131], v[84:87], a[8:11]
    ds_read_b64_tr_b16 v[124:125], v22 offset:27872
    ds_read_b64_tr_b16 v[126:127], v22 offset:32480
    v_mfma_f32_16x16x32_bf16 a[12:15], v[128:131], v[88:91], a[12:15]
    s_mov_b32 s39, 18432
    buffer_load_dwordx4 v[80:83], v18, s[24:27], s39 offen
    s_waitcnt vmcnt(8)
    s_barrier
    s_waitcnt lgkmcnt(10)
    v_mfma_f32_16x16x32_bf16 a[16:19], v[132:135], v[84:87], a[16:19]
    ds_read_b64_tr_b16 v[128:129], v22 offset:27904
    ds_read_b64_tr_b16 v[130:131], v22 offset:32512
    v_mfma_f32_16x16x32_bf16 a[20:23], v[132:135], v[88:91], a[20:23]
    s_add_u32 m0, s35, 0
    s_mov_b32 s38, 442368
    buffer_load_dwordx4 v8, s[20:23], s38 offen lds
    s_waitcnt lgkmcnt(10)
    v_mfma_f32_16x16x32_bf16 a[24:27], v[136:139], v[84:87], a[24:27]
    ds_read_b64_tr_b16 v[132:133], v23 offset:0
    ds_read_b64_tr_b16 v[134:135], v23 offset:4608
    v_mfma_f32_16x16x32_bf16 a[28:31], v[136:139], v[88:91], a[28:31]
    s_add_u32 m0, s35, 1024
    s_mov_b32 s38, 442368
    buffer_load_dwordx4 v9, s[20:23], s38 offen lds
    s_waitcnt lgkmcnt(10)
    v_mfma_f32_16x16x32_bf16 a[32:35], v[140:143], v[84:87], a[32:35]
    ds_read_b64_tr_b16 v[136:137], v23 offset:32
    ds_read_b64_tr_b16 v[138:139], v23 offset:4640
    v_mfma_f32_16x16x32_bf16 a[36:39], v[140:143], v[88:91], a[36:39]
    s_add_u32 m0, s35, 2048
    s_mov_b32 s38, 442368
    buffer_load_dwordx4 v10, s[20:23], s38 offen lds
    s_waitcnt lgkmcnt(10)
    v_mfma_f32_16x16x32_bf16 a[40:43], v[144:147], v[84:87], a[40:43]
    ds_read_b64_tr_b16 v[140:141], v23 offset:64
    ds_read_b64_tr_b16 v[142:143], v23 offset:4672
    v_mfma_f32_16x16x32_bf16 a[44:47], v[144:147], v[88:91], a[44:47]
    s_add_u32 m0, s35, 3072
    s_mov_b32 s38, 442368
    buffer_load_dwordx4 v11, s[20:23], s38 offen lds
    s_waitcnt lgkmcnt(10)
    v_mfma_f32_16x16x32_bf16 a[48:51], v[148:151], v[84:87], a[48:51]
    ds_read_b64_tr_b16 v[144:145], v23 offset:96
    ds_read_b64_tr_b16 v[146:147], v23 offset:4704
    v_mfma_f32_16x16x32_bf16 a[52:55], v[148:151], v[88:91], a[52:55]
    s_add_u32 m0, s35, 4096
    s_mov_b32 s38, 442368
    buffer_load_dwordx4 v12, s[20:23], s38 offen lds
    s_waitcnt lgkmcnt(10)
    v_mfma_f32_16x16x32_bf16 a[56:59], v[124:127], v[84:87], a[56:59]
    ds_read_b64_tr_b16 v[148:149], v23 offset:128
    ds_read_b64_tr_b16 v[150:151], v23 offset:4736
    v_mfma_f32_16x16x32_bf16 a[60:63], v[124:127], v[88:91], a[60:63]
    s_add_u32 m0, s35, 5120
    s_mov_b32 s38, 442368
    buffer_load_dwordx4 v13, s[20:23], s38 offen lds
    s_waitcnt lgkmcnt(10)
    v_mfma_f32_16x16x32_bf16 a[64:67], v[128:131], v[84:87], a[64:67]
    ds_read_b64_tr_b16 v[124:125], v23 offset:160
    ds_read_b64_tr_b16 v[126:127], v23 offset:4768
    v_mfma_f32_16x16x32_bf16 a[68:71], v[128:131], v[88:91], a[68:71]
    s_add_u32 m0, s35, 6144
    s_mov_b32 s38, 442368
    buffer_load_dwordx4 v14, s[20:23], s38 offen lds
    s_waitcnt lgkmcnt(10)
    v_mfma_f32_16x16x32_bf16 a[0:3], v[132:135], v[92:95], a[0:3]
    ds_read_b64_tr_b16 v[128:129], v23 offset:192
    ds_read_b64_tr_b16 v[130:131], v23 offset:4800
    v_mfma_f32_16x16x32_bf16 a[4:7], v[132:135], v[96:99], a[4:7]
    s_add_u32 m0, s35, 7168
    s_mov_b32 s38, 442368
    buffer_load_dwordx4 v15, s[20:23], s38 offen lds
    s_waitcnt lgkmcnt(10)
    v_mfma_f32_16x16x32_bf16 a[8:11], v[136:139], v[92:95], a[8:11]
    ds_read_b64_tr_b16 v[132:133], v23 offset:224
    ds_read_b64_tr_b16 v[134:135], v23 offset:4832
    v_mfma_f32_16x16x32_bf16 a[12:15], v[136:139], v[96:99], a[12:15]
    s_add_u32 m0, s35, 8192
    s_mov_b32 s38, 442368
    buffer_load_dwordx4 v16, s[20:23], s38 offen lds
    s_waitcnt lgkmcnt(10)
    v_mfma_f32_16x16x32_bf16 a[16:19], v[140:143], v[92:95], a[16:19]
    ds_read_b64_tr_b16 v[136:137], v23 offset:256
    ds_read_b64_tr_b16 v[138:139], v23 offset:4864
    v_mfma_f32_16x16x32_bf16 a[20:23], v[140:143], v[96:99], a[20:23]
    s_mov_b32 s39, 19456
    buffer_load_dwordx4 v[84:87], v17, s[24:27], s39 offen
    s_waitcnt lgkmcnt(10)
    v_mfma_f32_16x16x32_bf16 a[24:27], v[144:147], v[92:95], a[24:27]
    ds_read_b64_tr_b16 v[140:141], v23 offset:9216
    ds_read_b64_tr_b16 v[142:143], v23 offset:13824
    v_mfma_f32_16x16x32_bf16 a[28:31], v[144:147], v[96:99], a[28:31]
    s_mov_b32 s39, 19456
    buffer_load_dwordx4 v[88:91], v18, s[24:27], s39 offen
    s_waitcnt lgkmcnt(10)
    v_mfma_f32_16x16x32_bf16 a[32:35], v[148:151], v[92:95], a[32:35]
    ds_read_b64_tr_b16 v[144:145], v23 offset:9248
    v_mfma_f32_16x16x32_bf16 a[36:39], v[148:151], v[96:99], a[36:39]
    ds_read_b64_tr_b16 v[146:147], v23 offset:13856
    s_waitcnt lgkmcnt(10)
    v_mfma_f32_16x16x32_bf16 a[40:43], v[124:127], v[92:95], a[40:43]
    ds_read_b64_tr_b16 v[148:149], v23 offset:9280
    v_mfma_f32_16x16x32_bf16 a[44:47], v[124:127], v[96:99], a[44:47]
    ds_read_b64_tr_b16 v[150:151], v23 offset:13888
    s_waitcnt lgkmcnt(10)
    v_mfma_f32_16x16x32_bf16 a[48:51], v[128:131], v[92:95], a[48:51]
    ds_read_b64_tr_b16 v[124:125], v23 offset:9312
    v_mfma_f32_16x16x32_bf16 a[52:55], v[128:131], v[96:99], a[52:55]
    ds_read_b64_tr_b16 v[126:127], v23 offset:13920
    s_waitcnt lgkmcnt(10)
    v_mfma_f32_16x16x32_bf16 a[56:59], v[132:135], v[92:95], a[56:59]
    ds_read_b64_tr_b16 v[128:129], v23 offset:9344
    v_mfma_f32_16x16x32_bf16 a[60:63], v[132:135], v[96:99], a[60:63]
    ds_read_b64_tr_b16 v[130:131], v23 offset:13952
    s_waitcnt lgkmcnt(10)
    v_mfma_f32_16x16x32_bf16 a[64:67], v[136:139], v[92:95], a[64:67]
    ds_read_b64_tr_b16 v[132:133], v23 offset:9376
    v_mfma_f32_16x16x32_bf16 a[68:71], v[136:139], v[96:99], a[68:71]
    ds_read_b64_tr_b16 v[134:135], v23 offset:13984
    s_waitcnt lgkmcnt(10)
    v_mfma_f32_16x16x32_bf16 a[0:3], v[140:143], v[100:103], a[0:3]
    ds_read_b64_tr_b16 v[136:137], v23 offset:9408
    ds_read_b64_tr_b16 v[138:139], v23 offset:14016
    v_mfma_f32_16x16x32_bf16 a[4:7], v[140:143], v[104:107], a[4:7]
    s_mov_b32 s39, 20480
    buffer_load_dwordx4 v[92:95], v17, s[24:27], s39 offen
    s_waitcnt lgkmcnt(10)
    v_mfma_f32_16x16x32_bf16 a[8:11], v[144:147], v[100:103], a[8:11]
    ds_read_b64_tr_b16 v[140:141], v23 offset:9440
    ds_read_b64_tr_b16 v[142:143], v23 offset:14048
    v_mfma_f32_16x16x32_bf16 a[12:15], v[144:147], v[104:107], a[12:15]
    s_mov_b32 s39, 20480
    buffer_load_dwordx4 v[96:99], v18, s[24:27], s39 offen
    s_waitcnt lgkmcnt(10)
    v_mfma_f32_16x16x32_bf16 a[16:19], v[148:151], v[100:103], a[16:19]
    ds_read_b64_tr_b16 v[144:145], v23 offset:9472
    v_mfma_f32_16x16x32_bf16 a[20:23], v[148:151], v[104:107], a[20:23]
    ds_read_b64_tr_b16 v[146:147], v23 offset:14080
    s_waitcnt lgkmcnt(10)
    v_mfma_f32_16x16x32_bf16 a[24:27], v[124:127], v[100:103], a[24:27]
    ds_read_b64_tr_b16 v[148:149], v23 offset:18432
    v_mfma_f32_16x16x32_bf16 a[28:31], v[124:127], v[104:107], a[28:31]
    ds_read_b64_tr_b16 v[150:151], v23 offset:23040
    s_waitcnt lgkmcnt(10)
    v_mfma_f32_16x16x32_bf16 a[32:35], v[128:131], v[100:103], a[32:35]
    ds_read_b64_tr_b16 v[124:125], v23 offset:18464
    v_mfma_f32_16x16x32_bf16 a[36:39], v[128:131], v[104:107], a[36:39]
    ds_read_b64_tr_b16 v[126:127], v23 offset:23072
    s_waitcnt lgkmcnt(10)
    v_mfma_f32_16x16x32_bf16 a[40:43], v[132:135], v[100:103], a[40:43]
    ds_read_b64_tr_b16 v[128:129], v23 offset:18496
    v_mfma_f32_16x16x32_bf16 a[44:47], v[132:135], v[104:107], a[44:47]
    ds_read_b64_tr_b16 v[130:131], v23 offset:23104
    s_waitcnt lgkmcnt(10)
    v_mfma_f32_16x16x32_bf16 a[48:51], v[136:139], v[100:103], a[48:51]
    ds_read_b64_tr_b16 v[132:133], v23 offset:18528
    v_mfma_f32_16x16x32_bf16 a[52:55], v[136:139], v[104:107], a[52:55]
    ds_read_b64_tr_b16 v[134:135], v23 offset:23136
    s_waitcnt lgkmcnt(10)
    v_mfma_f32_16x16x32_bf16 a[56:59], v[140:143], v[100:103], a[56:59]
    ds_read_b64_tr_b16 v[136:137], v23 offset:18560
    v_mfma_f32_16x16x32_bf16 a[60:63], v[140:143], v[104:107], a[60:63]
    ds_read_b64_tr_b16 v[138:139], v23 offset:23168
    s_waitcnt lgkmcnt(10)
    v_mfma_f32_16x16x32_bf16 a[64:67], v[144:147], v[100:103], a[64:67]
    ds_read_b64_tr_b16 v[140:141], v23 offset:18592
    v_mfma_f32_16x16x32_bf16 a[68:71], v[144:147], v[104:107], a[68:71]
    ds_read_b64_tr_b16 v[142:143], v23 offset:23200
    s_waitcnt lgkmcnt(10)
    v_mfma_f32_16x16x32_bf16 a[0:3], v[148:151], v[108:111], a[0:3]
    ds_read_b64_tr_b16 v[144:145], v23 offset:18624
    ds_read_b64_tr_b16 v[146:147], v23 offset:23232
    v_mfma_f32_16x16x32_bf16 a[4:7], v[148:151], v[112:115], a[4:7]
    s_mov_b32 s39, 21504
    buffer_load_dwordx4 v[100:103], v17, s[24:27], s39 offen
    s_waitcnt lgkmcnt(10)
    v_mfma_f32_16x16x32_bf16 a[8:11], v[124:127], v[108:111], a[8:11]
    ds_read_b64_tr_b16 v[148:149], v23 offset:18656
    ds_read_b64_tr_b16 v[150:151], v23 offset:23264
    v_mfma_f32_16x16x32_bf16 a[12:15], v[124:127], v[112:115], a[12:15]
    s_mov_b32 s39, 21504
    buffer_load_dwordx4 v[104:107], v18, s[24:27], s39 offen
    s_waitcnt lgkmcnt(10)
    v_mfma_f32_16x16x32_bf16 a[16:19], v[128:131], v[108:111], a[16:19]
    ds_read_b64_tr_b16 v[124:125], v23 offset:18688
    v_mfma_f32_16x16x32_bf16 a[20:23], v[128:131], v[112:115], a[20:23]
    ds_read_b64_tr_b16 v[126:127], v23 offset:23296
    s_waitcnt lgkmcnt(10)
    v_mfma_f32_16x16x32_bf16 a[24:27], v[132:135], v[108:111], a[24:27]
    ds_read_b64_tr_b16 v[128:129], v23 offset:27648
    v_mfma_f32_16x16x32_bf16 a[28:31], v[132:135], v[112:115], a[28:31]
    ds_read_b64_tr_b16 v[130:131], v23 offset:32256
    s_waitcnt lgkmcnt(10)
    v_mfma_f32_16x16x32_bf16 a[32:35], v[136:139], v[108:111], a[32:35]
    ds_read_b64_tr_b16 v[132:133], v23 offset:27680
    v_mfma_f32_16x16x32_bf16 a[36:39], v[136:139], v[112:115], a[36:39]
    ds_read_b64_tr_b16 v[134:135], v23 offset:32288
    s_waitcnt lgkmcnt(10)
    v_mfma_f32_16x16x32_bf16 a[40:43], v[140:143], v[108:111], a[40:43]
    ds_read_b64_tr_b16 v[136:137], v23 offset:27712
    v_mfma_f32_16x16x32_bf16 a[44:47], v[140:143], v[112:115], a[44:47]
    ds_read_b64_tr_b16 v[138:139], v23 offset:32320
    s_waitcnt lgkmcnt(10)
    v_mfma_f32_16x16x32_bf16 a[48:51], v[144:147], v[108:111], a[48:51]
    ds_read_b64_tr_b16 v[140:141], v23 offset:27744
    v_mfma_f32_16x16x32_bf16 a[52:55], v[144:147], v[112:115], a[52:55]
    ds_read_b64_tr_b16 v[142:143], v23 offset:32352
    s_waitcnt lgkmcnt(10)
    v_mfma_f32_16x16x32_bf16 a[56:59], v[148:151], v[108:111], a[56:59]
    ds_read_b64_tr_b16 v[144:145], v23 offset:27776
    v_mfma_f32_16x16x32_bf16 a[60:63], v[148:151], v[112:115], a[60:63]
    ds_read_b64_tr_b16 v[146:147], v23 offset:32384
    s_waitcnt lgkmcnt(10)
    v_mfma_f32_16x16x32_bf16 a[64:67], v[124:127], v[108:111], a[64:67]
    ds_read_b64_tr_b16 v[148:149], v23 offset:27808
    v_mfma_f32_16x16x32_bf16 a[68:71], v[124:127], v[112:115], a[68:71]
    ds_read_b64_tr_b16 v[150:151], v23 offset:32416
    s_waitcnt lgkmcnt(10)
    v_mfma_f32_16x16x32_bf16 a[0:3], v[128:131], v[116:119], a[0:3]
    ds_read_b64_tr_b16 v[124:125], v23 offset:27840
    ds_read_b64_tr_b16 v[126:127], v23 offset:32448
    v_mfma_f32_16x16x32_bf16 a[4:7], v[128:131], v[120:123], a[4:7]
    s_mov_b32 s39, 22528
    buffer_load_dwordx4 v[108:111], v17, s[24:27], s39 offen
    s_waitcnt lgkmcnt(10)
    v_mfma_f32_16x16x32_bf16 a[8:11], v[132:135], v[116:119], a[8:11]
    ds_read_b64_tr_b16 v[128:129], v23 offset:27872
    ds_read_b64_tr_b16 v[130:131], v23 offset:32480
    v_mfma_f32_16x16x32_bf16 a[12:15], v[132:135], v[120:123], a[12:15]
    s_mov_b32 s39, 22528
    buffer_load_dwordx4 v[112:115], v18, s[24:27], s39 offen
    s_waitcnt vmcnt(8)
    s_barrier
    s_waitcnt lgkmcnt(10)
    v_mfma_f32_16x16x32_bf16 a[16:19], v[136:139], v[116:119], a[16:19]
    ds_read_b64_tr_b16 v[132:133], v23 offset:27904
    ds_read_b64_tr_b16 v[134:135], v23 offset:32512
    v_mfma_f32_16x16x32_bf16 a[20:23], v[136:139], v[120:123], a[20:23]
    s_add_u32 m0, s35, 36864
    s_mov_b32 s38, 589824
    buffer_load_dwordx4 v8, s[20:23], s38 offen lds
    s_waitcnt lgkmcnt(10)
    v_mfma_f32_16x16x32_bf16 a[24:27], v[140:143], v[116:119], a[24:27]
    ds_read_b64_tr_b16 v[136:137], v21 offset:0
    ds_read_b64_tr_b16 v[138:139], v21 offset:4608
    v_mfma_f32_16x16x32_bf16 a[28:31], v[140:143], v[120:123], a[28:31]
    s_add_u32 m0, s35, 37888
    s_mov_b32 s38, 589824
    buffer_load_dwordx4 v9, s[20:23], s38 offen lds
    s_waitcnt lgkmcnt(10)
    v_mfma_f32_16x16x32_bf16 a[32:35], v[144:147], v[116:119], a[32:35]
    ds_read_b64_tr_b16 v[140:141], v21 offset:32
    ds_read_b64_tr_b16 v[142:143], v21 offset:4640
    v_mfma_f32_16x16x32_bf16 a[36:39], v[144:147], v[120:123], a[36:39]
    s_add_u32 m0, s35, 38912
    s_mov_b32 s38, 589824
    buffer_load_dwordx4 v10, s[20:23], s38 offen lds
    s_waitcnt lgkmcnt(10)
    v_mfma_f32_16x16x32_bf16 a[40:43], v[148:151], v[116:119], a[40:43]
    ds_read_b64_tr_b16 v[144:145], v21 offset:64
    ds_read_b64_tr_b16 v[146:147], v21 offset:4672
    v_mfma_f32_16x16x32_bf16 a[44:47], v[148:151], v[120:123], a[44:47]
    s_add_u32 m0, s35, 39936
    s_mov_b32 s38, 589824
    buffer_load_dwordx4 v11, s[20:23], s38 offen lds
    s_waitcnt lgkmcnt(10)
    v_mfma_f32_16x16x32_bf16 a[48:51], v[124:127], v[116:119], a[48:51]
    ds_read_b64_tr_b16 v[148:149], v21 offset:96
    ds_read_b64_tr_b16 v[150:151], v21 offset:4704
    v_mfma_f32_16x16x32_bf16 a[52:55], v[124:127], v[120:123], a[52:55]
    s_add_u32 m0, s35, 40960
    s_mov_b32 s38, 589824
    buffer_load_dwordx4 v12, s[20:23], s38 offen lds
    s_waitcnt lgkmcnt(10)
    v_mfma_f32_16x16x32_bf16 a[56:59], v[128:131], v[116:119], a[56:59]
    ds_read_b64_tr_b16 v[124:125], v21 offset:128
    ds_read_b64_tr_b16 v[126:127], v21 offset:4736
    v_mfma_f32_16x16x32_bf16 a[60:63], v[128:131], v[120:123], a[60:63]
    s_add_u32 m0, s35, 41984
    s_mov_b32 s38, 589824
    buffer_load_dwordx4 v13, s[20:23], s38 offen lds
    s_waitcnt lgkmcnt(10)
    v_mfma_f32_16x16x32_bf16 a[64:67], v[132:135], v[116:119], a[64:67]
    ds_read_b64_tr_b16 v[128:129], v21 offset:160
    ds_read_b64_tr_b16 v[130:131], v21 offset:4768
    v_mfma_f32_16x16x32_bf16 a[68:71], v[132:135], v[120:123], a[68:71]
    s_add_u32 m0, s35, 43008
    s_mov_b32 s38, 589824
    buffer_load_dwordx4 v14, s[20:23], s38 offen lds
    s_waitcnt lgkmcnt(10)
    v_mfma_f32_16x16x32_bf16 a[0:3], v[136:139], v[28:31], a[0:3]
    ds_read_b64_tr_b16 v[132:133], v21 offset:192
    ds_read_b64_tr_b16 v[134:135], v21 offset:4800
    v_mfma_f32_16x16x32_bf16 a[4:7], v[136:139], v[32:35], a[4:7]
    s_add_u32 m0, s35, 44032
    s_mov_b32 s38, 589824
    buffer_load_dwordx4 v15, s[20:23], s38 offen lds
    s_waitcnt lgkmcnt(10)
    v_mfma_f32_16x16x32_bf16 a[8:11], v[140:143], v[28:31], a[8:11]
    ds_read_b64_tr_b16 v[136:137], v21 offset:224
    ds_read_b64_tr_b16 v[138:139], v21 offset:4832
    v_mfma_f32_16x16x32_bf16 a[12:15], v[140:143], v[32:35], a[12:15]
    s_add_u32 m0, s35, 45056
    s_mov_b32 s38, 589824
    buffer_load_dwordx4 v16, s[20:23], s38 offen lds
    s_waitcnt lgkmcnt(10)
    v_mfma_f32_16x16x32_bf16 a[16:19], v[144:147], v[28:31], a[16:19]
    ds_read_b64_tr_b16 v[140:141], v21 offset:256
    ds_read_b64_tr_b16 v[142:143], v21 offset:4864
    v_mfma_f32_16x16x32_bf16 a[20:23], v[144:147], v[32:35], a[20:23]
    s_mov_b32 s39, 23552
    buffer_load_dwordx4 v[116:119], v17, s[24:27], s39 offen
    s_waitcnt lgkmcnt(10)
    v_mfma_f32_16x16x32_bf16 a[24:27], v[148:151], v[28:31], a[24:27]
    ds_read_b64_tr_b16 v[144:145], v21 offset:9216
    ds_read_b64_tr_b16 v[146:147], v21 offset:13824
    v_mfma_f32_16x16x32_bf16 a[28:31], v[148:151], v[32:35], a[28:31]
    s_mov_b32 s39, 23552
    buffer_load_dwordx4 v[120:123], v18, s[24:27], s39 offen
    s_waitcnt lgkmcnt(10)
    v_mfma_f32_16x16x32_bf16 a[32:35], v[124:127], v[28:31], a[32:35]
    ds_read_b64_tr_b16 v[148:149], v21 offset:9248
    v_mfma_f32_16x16x32_bf16 a[36:39], v[124:127], v[32:35], a[36:39]
    ds_read_b64_tr_b16 v[150:151], v21 offset:13856
    s_waitcnt lgkmcnt(10)
    v_mfma_f32_16x16x32_bf16 a[40:43], v[128:131], v[28:31], a[40:43]
    ds_read_b64_tr_b16 v[124:125], v21 offset:9280
    v_mfma_f32_16x16x32_bf16 a[44:47], v[128:131], v[32:35], a[44:47]
    ds_read_b64_tr_b16 v[126:127], v21 offset:13888
    s_waitcnt lgkmcnt(10)
    v_mfma_f32_16x16x32_bf16 a[48:51], v[132:135], v[28:31], a[48:51]
    ds_read_b64_tr_b16 v[128:129], v21 offset:9312
    v_mfma_f32_16x16x32_bf16 a[52:55], v[132:135], v[32:35], a[52:55]
    ds_read_b64_tr_b16 v[130:131], v21 offset:13920
    s_waitcnt lgkmcnt(10)
    v_mfma_f32_16x16x32_bf16 a[56:59], v[136:139], v[28:31], a[56:59]
    ds_read_b64_tr_b16 v[132:133], v21 offset:9344
    v_mfma_f32_16x16x32_bf16 a[60:63], v[136:139], v[32:35], a[60:63]
    ds_read_b64_tr_b16 v[134:135], v21 offset:13952
    s_waitcnt lgkmcnt(10)
    v_mfma_f32_16x16x32_bf16 a[64:67], v[140:143], v[28:31], a[64:67]
    ds_read_b64_tr_b16 v[136:137], v21 offset:9376
    v_mfma_f32_16x16x32_bf16 a[68:71], v[140:143], v[32:35], a[68:71]
    ds_read_b64_tr_b16 v[138:139], v21 offset:13984
    s_waitcnt lgkmcnt(10)
    v_mfma_f32_16x16x32_bf16 a[0:3], v[144:147], v[36:39], a[0:3]
    ds_read_b64_tr_b16 v[140:141], v21 offset:9408
    ds_read_b64_tr_b16 v[142:143], v21 offset:14016
    v_mfma_f32_16x16x32_bf16 a[4:7], v[144:147], v[40:43], a[4:7]
    s_mov_b32 s39, 24576
    buffer_load_dwordx4 v[28:31], v17, s[24:27], s39 offen
    s_waitcnt lgkmcnt(10)
    v_mfma_f32_16x16x32_bf16 a[8:11], v[148:151], v[36:39], a[8:11]
    ds_read_b64_tr_b16 v[144:145], v21 offset:9440
    ds_read_b64_tr_b16 v[146:147], v21 offset:14048
    v_mfma_f32_16x16x32_bf16 a[12:15], v[148:151], v[40:43], a[12:15]
    s_mov_b32 s39, 24576
    buffer_load_dwordx4 v[32:35], v18, s[24:27], s39 offen
    s_waitcnt lgkmcnt(10)
    v_mfma_f32_16x16x32_bf16 a[16:19], v[124:127], v[36:39], a[16:19]
    ds_read_b64_tr_b16 v[148:149], v21 offset:9472
    v_mfma_f32_16x16x32_bf16 a[20:23], v[124:127], v[40:43], a[20:23]
    ds_read_b64_tr_b16 v[150:151], v21 offset:14080
    s_waitcnt lgkmcnt(10)
    v_mfma_f32_16x16x32_bf16 a[24:27], v[128:131], v[36:39], a[24:27]
    ds_read_b64_tr_b16 v[124:125], v21 offset:18432
    v_mfma_f32_16x16x32_bf16 a[28:31], v[128:131], v[40:43], a[28:31]
    ds_read_b64_tr_b16 v[126:127], v21 offset:23040
    s_waitcnt lgkmcnt(10)
    v_mfma_f32_16x16x32_bf16 a[32:35], v[132:135], v[36:39], a[32:35]
    ds_read_b64_tr_b16 v[128:129], v21 offset:18464
    v_mfma_f32_16x16x32_bf16 a[36:39], v[132:135], v[40:43], a[36:39]
    ds_read_b64_tr_b16 v[130:131], v21 offset:23072
    s_waitcnt lgkmcnt(10)
    v_mfma_f32_16x16x32_bf16 a[40:43], v[136:139], v[36:39], a[40:43]
    ds_read_b64_tr_b16 v[132:133], v21 offset:18496
    v_mfma_f32_16x16x32_bf16 a[44:47], v[136:139], v[40:43], a[44:47]
    ds_read_b64_tr_b16 v[134:135], v21 offset:23104
    s_waitcnt lgkmcnt(10)
    v_mfma_f32_16x16x32_bf16 a[48:51], v[140:143], v[36:39], a[48:51]
    ds_read_b64_tr_b16 v[136:137], v21 offset:18528
    v_mfma_f32_16x16x32_bf16 a[52:55], v[140:143], v[40:43], a[52:55]
    ds_read_b64_tr_b16 v[138:139], v21 offset:23136
    s_waitcnt lgkmcnt(10)
    v_mfma_f32_16x16x32_bf16 a[56:59], v[144:147], v[36:39], a[56:59]
    ds_read_b64_tr_b16 v[140:141], v21 offset:18560
    v_mfma_f32_16x16x32_bf16 a[60:63], v[144:147], v[40:43], a[60:63]
    ds_read_b64_tr_b16 v[142:143], v21 offset:23168
    s_waitcnt lgkmcnt(10)
    v_mfma_f32_16x16x32_bf16 a[64:67], v[148:151], v[36:39], a[64:67]
    ds_read_b64_tr_b16 v[144:145], v21 offset:18592
    v_mfma_f32_16x16x32_bf16 a[68:71], v[148:151], v[40:43], a[68:71]
    ds_read_b64_tr_b16 v[146:147], v21 offset:23200
    s_waitcnt lgkmcnt(10)
    v_mfma_f32_16x16x32_bf16 a[0:3], v[124:127], v[44:47], a[0:3]
    ds_read_b64_tr_b16 v[148:149], v21 offset:18624
    ds_read_b64_tr_b16 v[150:151], v21 offset:23232
    v_mfma_f32_16x16x32_bf16 a[4:7], v[124:127], v[48:51], a[4:7]
    s_mov_b32 s39, 25600
    buffer_load_dwordx4 v[36:39], v17, s[24:27], s39 offen
    s_waitcnt lgkmcnt(10)
    v_mfma_f32_16x16x32_bf16 a[8:11], v[128:131], v[44:47], a[8:11]
    ds_read_b64_tr_b16 v[124:125], v21 offset:18656
    ds_read_b64_tr_b16 v[126:127], v21 offset:23264
    v_mfma_f32_16x16x32_bf16 a[12:15], v[128:131], v[48:51], a[12:15]
    s_mov_b32 s39, 25600
    buffer_load_dwordx4 v[40:43], v18, s[24:27], s39 offen
    s_waitcnt lgkmcnt(10)
    v_mfma_f32_16x16x32_bf16 a[16:19], v[132:135], v[44:47], a[16:19]
    ds_read_b64_tr_b16 v[128:129], v21 offset:18688
    v_mfma_f32_16x16x32_bf16 a[20:23], v[132:135], v[48:51], a[20:23]
    ds_read_b64_tr_b16 v[130:131], v21 offset:23296
    s_waitcnt lgkmcnt(10)
    v_mfma_f32_16x16x32_bf16 a[24:27], v[136:139], v[44:47], a[24:27]
    ds_read_b64_tr_b16 v[132:133], v21 offset:27648
    v_mfma_f32_16x16x32_bf16 a[28:31], v[136:139], v[48:51], a[28:31]
    ds_read_b64_tr_b16 v[134:135], v21 offset:32256
    s_waitcnt lgkmcnt(10)
    v_mfma_f32_16x16x32_bf16 a[32:35], v[140:143], v[44:47], a[32:35]
    ds_read_b64_tr_b16 v[136:137], v21 offset:27680
    v_mfma_f32_16x16x32_bf16 a[36:39], v[140:143], v[48:51], a[36:39]
    ds_read_b64_tr_b16 v[138:139], v21 offset:32288
    s_waitcnt lgkmcnt(10)
    v_mfma_f32_16x16x32_bf16 a[40:43], v[144:147], v[44:47], a[40:43]
    ds_read_b64_tr_b16 v[140:141], v21 offset:27712
    v_mfma_f32_16x16x32_bf16 a[44:47], v[144:147], v[48:51], a[44:47]
    ds_read_b64_tr_b16 v[142:143], v21 offset:32320
    s_waitcnt lgkmcnt(10)
    v_mfma_f32_16x16x32_bf16 a[48:51], v[148:151], v[44:47], a[48:51]
    ds_read_b64_tr_b16 v[144:145], v21 offset:27744
    v_mfma_f32_16x16x32_bf16 a[52:55], v[148:151], v[48:51], a[52:55]
    ds_read_b64_tr_b16 v[146:147], v21 offset:32352
    s_waitcnt lgkmcnt(10)
    v_mfma_f32_16x16x32_bf16 a[56:59], v[124:127], v[44:47], a[56:59]
    ds_read_b64_tr_b16 v[148:149], v21 offset:27776
    v_mfma_f32_16x16x32_bf16 a[60:63], v[124:127], v[48:51], a[60:63]
    ds_read_b64_tr_b16 v[150:151], v21 offset:32384
    s_waitcnt lgkmcnt(10)
    v_mfma_f32_16x16x32_bf16 a[64:67], v[128:131], v[44:47], a[64:67]
    ds_read_b64_tr_b16 v[124:125], v21 offset:27808
    v_mfma_f32_16x16x32_bf16 a[68:71], v[128:131], v[48:51], a[68:71]
    ds_read_b64_tr_b16 v[126:127], v21 offset:32416
    s_waitcnt lgkmcnt(10)
    v_mfma_f32_16x16x32_bf16 a[0:3], v[132:135], v[52:55], a[0:3]
    ds_read_b64_tr_b16 v[128:129], v21 offset:27840
    ds_read_b64_tr_b16 v[130:131], v21 offset:32448
    v_mfma_f32_16x16x32_bf16 a[4:7], v[132:135], v[56:59], a[4:7]
    s_mov_b32 s39, 26624
    buffer_load_dwordx4 v[44:47], v17, s[24:27], s39 offen
    s_waitcnt lgkmcnt(10)
    v_mfma_f32_16x16x32_bf16 a[8:11], v[136:139], v[52:55], a[8:11]
    ds_read_b64_tr_b16 v[132:133], v21 offset:27872
    ds_read_b64_tr_b16 v[134:135], v21 offset:32480
    v_mfma_f32_16x16x32_bf16 a[12:15], v[136:139], v[56:59], a[12:15]
    s_mov_b32 s39, 26624
    buffer_load_dwordx4 v[48:51], v18, s[24:27], s39 offen
    s_waitcnt vmcnt(8)
    s_barrier
    s_waitcnt lgkmcnt(10)
    v_mfma_f32_16x16x32_bf16 a[16:19], v[140:143], v[52:55], a[16:19]
    ds_read_b64_tr_b16 v[136:137], v21 offset:27904
    ds_read_b64_tr_b16 v[138:139], v21 offset:32512
    v_mfma_f32_16x16x32_bf16 a[20:23], v[140:143], v[56:59], a[20:23]
    s_add_u32 m0, s35, 73728
    s_mov_b32 s38, 737280
    buffer_load_dwordx4 v8, s[20:23], s38 offen lds
    s_waitcnt lgkmcnt(10)
    v_mfma_f32_16x16x32_bf16 a[24:27], v[144:147], v[52:55], a[24:27]
    ds_read_b64_tr_b16 v[140:141], v22 offset:0
    ds_read_b64_tr_b16 v[142:143], v22 offset:4608
    v_mfma_f32_16x16x32_bf16 a[28:31], v[144:147], v[56:59], a[28:31]
    s_add_u32 m0, s35, 74752
    s_mov_b32 s38, 737280
    buffer_load_dwordx4 v9, s[20:23], s38 offen lds
    s_waitcnt lgkmcnt(10)
    v_mfma_f32_16x16x32_bf16 a[32:35], v[148:151], v[52:55], a[32:35]
    ds_read_b64_tr_b16 v[144:145], v22 offset:32
    ds_read_b64_tr_b16 v[146:147], v22 offset:4640
    v_mfma_f32_16x16x32_bf16 a[36:39], v[148:151], v[56:59], a[36:39]
    s_add_u32 m0, s35, 75776
    s_mov_b32 s38, 737280
    buffer_load_dwordx4 v10, s[20:23], s38 offen lds
    s_waitcnt lgkmcnt(10)
    v_mfma_f32_16x16x32_bf16 a[40:43], v[124:127], v[52:55], a[40:43]
    ds_read_b64_tr_b16 v[148:149], v22 offset:64
    ds_read_b64_tr_b16 v[150:151], v22 offset:4672
    v_mfma_f32_16x16x32_bf16 a[44:47], v[124:127], v[56:59], a[44:47]
    s_add_u32 m0, s35, 76800
    s_mov_b32 s38, 737280
    buffer_load_dwordx4 v11, s[20:23], s38 offen lds
    s_waitcnt lgkmcnt(10)
    v_mfma_f32_16x16x32_bf16 a[48:51], v[128:131], v[52:55], a[48:51]
    ds_read_b64_tr_b16 v[124:125], v22 offset:96
    ds_read_b64_tr_b16 v[126:127], v22 offset:4704
    v_mfma_f32_16x16x32_bf16 a[52:55], v[128:131], v[56:59], a[52:55]
    s_add_u32 m0, s35, 77824
    s_mov_b32 s38, 737280
    buffer_load_dwordx4 v12, s[20:23], s38 offen lds
    s_waitcnt lgkmcnt(10)
    v_mfma_f32_16x16x32_bf16 a[56:59], v[132:135], v[52:55], a[56:59]
    ds_read_b64_tr_b16 v[128:129], v22 offset:128
    ds_read_b64_tr_b16 v[130:131], v22 offset:4736
    v_mfma_f32_16x16x32_bf16 a[60:63], v[132:135], v[56:59], a[60:63]
    s_add_u32 m0, s35, 78848
    s_mov_b32 s38, 737280
    buffer_load_dwordx4 v13, s[20:23], s38 offen lds
    s_waitcnt lgkmcnt(10)
    v_mfma_f32_16x16x32_bf16 a[64:67], v[136:139], v[52:55], a[64:67]
    ds_read_b64_tr_b16 v[132:133], v22 offset:160
    ds_read_b64_tr_b16 v[134:135], v22 offset:4768
    v_mfma_f32_16x16x32_bf16 a[68:71], v[136:139], v[56:59], a[68:71]
    s_add_u32 m0, s35, 79872
    s_mov_b32 s38, 737280
    buffer_load_dwordx4 v14, s[20:23], s38 offen lds
    s_waitcnt lgkmcnt(10)
    v_mfma_f32_16x16x32_bf16 a[0:3], v[140:143], v[60:63], a[0:3]
    ds_read_b64_tr_b16 v[136:137], v22 offset:192
    ds_read_b64_tr_b16 v[138:139], v22 offset:4800
    v_mfma_f32_16x16x32_bf16 a[4:7], v[140:143], v[64:67], a[4:7]
    s_add_u32 m0, s35, 80896
    s_mov_b32 s38, 737280
    buffer_load_dwordx4 v15, s[20:23], s38 offen lds
    s_waitcnt lgkmcnt(10)
    v_mfma_f32_16x16x32_bf16 a[8:11], v[144:147], v[60:63], a[8:11]
    ds_read_b64_tr_b16 v[140:141], v22 offset:224
    ds_read_b64_tr_b16 v[142:143], v22 offset:4832
    v_mfma_f32_16x16x32_bf16 a[12:15], v[144:147], v[64:67], a[12:15]
    s_add_u32 m0, s35, 81920
    s_mov_b32 s38, 737280
    buffer_load_dwordx4 v16, s[20:23], s38 offen lds
    s_waitcnt lgkmcnt(10)
    v_mfma_f32_16x16x32_bf16 a[16:19], v[148:151], v[60:63], a[16:19]
    ds_read_b64_tr_b16 v[144:145], v22 offset:256
    ds_read_b64_tr_b16 v[146:147], v22 offset:4864
    v_mfma_f32_16x16x32_bf16 a[20:23], v[148:151], v[64:67], a[20:23]
    s_mov_b32 s39, 27648
    buffer_load_dwordx4 v[52:55], v17, s[24:27], s39 offen
    s_waitcnt lgkmcnt(10)
    v_mfma_f32_16x16x32_bf16 a[24:27], v[124:127], v[60:63], a[24:27]
    ds_read_b64_tr_b16 v[148:149], v22 offset:9216
    ds_read_b64_tr_b16 v[150:151], v22 offset:13824
    v_mfma_f32_16x16x32_bf16 a[28:31], v[124:127], v[64:67], a[28:31]
    s_mov_b32 s39, 27648
    buffer_load_dwordx4 v[56:59], v18, s[24:27], s39 offen
    s_waitcnt lgkmcnt(10)
    v_mfma_f32_16x16x32_bf16 a[32:35], v[128:131], v[60:63], a[32:35]
    ds_read_b64_tr_b16 v[124:125], v22 offset:9248
    v_mfma_f32_16x16x32_bf16 a[36:39], v[128:131], v[64:67], a[36:39]
    ds_read_b64_tr_b16 v[126:127], v22 offset:13856
    s_waitcnt lgkmcnt(10)
    v_mfma_f32_16x16x32_bf16 a[40:43], v[132:135], v[60:63], a[40:43]
    ds_read_b64_tr_b16 v[128:129], v22 offset:9280
    v_mfma_f32_16x16x32_bf16 a[44:47], v[132:135], v[64:67], a[44:47]
    ds_read_b64_tr_b16 v[130:131], v22 offset:13888
    s_waitcnt lgkmcnt(10)
    v_mfma_f32_16x16x32_bf16 a[48:51], v[136:139], v[60:63], a[48:51]
    ds_read_b64_tr_b16 v[132:133], v22 offset:9312
    v_mfma_f32_16x16x32_bf16 a[52:55], v[136:139], v[64:67], a[52:55]
    ds_read_b64_tr_b16 v[134:135], v22 offset:13920
    s_waitcnt lgkmcnt(10)
    v_mfma_f32_16x16x32_bf16 a[56:59], v[140:143], v[60:63], a[56:59]
    ds_read_b64_tr_b16 v[136:137], v22 offset:9344
    v_mfma_f32_16x16x32_bf16 a[60:63], v[140:143], v[64:67], a[60:63]
    ds_read_b64_tr_b16 v[138:139], v22 offset:13952
    s_waitcnt lgkmcnt(10)
    v_mfma_f32_16x16x32_bf16 a[64:67], v[144:147], v[60:63], a[64:67]
    ds_read_b64_tr_b16 v[140:141], v22 offset:9376
    v_mfma_f32_16x16x32_bf16 a[68:71], v[144:147], v[64:67], a[68:71]
    ds_read_b64_tr_b16 v[142:143], v22 offset:13984
    s_waitcnt lgkmcnt(10)
    v_mfma_f32_16x16x32_bf16 a[0:3], v[148:151], v[68:71], a[0:3]
    ds_read_b64_tr_b16 v[144:145], v22 offset:9408
    ds_read_b64_tr_b16 v[146:147], v22 offset:14016
    v_mfma_f32_16x16x32_bf16 a[4:7], v[148:151], v[72:75], a[4:7]
    s_mov_b32 s39, 28672
    buffer_load_dwordx4 v[60:63], v17, s[24:27], s39 offen
    s_waitcnt lgkmcnt(10)
    v_mfma_f32_16x16x32_bf16 a[8:11], v[124:127], v[68:71], a[8:11]
    ds_read_b64_tr_b16 v[148:149], v22 offset:9440
    ds_read_b64_tr_b16 v[150:151], v22 offset:14048
    v_mfma_f32_16x16x32_bf16 a[12:15], v[124:127], v[72:75], a[12:15]
    s_mov_b32 s39, 28672
    buffer_load_dwordx4 v[64:67], v18, s[24:27], s39 offen
    s_waitcnt lgkmcnt(10)
    v_mfma_f32_16x16x32_bf16 a[16:19], v[128:131], v[68:71], a[16:19]
    ds_read_b64_tr_b16 v[124:125], v22 offset:9472
    v_mfma_f32_16x16x32_bf16 a[20:23], v[128:131], v[72:75], a[20:23]
    ds_read_b64_tr_b16 v[126:127], v22 offset:14080
    s_waitcnt lgkmcnt(10)
    v_mfma_f32_16x16x32_bf16 a[24:27], v[132:135], v[68:71], a[24:27]
    ds_read_b64_tr_b16 v[128:129], v22 offset:18432
    v_mfma_f32_16x16x32_bf16 a[28:31], v[132:135], v[72:75], a[28:31]
    ds_read_b64_tr_b16 v[130:131], v22 offset:23040
    s_waitcnt lgkmcnt(10)
    v_mfma_f32_16x16x32_bf16 a[32:35], v[136:139], v[68:71], a[32:35]
    ds_read_b64_tr_b16 v[132:133], v22 offset:18464
    v_mfma_f32_16x16x32_bf16 a[36:39], v[136:139], v[72:75], a[36:39]
    ds_read_b64_tr_b16 v[134:135], v22 offset:23072
    s_waitcnt lgkmcnt(10)
    v_mfma_f32_16x16x32_bf16 a[40:43], v[140:143], v[68:71], a[40:43]
    ds_read_b64_tr_b16 v[136:137], v22 offset:18496
    v_mfma_f32_16x16x32_bf16 a[44:47], v[140:143], v[72:75], a[44:47]
    ds_read_b64_tr_b16 v[138:139], v22 offset:23104
    s_waitcnt lgkmcnt(10)
    v_mfma_f32_16x16x32_bf16 a[48:51], v[144:147], v[68:71], a[48:51]
    ds_read_b64_tr_b16 v[140:141], v22 offset:18528
    v_mfma_f32_16x16x32_bf16 a[52:55], v[144:147], v[72:75], a[52:55]
    ds_read_b64_tr_b16 v[142:143], v22 offset:23136
    s_waitcnt lgkmcnt(10)
    v_mfma_f32_16x16x32_bf16 a[56:59], v[148:151], v[68:71], a[56:59]
    ds_read_b64_tr_b16 v[144:145], v22 offset:18560
    v_mfma_f32_16x16x32_bf16 a[60:63], v[148:151], v[72:75], a[60:63]
    ds_read_b64_tr_b16 v[146:147], v22 offset:23168
    s_waitcnt lgkmcnt(10)
    v_mfma_f32_16x16x32_bf16 a[64:67], v[124:127], v[68:71], a[64:67]
    ds_read_b64_tr_b16 v[148:149], v22 offset:18592
    v_mfma_f32_16x16x32_bf16 a[68:71], v[124:127], v[72:75], a[68:71]
    ds_read_b64_tr_b16 v[150:151], v22 offset:23200
    s_waitcnt lgkmcnt(10)
    v_mfma_f32_16x16x32_bf16 a[0:3], v[128:131], v[76:79], a[0:3]
    ds_read_b64_tr_b16 v[124:125], v22 offset:18624
    ds_read_b64_tr_b16 v[126:127], v22 offset:23232
    v_mfma_f32_16x16x32_bf16 a[4:7], v[128:131], v[80:83], a[4:7]
    s_mov_b32 s39, 29696
    buffer_load_dwordx4 v[68:71], v17, s[24:27], s39 offen
    s_waitcnt lgkmcnt(10)
    v_mfma_f32_16x16x32_bf16 a[8:11], v[132:135], v[76:79], a[8:11]
    ds_read_b64_tr_b16 v[128:129], v22 offset:18656
    ds_read_b64_tr_b16 v[130:131], v22 offset:23264
    v_mfma_f32_16x16x32_bf16 a[12:15], v[132:135], v[80:83], a[12:15]
    s_mov_b32 s39, 29696
    buffer_load_dwordx4 v[72:75], v18, s[24:27], s39 offen
    s_waitcnt lgkmcnt(10)
    v_mfma_f32_16x16x32_bf16 a[16:19], v[136:139], v[76:79], a[16:19]
    ds_read_b64_tr_b16 v[132:133], v22 offset:18688
    v_mfma_f32_16x16x32_bf16 a[20:23], v[136:139], v[80:83], a[20:23]
    ds_read_b64_tr_b16 v[134:135], v22 offset:23296
    s_waitcnt lgkmcnt(10)
    v_mfma_f32_16x16x32_bf16 a[24:27], v[140:143], v[76:79], a[24:27]
    ds_read_b64_tr_b16 v[136:137], v22 offset:27648
    v_mfma_f32_16x16x32_bf16 a[28:31], v[140:143], v[80:83], a[28:31]
    ds_read_b64_tr_b16 v[138:139], v22 offset:32256
    s_waitcnt lgkmcnt(10)
    v_mfma_f32_16x16x32_bf16 a[32:35], v[144:147], v[76:79], a[32:35]
    ds_read_b64_tr_b16 v[140:141], v22 offset:27680
    v_mfma_f32_16x16x32_bf16 a[36:39], v[144:147], v[80:83], a[36:39]
    ds_read_b64_tr_b16 v[142:143], v22 offset:32288
    s_waitcnt lgkmcnt(10)
    v_mfma_f32_16x16x32_bf16 a[40:43], v[148:151], v[76:79], a[40:43]
    ds_read_b64_tr_b16 v[144:145], v22 offset:27712
    v_mfma_f32_16x16x32_bf16 a[44:47], v[148:151], v[80:83], a[44:47]
    ds_read_b64_tr_b16 v[146:147], v22 offset:32320
    s_waitcnt lgkmcnt(10)
    v_mfma_f32_16x16x32_bf16 a[48:51], v[124:127], v[76:79], a[48:51]
    ds_read_b64_tr_b16 v[148:149], v22 offset:27744
    v_mfma_f32_16x16x32_bf16 a[52:55], v[124:127], v[80:83], a[52:55]
    ds_read_b64_tr_b16 v[150:151], v22 offset:32352
    s_waitcnt lgkmcnt(10)
    v_mfma_f32_16x16x32_bf16 a[56:59], v[128:131], v[76:79], a[56:59]
    ds_read_b64_tr_b16 v[124:125], v22 offset:27776
    v_mfma_f32_16x16x32_bf16 a[60:63], v[128:131], v[80:83], a[60:63]
    ds_read_b64_tr_b16 v[126:127], v22 offset:32384
    s_waitcnt lgkmcnt(10)
    v_mfma_f32_16x16x32_bf16 a[64:67], v[132:135], v[76:79], a[64:67]
    ds_read_b64_tr_b16 v[128:129], v22 offset:27808
    v_mfma_f32_16x16x32_bf16 a[68:71], v[132:135], v[80:83], a[68:71]
    ds_read_b64_tr_b16 v[130:131], v22 offset:32416
    s_waitcnt lgkmcnt(10)
    v_mfma_f32_16x16x32_bf16 a[0:3], v[136:139], v[84:87], a[0:3]
    ds_read_b64_tr_b16 v[132:133], v22 offset:27840
    ds_read_b64_tr_b16 v[134:135], v22 offset:32448
    v_mfma_f32_16x16x32_bf16 a[4:7], v[136:139], v[88:91], a[4:7]
    s_mov_b32 s39, 30720
    buffer_load_dwordx4 v[76:79], v17, s[24:27], s39 offen
    s_waitcnt lgkmcnt(10)
    v_mfma_f32_16x16x32_bf16 a[8:11], v[140:143], v[84:87], a[8:11]
    ds_read_b64_tr_b16 v[136:137], v22 offset:27872
    ds_read_b64_tr_b16 v[138:139], v22 offset:32480
    v_mfma_f32_16x16x32_bf16 a[12:15], v[140:143], v[88:91], a[12:15]
    s_mov_b32 s39, 30720
    buffer_load_dwordx4 v[80:83], v18, s[24:27], s39 offen
    s_waitcnt vmcnt(8)
    s_barrier
    s_waitcnt lgkmcnt(10)
    v_mfma_f32_16x16x32_bf16 a[16:19], v[144:147], v[84:87], a[16:19]
    ds_read_b64_tr_b16 v[140:141], v22 offset:27904
    ds_read_b64_tr_b16 v[142:143], v22 offset:32512
    v_mfma_f32_16x16x32_bf16 a[20:23], v[144:147], v[88:91], a[20:23]
    s_add_u32 m0, s35, 0
    s_mov_b32 s38, 884736
    buffer_load_dwordx4 v8, s[20:23], s38 offen lds
    s_waitcnt lgkmcnt(10)
    v_mfma_f32_16x16x32_bf16 a[24:27], v[148:151], v[84:87], a[24:27]
    ds_read_b64_tr_b16 v[144:145], v23 offset:0
    ds_read_b64_tr_b16 v[146:147], v23 offset:4608
    v_mfma_f32_16x16x32_bf16 a[28:31], v[148:151], v[88:91], a[28:31]
    s_add_u32 m0, s35, 1024
    s_mov_b32 s38, 884736
    buffer_load_dwordx4 v9, s[20:23], s38 offen lds
    s_waitcnt lgkmcnt(10)
    v_mfma_f32_16x16x32_bf16 a[32:35], v[124:127], v[84:87], a[32:35]
    ds_read_b64_tr_b16 v[148:149], v23 offset:32
    ds_read_b64_tr_b16 v[150:151], v23 offset:4640
    v_mfma_f32_16x16x32_bf16 a[36:39], v[124:127], v[88:91], a[36:39]
    s_add_u32 m0, s35, 2048
    s_mov_b32 s38, 884736
    buffer_load_dwordx4 v10, s[20:23], s38 offen lds
    s_waitcnt lgkmcnt(10)
    v_mfma_f32_16x16x32_bf16 a[40:43], v[128:131], v[84:87], a[40:43]
    ds_read_b64_tr_b16 v[124:125], v23 offset:64
    ds_read_b64_tr_b16 v[126:127], v23 offset:4672
    v_mfma_f32_16x16x32_bf16 a[44:47], v[128:131], v[88:91], a[44:47]
    s_add_u32 m0, s35, 3072
    s_mov_b32 s38, 884736
    buffer_load_dwordx4 v11, s[20:23], s38 offen lds
    s_waitcnt lgkmcnt(10)
    v_mfma_f32_16x16x32_bf16 a[48:51], v[132:135], v[84:87], a[48:51]
    ds_read_b64_tr_b16 v[128:129], v23 offset:96
    ds_read_b64_tr_b16 v[130:131], v23 offset:4704
    v_mfma_f32_16x16x32_bf16 a[52:55], v[132:135], v[88:91], a[52:55]
    s_add_u32 m0, s35, 4096
    s_mov_b32 s38, 884736
    buffer_load_dwordx4 v12, s[20:23], s38 offen lds
    s_waitcnt lgkmcnt(10)
    v_mfma_f32_16x16x32_bf16 a[56:59], v[136:139], v[84:87], a[56:59]
    ds_read_b64_tr_b16 v[132:133], v23 offset:128
    ds_read_b64_tr_b16 v[134:135], v23 offset:4736
    v_mfma_f32_16x16x32_bf16 a[60:63], v[136:139], v[88:91], a[60:63]
    s_add_u32 m0, s35, 5120
    s_mov_b32 s38, 884736
    buffer_load_dwordx4 v13, s[20:23], s38 offen lds
    s_waitcnt lgkmcnt(10)
    v_mfma_f32_16x16x32_bf16 a[64:67], v[140:143], v[84:87], a[64:67]
    ds_read_b64_tr_b16 v[136:137], v23 offset:160
    ds_read_b64_tr_b16 v[138:139], v23 offset:4768
    v_mfma_f32_16x16x32_bf16 a[68:71], v[140:143], v[88:91], a[68:71]
    s_add_u32 m0, s35, 6144
    s_mov_b32 s38, 884736
    buffer_load_dwordx4 v14, s[20:23], s38 offen lds
    s_waitcnt lgkmcnt(10)
    v_mfma_f32_16x16x32_bf16 a[0:3], v[144:147], v[92:95], a[0:3]
    ds_read_b64_tr_b16 v[140:141], v23 offset:192
    ds_read_b64_tr_b16 v[142:143], v23 offset:4800
    v_mfma_f32_16x16x32_bf16 a[4:7], v[144:147], v[96:99], a[4:7]
    s_add_u32 m0, s35, 7168
    s_mov_b32 s38, 884736
    buffer_load_dwordx4 v15, s[20:23], s38 offen lds
    s_waitcnt lgkmcnt(10)
    v_mfma_f32_16x16x32_bf16 a[8:11], v[148:151], v[92:95], a[8:11]
    ds_read_b64_tr_b16 v[144:145], v23 offset:224
    ds_read_b64_tr_b16 v[146:147], v23 offset:4832
    v_mfma_f32_16x16x32_bf16 a[12:15], v[148:151], v[96:99], a[12:15]
    s_add_u32 m0, s35, 8192
    s_mov_b32 s38, 884736
    buffer_load_dwordx4 v16, s[20:23], s38 offen lds
    s_waitcnt lgkmcnt(10)
    v_mfma_f32_16x16x32_bf16 a[16:19], v[124:127], v[92:95], a[16:19]
    ds_read_b64_tr_b16 v[148:149], v23 offset:256
    ds_read_b64_tr_b16 v[150:151], v23 offset:4864
    v_mfma_f32_16x16x32_bf16 a[20:23], v[124:127], v[96:99], a[20:23]
    s_mov_b32 s39, 31744
    buffer_load_dwordx4 v[84:87], v17, s[24:27], s39 offen
    s_waitcnt lgkmcnt(10)
    v_mfma_f32_16x16x32_bf16 a[24:27], v[128:131], v[92:95], a[24:27]
    ds_read_b64_tr_b16 v[124:125], v23 offset:9216
    ds_read_b64_tr_b16 v[126:127], v23 offset:13824
    v_mfma_f32_16x16x32_bf16 a[28:31], v[128:131], v[96:99], a[28:31]
    s_mov_b32 s39, 31744
    buffer_load_dwordx4 v[88:91], v18, s[24:27], s39 offen
    s_waitcnt lgkmcnt(10)
    v_mfma_f32_16x16x32_bf16 a[32:35], v[132:135], v[92:95], a[32:35]
    ds_read_b64_tr_b16 v[128:129], v23 offset:9248
    v_mfma_f32_16x16x32_bf16 a[36:39], v[132:135], v[96:99], a[36:39]
    ds_read_b64_tr_b16 v[130:131], v23 offset:13856
    s_waitcnt lgkmcnt(10)
    v_mfma_f32_16x16x32_bf16 a[40:43], v[136:139], v[92:95], a[40:43]
    ds_read_b64_tr_b16 v[132:133], v23 offset:9280
    v_mfma_f32_16x16x32_bf16 a[44:47], v[136:139], v[96:99], a[44:47]
    ds_read_b64_tr_b16 v[134:135], v23 offset:13888
    s_waitcnt lgkmcnt(10)
    v_mfma_f32_16x16x32_bf16 a[48:51], v[140:143], v[92:95], a[48:51]
    ds_read_b64_tr_b16 v[136:137], v23 offset:9312
    v_mfma_f32_16x16x32_bf16 a[52:55], v[140:143], v[96:99], a[52:55]
    ds_read_b64_tr_b16 v[138:139], v23 offset:13920
    s_waitcnt lgkmcnt(10)
    v_mfma_f32_16x16x32_bf16 a[56:59], v[144:147], v[92:95], a[56:59]
    ds_read_b64_tr_b16 v[140:141], v23 offset:9344
    v_mfma_f32_16x16x32_bf16 a[60:63], v[144:147], v[96:99], a[60:63]
    ds_read_b64_tr_b16 v[142:143], v23 offset:13952
    s_waitcnt lgkmcnt(10)
    v_mfma_f32_16x16x32_bf16 a[64:67], v[148:151], v[92:95], a[64:67]
    ds_read_b64_tr_b16 v[144:145], v23 offset:9376
    v_mfma_f32_16x16x32_bf16 a[68:71], v[148:151], v[96:99], a[68:71]
    ds_read_b64_tr_b16 v[146:147], v23 offset:13984
    s_waitcnt lgkmcnt(10)
    v_mfma_f32_16x16x32_bf16 a[0:3], v[124:127], v[100:103], a[0:3]
    ds_read_b64_tr_b16 v[148:149], v23 offset:9408
    ds_read_b64_tr_b16 v[150:151], v23 offset:14016
    v_mfma_f32_16x16x32_bf16 a[4:7], v[124:127], v[104:107], a[4:7]
    s_mov_b32 s39, 32768
    buffer_load_dwordx4 v[92:95], v17, s[24:27], s39 offen
    s_waitcnt lgkmcnt(10)
    v_mfma_f32_16x16x32_bf16 a[8:11], v[128:131], v[100:103], a[8:11]
    ds_read_b64_tr_b16 v[124:125], v23 offset:9440
    ds_read_b64_tr_b16 v[126:127], v23 offset:14048
    v_mfma_f32_16x16x32_bf16 a[12:15], v[128:131], v[104:107], a[12:15]
    s_mov_b32 s39, 32768
    buffer_load_dwordx4 v[96:99], v18, s[24:27], s39 offen
    s_waitcnt lgkmcnt(10)
    v_mfma_f32_16x16x32_bf16 a[16:19], v[132:135], v[100:103], a[16:19]
    ds_read_b64_tr_b16 v[128:129], v23 offset:9472
    v_mfma_f32_16x16x32_bf16 a[20:23], v[132:135], v[104:107], a[20:23]
    ds_read_b64_tr_b16 v[130:131], v23 offset:14080
    s_waitcnt lgkmcnt(10)
    v_mfma_f32_16x16x32_bf16 a[24:27], v[136:139], v[100:103], a[24:27]
    ds_read_b64_tr_b16 v[132:133], v23 offset:18432
    v_mfma_f32_16x16x32_bf16 a[28:31], v[136:139], v[104:107], a[28:31]
    ds_read_b64_tr_b16 v[134:135], v23 offset:23040
    s_waitcnt lgkmcnt(10)
    v_mfma_f32_16x16x32_bf16 a[32:35], v[140:143], v[100:103], a[32:35]
    ds_read_b64_tr_b16 v[136:137], v23 offset:18464
    v_mfma_f32_16x16x32_bf16 a[36:39], v[140:143], v[104:107], a[36:39]
    ds_read_b64_tr_b16 v[138:139], v23 offset:23072
    s_waitcnt lgkmcnt(10)
    v_mfma_f32_16x16x32_bf16 a[40:43], v[144:147], v[100:103], a[40:43]
    ds_read_b64_tr_b16 v[140:141], v23 offset:18496
    v_mfma_f32_16x16x32_bf16 a[44:47], v[144:147], v[104:107], a[44:47]
    ds_read_b64_tr_b16 v[142:143], v23 offset:23104
    s_waitcnt lgkmcnt(10)
    v_mfma_f32_16x16x32_bf16 a[48:51], v[148:151], v[100:103], a[48:51]
    ds_read_b64_tr_b16 v[144:145], v23 offset:18528
    v_mfma_f32_16x16x32_bf16 a[52:55], v[148:151], v[104:107], a[52:55]
    ds_read_b64_tr_b16 v[146:147], v23 offset:23136
    s_waitcnt lgkmcnt(10)
    v_mfma_f32_16x16x32_bf16 a[56:59], v[124:127], v[100:103], a[56:59]
    ds_read_b64_tr_b16 v[148:149], v23 offset:18560
    v_mfma_f32_16x16x32_bf16 a[60:63], v[124:127], v[104:107], a[60:63]
    ds_read_b64_tr_b16 v[150:151], v23 offset:23168
    s_waitcnt lgkmcnt(10)
    v_mfma_f32_16x16x32_bf16 a[64:67], v[128:131], v[100:103], a[64:67]
    ds_read_b64_tr_b16 v[124:125], v23 offset:18592
    v_mfma_f32_16x16x32_bf16 a[68:71], v[128:131], v[104:107], a[68:71]
    ds_read_b64_tr_b16 v[126:127], v23 offset:23200
    s_waitcnt lgkmcnt(10)
    v_mfma_f32_16x16x32_bf16 a[0:3], v[132:135], v[108:111], a[0:3]
    ds_read_b64_tr_b16 v[128:129], v23 offset:18624
    ds_read_b64_tr_b16 v[130:131], v23 offset:23232
    v_mfma_f32_16x16x32_bf16 a[4:7], v[132:135], v[112:115], a[4:7]
    s_mov_b32 s39, 33792
    buffer_load_dwordx4 v[100:103], v17, s[24:27], s39 offen
    s_waitcnt lgkmcnt(10)
    v_mfma_f32_16x16x32_bf16 a[8:11], v[136:139], v[108:111], a[8:11]
    ds_read_b64_tr_b16 v[132:133], v23 offset:18656
    ds_read_b64_tr_b16 v[134:135], v23 offset:23264
    v_mfma_f32_16x16x32_bf16 a[12:15], v[136:139], v[112:115], a[12:15]
    s_mov_b32 s39, 33792
    buffer_load_dwordx4 v[104:107], v18, s[24:27], s39 offen
    s_waitcnt lgkmcnt(10)
    v_mfma_f32_16x16x32_bf16 a[16:19], v[140:143], v[108:111], a[16:19]
    ds_read_b64_tr_b16 v[136:137], v23 offset:18688
    v_mfma_f32_16x16x32_bf16 a[20:23], v[140:143], v[112:115], a[20:23]
    ds_read_b64_tr_b16 v[138:139], v23 offset:23296
    s_waitcnt lgkmcnt(10)
    v_mfma_f32_16x16x32_bf16 a[24:27], v[144:147], v[108:111], a[24:27]
    ds_read_b64_tr_b16 v[140:141], v23 offset:27648
    v_mfma_f32_16x16x32_bf16 a[28:31], v[144:147], v[112:115], a[28:31]
    ds_read_b64_tr_b16 v[142:143], v23 offset:32256
    s_waitcnt lgkmcnt(10)
    v_mfma_f32_16x16x32_bf16 a[32:35], v[148:151], v[108:111], a[32:35]
    ds_read_b64_tr_b16 v[144:145], v23 offset:27680
    v_mfma_f32_16x16x32_bf16 a[36:39], v[148:151], v[112:115], a[36:39]
    ds_read_b64_tr_b16 v[146:147], v23 offset:32288
    s_waitcnt lgkmcnt(10)
    v_mfma_f32_16x16x32_bf16 a[40:43], v[124:127], v[108:111], a[40:43]
    ds_read_b64_tr_b16 v[148:149], v23 offset:27712
    v_mfma_f32_16x16x32_bf16 a[44:47], v[124:127], v[112:115], a[44:47]
    ds_read_b64_tr_b16 v[150:151], v23 offset:32320
    s_waitcnt lgkmcnt(10)
    v_mfma_f32_16x16x32_bf16 a[48:51], v[128:131], v[108:111], a[48:51]
    ds_read_b64_tr_b16 v[124:125], v23 offset:27744
    v_mfma_f32_16x16x32_bf16 a[52:55], v[128:131], v[112:115], a[52:55]
    ds_read_b64_tr_b16 v[126:127], v23 offset:32352
    s_waitcnt lgkmcnt(10)
    v_mfma_f32_16x16x32_bf16 a[56:59], v[132:135], v[108:111], a[56:59]
    ds_read_b64_tr_b16 v[128:129], v23 offset:27776
    v_mfma_f32_16x16x32_bf16 a[60:63], v[132:135], v[112:115], a[60:63]
    ds_read_b64_tr_b16 v[130:131], v23 offset:32384
    s_waitcnt lgkmcnt(10)
    v_mfma_f32_16x16x32_bf16 a[64:67], v[136:139], v[108:111], a[64:67]
    ds_read_b64_tr_b16 v[132:133], v23 offset:27808
    v_mfma_f32_16x16x32_bf16 a[68:71], v[136:139], v[112:115], a[68:71]
    ds_read_b64_tr_b16 v[134:135], v23 offset:32416
    s_waitcnt lgkmcnt(10)
    v_mfma_f32_16x16x32_bf16 a[0:3], v[140:143], v[116:119], a[0:3]
    ds_read_b64_tr_b16 v[136:137], v23 offset:27840
    ds_read_b64_tr_b16 v[138:139], v23 offset:32448
    v_mfma_f32_16x16x32_bf16 a[4:7], v[140:143], v[120:123], a[4:7]
    s_mov_b32 s39, 34816
    buffer_load_dwordx4 v[108:111], v17, s[24:27], s39 offen
    s_waitcnt lgkmcnt(10)
    v_mfma_f32_16x16x32_bf16 a[8:11], v[144:147], v[116:119], a[8:11]
    ds_read_b64_tr_b16 v[140:141], v23 offset:27872
    ds_read_b64_tr_b16 v[142:143], v23 offset:32480
    v_mfma_f32_16x16x32_bf16 a[12:15], v[144:147], v[120:123], a[12:15]
    s_mov_b32 s39, 34816
    buffer_load_dwordx4 v[112:115], v18, s[24:27], s39 offen
    s_waitcnt vmcnt(8)
    s_barrier
    s_waitcnt lgkmcnt(10)
    v_mfma_f32_16x16x32_bf16 a[16:19], v[148:151], v[116:119], a[16:19]
    ds_read_b64_tr_b16 v[144:145], v23 offset:27904
    ds_read_b64_tr_b16 v[146:147], v23 offset:32512
    v_mfma_f32_16x16x32_bf16 a[20:23], v[148:151], v[120:123], a[20:23]
    s_add_u32 m0, s35, 36864
    s_mov_b32 s38, 1032192
    buffer_load_dwordx4 v8, s[20:23], s38 offen lds
    s_waitcnt lgkmcnt(10)
    v_mfma_f32_16x16x32_bf16 a[24:27], v[124:127], v[116:119], a[24:27]
    ds_read_b64_tr_b16 v[148:149], v21 offset:0
    ds_read_b64_tr_b16 v[150:151], v21 offset:4608
    v_mfma_f32_16x16x32_bf16 a[28:31], v[124:127], v[120:123], a[28:31]
    s_add_u32 m0, s35, 37888
    s_mov_b32 s38, 1032192
    buffer_load_dwordx4 v9, s[20:23], s38 offen lds
    s_waitcnt lgkmcnt(10)
    v_mfma_f32_16x16x32_bf16 a[32:35], v[128:131], v[116:119], a[32:35]
    ds_read_b64_tr_b16 v[124:125], v21 offset:32
    ds_read_b64_tr_b16 v[126:127], v21 offset:4640
    v_mfma_f32_16x16x32_bf16 a[36:39], v[128:131], v[120:123], a[36:39]
    s_add_u32 m0, s35, 38912
    s_mov_b32 s38, 1032192
    buffer_load_dwordx4 v10, s[20:23], s38 offen lds
    s_waitcnt lgkmcnt(10)
    v_mfma_f32_16x16x32_bf16 a[40:43], v[132:135], v[116:119], a[40:43]
    ds_read_b64_tr_b16 v[128:129], v21 offset:64
    ds_read_b64_tr_b16 v[130:131], v21 offset:4672
    v_mfma_f32_16x16x32_bf16 a[44:47], v[132:135], v[120:123], a[44:47]
    s_add_u32 m0, s35, 39936
    s_mov_b32 s38, 1032192
    buffer_load_dwordx4 v11, s[20:23], s38 offen lds
    s_waitcnt lgkmcnt(10)
    v_mfma_f32_16x16x32_bf16 a[48:51], v[136:139], v[116:119], a[48:51]
    ds_read_b64_tr_b16 v[132:133], v21 offset:96
    ds_read_b64_tr_b16 v[134:135], v21 offset:4704
    v_mfma_f32_16x16x32_bf16 a[52:55], v[136:139], v[120:123], a[52:55]
    s_add_u32 m0, s35, 40960
    s_mov_b32 s38, 1032192
    buffer_load_dwordx4 v12, s[20:23], s38 offen lds
    s_waitcnt lgkmcnt(10)
    v_mfma_f32_16x16x32_bf16 a[56:59], v[140:143], v[116:119], a[56:59]
    ds_read_b64_tr_b16 v[136:137], v21 offset:128
    ds_read_b64_tr_b16 v[138:139], v21 offset:4736
    v_mfma_f32_16x16x32_bf16 a[60:63], v[140:143], v[120:123], a[60:63]
    s_add_u32 m0, s35, 41984
    s_mov_b32 s38, 1032192
    buffer_load_dwordx4 v13, s[20:23], s38 offen lds
    s_waitcnt lgkmcnt(10)
    v_mfma_f32_16x16x32_bf16 a[64:67], v[144:147], v[116:119], a[64:67]
    ds_read_b64_tr_b16 v[140:141], v21 offset:160
    ds_read_b64_tr_b16 v[142:143], v21 offset:4768
    v_mfma_f32_16x16x32_bf16 a[68:71], v[144:147], v[120:123], a[68:71]
    s_add_u32 m0, s35, 43008
    s_mov_b32 s38, 1032192
    buffer_load_dwordx4 v14, s[20:23], s38 offen lds
    s_waitcnt lgkmcnt(10)
    v_mfma_f32_16x16x32_bf16 a[0:3], v[148:151], v[28:31], a[0:3]
    ds_read_b64_tr_b16 v[144:145], v21 offset:192
    ds_read_b64_tr_b16 v[146:147], v21 offset:4800
    v_mfma_f32_16x16x32_bf16 a[4:7], v[148:151], v[32:35], a[4:7]
    s_add_u32 m0, s35, 44032
    s_mov_b32 s38, 1032192
    buffer_load_dwordx4 v15, s[20:23], s38 offen lds
    s_waitcnt lgkmcnt(10)
    v_mfma_f32_16x16x32_bf16 a[8:11], v[124:127], v[28:31], a[8:11]
    ds_read_b64_tr_b16 v[148:149], v21 offset:224
    ds_read_b64_tr_b16 v[150:151], v21 offset:4832
    v_mfma_f32_16x16x32_bf16 a[12:15], v[124:127], v[32:35], a[12:15]
    s_add_u32 m0, s35, 45056
    s_mov_b32 s38, 1032192
    buffer_load_dwordx4 v16, s[20:23], s38 offen lds
    s_waitcnt lgkmcnt(10)
    v_mfma_f32_16x16x32_bf16 a[16:19], v[128:131], v[28:31], a[16:19]
    ds_read_b64_tr_b16 v[124:125], v21 offset:256
    ds_read_b64_tr_b16 v[126:127], v21 offset:4864
    v_mfma_f32_16x16x32_bf16 a[20:23], v[128:131], v[32:35], a[20:23]
    s_mov_b32 s39, 35840
    buffer_load_dwordx4 v[116:119], v17, s[24:27], s39 offen
    s_waitcnt lgkmcnt(10)
    v_mfma_f32_16x16x32_bf16 a[24:27], v[132:135], v[28:31], a[24:27]
    ds_read_b64_tr_b16 v[128:129], v21 offset:9216
    ds_read_b64_tr_b16 v[130:131], v21 offset:13824
    v_mfma_f32_16x16x32_bf16 a[28:31], v[132:135], v[32:35], a[28:31]
    s_mov_b32 s39, 35840
    buffer_load_dwordx4 v[120:123], v18, s[24:27], s39 offen
    s_waitcnt lgkmcnt(10)
    v_mfma_f32_16x16x32_bf16 a[32:35], v[136:139], v[28:31], a[32:35]
    ds_read_b64_tr_b16 v[132:133], v21 offset:9248
    v_mfma_f32_16x16x32_bf16 a[36:39], v[136:139], v[32:35], a[36:39]
    ds_read_b64_tr_b16 v[134:135], v21 offset:13856
    s_waitcnt lgkmcnt(10)
    v_mfma_f32_16x16x32_bf16 a[40:43], v[140:143], v[28:31], a[40:43]
    ds_read_b64_tr_b16 v[136:137], v21 offset:9280
    v_mfma_f32_16x16x32_bf16 a[44:47], v[140:143], v[32:35], a[44:47]
    ds_read_b64_tr_b16 v[138:139], v21 offset:13888
    s_waitcnt lgkmcnt(10)
    v_mfma_f32_16x16x32_bf16 a[48:51], v[144:147], v[28:31], a[48:51]
    ds_read_b64_tr_b16 v[140:141], v21 offset:9312
    v_mfma_f32_16x16x32_bf16 a[52:55], v[144:147], v[32:35], a[52:55]
    ds_read_b64_tr_b16 v[142:143], v21 offset:13920
    s_waitcnt lgkmcnt(10)
    v_mfma_f32_16x16x32_bf16 a[56:59], v[148:151], v[28:31], a[56:59]
    ds_read_b64_tr_b16 v[144:145], v21 offset:9344
    v_mfma_f32_16x16x32_bf16 a[60:63], v[148:151], v[32:35], a[60:63]
    ds_read_b64_tr_b16 v[146:147], v21 offset:13952
    s_waitcnt lgkmcnt(10)
    v_mfma_f32_16x16x32_bf16 a[64:67], v[124:127], v[28:31], a[64:67]
    ds_read_b64_tr_b16 v[148:149], v21 offset:9376
    v_mfma_f32_16x16x32_bf16 a[68:71], v[124:127], v[32:35], a[68:71]
    ds_read_b64_tr_b16 v[150:151], v21 offset:13984
    s_waitcnt lgkmcnt(10)
    v_mfma_f32_16x16x32_bf16 a[0:3], v[128:131], v[36:39], a[0:3]
    ds_read_b64_tr_b16 v[124:125], v21 offset:9408
    v_mfma_f32_16x16x32_bf16 a[4:7], v[128:131], v[40:43], a[4:7]
    ds_read_b64_tr_b16 v[126:127], v21 offset:14016
    s_waitcnt lgkmcnt(10)
    v_mfma_f32_16x16x32_bf16 a[8:11], v[132:135], v[36:39], a[8:11]
    ds_read_b64_tr_b16 v[128:129], v21 offset:9440
    v_mfma_f32_16x16x32_bf16 a[12:15], v[132:135], v[40:43], a[12:15]
    ds_read_b64_tr_b16 v[130:131], v21 offset:14048
    s_waitcnt lgkmcnt(10)
    v_mfma_f32_16x16x32_bf16 a[16:19], v[136:139], v[36:39], a[16:19]
    ds_read_b64_tr_b16 v[132:133], v21 offset:9472
    v_mfma_f32_16x16x32_bf16 a[20:23], v[136:139], v[40:43], a[20:23]
    ds_read_b64_tr_b16 v[134:135], v21 offset:14080
    s_waitcnt lgkmcnt(10)
    v_mfma_f32_16x16x32_bf16 a[24:27], v[140:143], v[36:39], a[24:27]
    ds_read_b64_tr_b16 v[136:137], v21 offset:18432
    v_mfma_f32_16x16x32_bf16 a[28:31], v[140:143], v[40:43], a[28:31]
    ds_read_b64_tr_b16 v[138:139], v21 offset:23040
    s_waitcnt lgkmcnt(10)
    v_mfma_f32_16x16x32_bf16 a[32:35], v[144:147], v[36:39], a[32:35]
    ds_read_b64_tr_b16 v[140:141], v21 offset:18464
    v_mfma_f32_16x16x32_bf16 a[36:39], v[144:147], v[40:43], a[36:39]
    ds_read_b64_tr_b16 v[142:143], v21 offset:23072
    s_waitcnt lgkmcnt(10)
    v_mfma_f32_16x16x32_bf16 a[40:43], v[148:151], v[36:39], a[40:43]
    ds_read_b64_tr_b16 v[144:145], v21 offset:18496
    v_mfma_f32_16x16x32_bf16 a[44:47], v[148:151], v[40:43], a[44:47]
    ds_read_b64_tr_b16 v[146:147], v21 offset:23104
    s_waitcnt lgkmcnt(10)
    v_mfma_f32_16x16x32_bf16 a[48:51], v[124:127], v[36:39], a[48:51]
    ds_read_b64_tr_b16 v[148:149], v21 offset:18528
    v_mfma_f32_16x16x32_bf16 a[52:55], v[124:127], v[40:43], a[52:55]
    ds_read_b64_tr_b16 v[150:151], v21 offset:23136
    s_waitcnt lgkmcnt(10)
    v_mfma_f32_16x16x32_bf16 a[56:59], v[128:131], v[36:39], a[56:59]
    ds_read_b64_tr_b16 v[124:125], v21 offset:18560
    v_mfma_f32_16x16x32_bf16 a[60:63], v[128:131], v[40:43], a[60:63]
    ds_read_b64_tr_b16 v[126:127], v21 offset:23168
    s_waitcnt lgkmcnt(10)
    v_mfma_f32_16x16x32_bf16 a[64:67], v[132:135], v[36:39], a[64:67]
    ds_read_b64_tr_b16 v[128:129], v21 offset:18592
    v_mfma_f32_16x16x32_bf16 a[68:71], v[132:135], v[40:43], a[68:71]
    ds_read_b64_tr_b16 v[130:131], v21 offset:23200
    s_waitcnt lgkmcnt(10)
    v_mfma_f32_16x16x32_bf16 a[0:3], v[136:139], v[44:47], a[0:3]
    ds_read_b64_tr_b16 v[132:133], v21 offset:18624
    v_mfma_f32_16x16x32_bf16 a[4:7], v[136:139], v[48:51], a[4:7]
    ds_read_b64_tr_b16 v[134:135], v21 offset:23232
    s_waitcnt lgkmcnt(10)
    v_mfma_f32_16x16x32_bf16 a[8:11], v[140:143], v[44:47], a[8:11]
    ds_read_b64_tr_b16 v[136:137], v21 offset:18656
    v_mfma_f32_16x16x32_bf16 a[12:15], v[140:143], v[48:51], a[12:15]
    ds_read_b64_tr_b16 v[138:139], v21 offset:23264
    s_waitcnt lgkmcnt(10)
    v_mfma_f32_16x16x32_bf16 a[16:19], v[144:147], v[44:47], a[16:19]
    ds_read_b64_tr_b16 v[140:141], v21 offset:18688
    v_mfma_f32_16x16x32_bf16 a[20:23], v[144:147], v[48:51], a[20:23]
    ds_read_b64_tr_b16 v[142:143], v21 offset:23296
    s_waitcnt lgkmcnt(10)
    v_mfma_f32_16x16x32_bf16 a[24:27], v[148:151], v[44:47], a[24:27]
    ds_read_b64_tr_b16 v[144:145], v21 offset:27648
    v_mfma_f32_16x16x32_bf16 a[28:31], v[148:151], v[48:51], a[28:31]
    ds_read_b64_tr_b16 v[146:147], v21 offset:32256
    s_waitcnt lgkmcnt(10)
    v_mfma_f32_16x16x32_bf16 a[32:35], v[124:127], v[44:47], a[32:35]
    ds_read_b64_tr_b16 v[148:149], v21 offset:27680
    v_mfma_f32_16x16x32_bf16 a[36:39], v[124:127], v[48:51], a[36:39]
    ds_read_b64_tr_b16 v[150:151], v21 offset:32288
    s_waitcnt lgkmcnt(10)
    v_mfma_f32_16x16x32_bf16 a[40:43], v[128:131], v[44:47], a[40:43]
    ds_read_b64_tr_b16 v[124:125], v21 offset:27712
    v_mfma_f32_16x16x32_bf16 a[44:47], v[128:131], v[48:51], a[44:47]
    ds_read_b64_tr_b16 v[126:127], v21 offset:32320
    s_waitcnt lgkmcnt(10)
    v_mfma_f32_16x16x32_bf16 a[48:51], v[132:135], v[44:47], a[48:51]
    ds_read_b64_tr_b16 v[128:129], v21 offset:27744
    v_mfma_f32_16x16x32_bf16 a[52:55], v[132:135], v[48:51], a[52:55]
    ds_read_b64_tr_b16 v[130:131], v21 offset:32352
    s_waitcnt lgkmcnt(10)
    v_mfma_f32_16x16x32_bf16 a[56:59], v[136:139], v[44:47], a[56:59]
    ds_read_b64_tr_b16 v[132:133], v21 offset:27776
    v_mfma_f32_16x16x32_bf16 a[60:63], v[136:139], v[48:51], a[60:63]
    ds_read_b64_tr_b16 v[134:135], v21 offset:32384
    s_waitcnt lgkmcnt(10)
    v_mfma_f32_16x16x32_bf16 a[64:67], v[140:143], v[44:47], a[64:67]
    ds_read_b64_tr_b16 v[136:137], v21 offset:27808
    v_mfma_f32_16x16x32_bf16 a[68:71], v[140:143], v[48:51], a[68:71]
    ds_read_b64_tr_b16 v[138:139], v21 offset:32416
    s_waitcnt lgkmcnt(10)
    v_mfma_f32_16x16x32_bf16 a[0:3], v[144:147], v[52:55], a[0:3]
    ds_read_b64_tr_b16 v[140:141], v21 offset:27840
    v_mfma_f32_16x16x32_bf16 a[4:7], v[144:147], v[56:59], a[4:7]
    ds_read_b64_tr_b16 v[142:143], v21 offset:32448
    s_waitcnt lgkmcnt(10)
    v_mfma_f32_16x16x32_bf16 a[8:11], v[148:151], v[52:55], a[8:11]
    ds_read_b64_tr_b16 v[144:145], v21 offset:27872
    v_mfma_f32_16x16x32_bf16 a[12:15], v[148:151], v[56:59], a[12:15]
    ds_read_b64_tr_b16 v[146:147], v21 offset:32480
    s_waitcnt vmcnt(2)
    s_barrier
    s_waitcnt lgkmcnt(10)
    v_mfma_f32_16x16x32_bf16 a[16:19], v[124:127], v[52:55], a[16:19]
    ds_read_b64_tr_b16 v[148:149], v21 offset:27904
    ds_read_b64_tr_b16 v[150:151], v21 offset:32512
    v_mfma_f32_16x16x32_bf16 a[20:23], v[124:127], v[56:59], a[20:23]
    s_add_u32 m0, s35, 73728
    s_mov_b32 s38, 1179648
    buffer_load_dwordx4 v8, s[20:23], s38 offen lds
    s_waitcnt lgkmcnt(10)
    v_mfma_f32_16x16x32_bf16 a[24:27], v[128:131], v[52:55], a[24:27]
    ds_read_b64_tr_b16 v[124:125], v22 offset:0
    ds_read_b64_tr_b16 v[126:127], v22 offset:4608
    v_mfma_f32_16x16x32_bf16 a[28:31], v[128:131], v[56:59], a[28:31]
    s_add_u32 m0, s35, 74752
    s_mov_b32 s38, 1179648
    buffer_load_dwordx4 v9, s[20:23], s38 offen lds
    s_waitcnt lgkmcnt(10)
    v_mfma_f32_16x16x32_bf16 a[32:35], v[132:135], v[52:55], a[32:35]
    ds_read_b64_tr_b16 v[128:129], v22 offset:32
    ds_read_b64_tr_b16 v[130:131], v22 offset:4640
    v_mfma_f32_16x16x32_bf16 a[36:39], v[132:135], v[56:59], a[36:39]
    s_add_u32 m0, s35, 75776
    s_mov_b32 s38, 1179648
    buffer_load_dwordx4 v10, s[20:23], s38 offen lds
    s_waitcnt lgkmcnt(10)
    v_mfma_f32_16x16x32_bf16 a[40:43], v[136:139], v[52:55], a[40:43]
    ds_read_b64_tr_b16 v[132:133], v22 offset:64
    ds_read_b64_tr_b16 v[134:135], v22 offset:4672
    v_mfma_f32_16x16x32_bf16 a[44:47], v[136:139], v[56:59], a[44:47]
    s_add_u32 m0, s35, 76800
    s_mov_b32 s38, 1179648
    buffer_load_dwordx4 v11, s[20:23], s38 offen lds
    s_waitcnt lgkmcnt(10)
    v_mfma_f32_16x16x32_bf16 a[48:51], v[140:143], v[52:55], a[48:51]
    ds_read_b64_tr_b16 v[136:137], v22 offset:96
    ds_read_b64_tr_b16 v[138:139], v22 offset:4704
    v_mfma_f32_16x16x32_bf16 a[52:55], v[140:143], v[56:59], a[52:55]
    s_add_u32 m0, s35, 77824
    s_mov_b32 s38, 1179648
    buffer_load_dwordx4 v12, s[20:23], s38 offen lds
    s_waitcnt lgkmcnt(10)
    v_mfma_f32_16x16x32_bf16 a[56:59], v[144:147], v[52:55], a[56:59]
    ds_read_b64_tr_b16 v[140:141], v22 offset:128
    ds_read_b64_tr_b16 v[142:143], v22 offset:4736
    v_mfma_f32_16x16x32_bf16 a[60:63], v[144:147], v[56:59], a[60:63]
    s_add_u32 m0, s35, 78848
    s_mov_b32 s38, 1179648
    buffer_load_dwordx4 v13, s[20:23], s38 offen lds
    s_waitcnt lgkmcnt(10)
    v_mfma_f32_16x16x32_bf16 a[64:67], v[148:151], v[52:55], a[64:67]
    ds_read_b64_tr_b16 v[144:145], v22 offset:160
    ds_read_b64_tr_b16 v[146:147], v22 offset:4768
    v_mfma_f32_16x16x32_bf16 a[68:71], v[148:151], v[56:59], a[68:71]
    s_add_u32 m0, s35, 79872
    s_mov_b32 s38, 1179648
    buffer_load_dwordx4 v14, s[20:23], s38 offen lds
    s_waitcnt lgkmcnt(10)
    v_mfma_f32_16x16x32_bf16 a[0:3], v[124:127], v[60:63], a[0:3]
    ds_read_b64_tr_b16 v[148:149], v22 offset:192
    ds_read_b64_tr_b16 v[150:151], v22 offset:4800
    v_mfma_f32_16x16x32_bf16 a[4:7], v[124:127], v[64:67], a[4:7]
    s_add_u32 m0, s35, 80896
    s_mov_b32 s38, 1179648
    buffer_load_dwordx4 v15, s[20:23], s38 offen lds
    s_waitcnt lgkmcnt(10)
    v_mfma_f32_16x16x32_bf16 a[8:11], v[128:131], v[60:63], a[8:11]
    ds_read_b64_tr_b16 v[124:125], v22 offset:224
    ds_read_b64_tr_b16 v[126:127], v22 offset:4832
    v_mfma_f32_16x16x32_bf16 a[12:15], v[128:131], v[64:67], a[12:15]
    s_add_u32 m0, s35, 81920
    s_mov_b32 s38, 1179648
    buffer_load_dwordx4 v16, s[20:23], s38 offen lds
    s_waitcnt lgkmcnt(10)
    v_mfma_f32_16x16x32_bf16 a[16:19], v[132:135], v[60:63], a[16:19]
    ds_read_b64_tr_b16 v[128:129], v22 offset:256
    v_mfma_f32_16x16x32_bf16 a[20:23], v[132:135], v[64:67], a[20:23]
    ds_read_b64_tr_b16 v[130:131], v22 offset:4864
    s_waitcnt lgkmcnt(10)
    v_mfma_f32_16x16x32_bf16 a[24:27], v[136:139], v[60:63], a[24:27]
    ds_read_b64_tr_b16 v[132:133], v22 offset:9216
    v_mfma_f32_16x16x32_bf16 a[28:31], v[136:139], v[64:67], a[28:31]
    ds_read_b64_tr_b16 v[134:135], v22 offset:13824
    s_waitcnt lgkmcnt(10)
    v_mfma_f32_16x16x32_bf16 a[32:35], v[140:143], v[60:63], a[32:35]
    ds_read_b64_tr_b16 v[136:137], v22 offset:9248
    v_mfma_f32_16x16x32_bf16 a[36:39], v[140:143], v[64:67], a[36:39]
    ds_read_b64_tr_b16 v[138:139], v22 offset:13856
    s_waitcnt lgkmcnt(10)
    v_mfma_f32_16x16x32_bf16 a[40:43], v[144:147], v[60:63], a[40:43]
    ds_read_b64_tr_b16 v[140:141], v22 offset:9280
    v_mfma_f32_16x16x32_bf16 a[44:47], v[144:147], v[64:67], a[44:47]
    ds_read_b64_tr_b16 v[142:143], v22 offset:13888
    s_waitcnt lgkmcnt(10)
    v_mfma_f32_16x16x32_bf16 a[48:51], v[148:151], v[60:63], a[48:51]
    ds_read_b64_tr_b16 v[144:145], v22 offset:9312
    v_mfma_f32_16x16x32_bf16 a[52:55], v[148:151], v[64:67], a[52:55]
    ds_read_b64_tr_b16 v[146:147], v22 offset:13920
    s_waitcnt lgkmcnt(10)
    v_mfma_f32_16x16x32_bf16 a[56:59], v[124:127], v[60:63], a[56:59]
    ds_read_b64_tr_b16 v[148:149], v22 offset:9344
    v_mfma_f32_16x16x32_bf16 a[60:63], v[124:127], v[64:67], a[60:63]
    ds_read_b64_tr_b16 v[150:151], v22 offset:13952
    s_waitcnt lgkmcnt(10)
    v_mfma_f32_16x16x32_bf16 a[64:67], v[128:131], v[60:63], a[64:67]
    ds_read_b64_tr_b16 v[124:125], v22 offset:9376
    v_mfma_f32_16x16x32_bf16 a[68:71], v[128:131], v[64:67], a[68:71]
    ds_read_b64_tr_b16 v[126:127], v22 offset:13984
    s_waitcnt lgkmcnt(10)
    v_mfma_f32_16x16x32_bf16 a[0:3], v[132:135], v[68:71], a[0:3]
    ds_read_b64_tr_b16 v[128:129], v22 offset:9408
    v_mfma_f32_16x16x32_bf16 a[4:7], v[132:135], v[72:75], a[4:7]
    ds_read_b64_tr_b16 v[130:131], v22 offset:14016
    s_waitcnt lgkmcnt(10)
    v_mfma_f32_16x16x32_bf16 a[8:11], v[136:139], v[68:71], a[8:11]
    ds_read_b64_tr_b16 v[132:133], v22 offset:9440
    v_mfma_f32_16x16x32_bf16 a[12:15], v[136:139], v[72:75], a[12:15]
    ds_read_b64_tr_b16 v[134:135], v22 offset:14048
    s_waitcnt lgkmcnt(10)
    v_mfma_f32_16x16x32_bf16 a[16:19], v[140:143], v[68:71], a[16:19]
    ds_read_b64_tr_b16 v[136:137], v22 offset:9472
    v_mfma_f32_16x16x32_bf16 a[20:23], v[140:143], v[72:75], a[20:23]
    ds_read_b64_tr_b16 v[138:139], v22 offset:14080
    s_waitcnt lgkmcnt(10)
    v_mfma_f32_16x16x32_bf16 a[24:27], v[144:147], v[68:71], a[24:27]
    ds_read_b64_tr_b16 v[140:141], v22 offset:18432
    v_mfma_f32_16x16x32_bf16 a[28:31], v[144:147], v[72:75], a[28:31]
    ds_read_b64_tr_b16 v[142:143], v22 offset:23040
    s_waitcnt lgkmcnt(10)
    v_mfma_f32_16x16x32_bf16 a[32:35], v[148:151], v[68:71], a[32:35]
    ds_read_b64_tr_b16 v[144:145], v22 offset:18464
    v_mfma_f32_16x16x32_bf16 a[36:39], v[148:151], v[72:75], a[36:39]
    ds_read_b64_tr_b16 v[146:147], v22 offset:23072
    s_waitcnt lgkmcnt(10)
    v_mfma_f32_16x16x32_bf16 a[40:43], v[124:127], v[68:71], a[40:43]
    ds_read_b64_tr_b16 v[148:149], v22 offset:18496
    v_mfma_f32_16x16x32_bf16 a[44:47], v[124:127], v[72:75], a[44:47]
    ds_read_b64_tr_b16 v[150:151], v22 offset:23104
    s_waitcnt lgkmcnt(10)
    v_mfma_f32_16x16x32_bf16 a[48:51], v[128:131], v[68:71], a[48:51]
    ds_read_b64_tr_b16 v[124:125], v22 offset:18528
    v_mfma_f32_16x16x32_bf16 a[52:55], v[128:131], v[72:75], a[52:55]
    ds_read_b64_tr_b16 v[126:127], v22 offset:23136
    s_waitcnt lgkmcnt(10)
    v_mfma_f32_16x16x32_bf16 a[56:59], v[132:135], v[68:71], a[56:59]
    ds_read_b64_tr_b16 v[128:129], v22 offset:18560
    v_mfma_f32_16x16x32_bf16 a[60:63], v[132:135], v[72:75], a[60:63]
    ds_read_b64_tr_b16 v[130:131], v22 offset:23168
    s_waitcnt lgkmcnt(10)
    v_mfma_f32_16x16x32_bf16 a[64:67], v[136:139], v[68:71], a[64:67]
    ds_read_b64_tr_b16 v[132:133], v22 offset:18592
    v_mfma_f32_16x16x32_bf16 a[68:71], v[136:139], v[72:75], a[68:71]
    ds_read_b64_tr_b16 v[134:135], v22 offset:23200
    s_waitcnt lgkmcnt(10)
    v_mfma_f32_16x16x32_bf16 a[0:3], v[140:143], v[76:79], a[0:3]
    ds_read_b64_tr_b16 v[136:137], v22 offset:18624
    v_mfma_f32_16x16x32_bf16 a[4:7], v[140:143], v[80:83], a[4:7]
    ds_read_b64_tr_b16 v[138:139], v22 offset:23232
    s_waitcnt lgkmcnt(10)
    v_mfma_f32_16x16x32_bf16 a[8:11], v[144:147], v[76:79], a[8:11]
    ds_read_b64_tr_b16 v[140:141], v22 offset:18656
    v_mfma_f32_16x16x32_bf16 a[12:15], v[144:147], v[80:83], a[12:15]
    ds_read_b64_tr_b16 v[142:143], v22 offset:23264
    s_waitcnt lgkmcnt(10)
    v_mfma_f32_16x16x32_bf16 a[16:19], v[148:151], v[76:79], a[16:19]
    ds_read_b64_tr_b16 v[144:145], v22 offset:18688
    v_mfma_f32_16x16x32_bf16 a[20:23], v[148:151], v[80:83], a[20:23]
    ds_read_b64_tr_b16 v[146:147], v22 offset:23296
    s_waitcnt lgkmcnt(10)
    v_mfma_f32_16x16x32_bf16 a[24:27], v[124:127], v[76:79], a[24:27]
    ds_read_b64_tr_b16 v[148:149], v22 offset:27648
    v_mfma_f32_16x16x32_bf16 a[28:31], v[124:127], v[80:83], a[28:31]
    ds_read_b64_tr_b16 v[150:151], v22 offset:32256
    s_waitcnt lgkmcnt(10)
    v_mfma_f32_16x16x32_bf16 a[32:35], v[128:131], v[76:79], a[32:35]
    ds_read_b64_tr_b16 v[124:125], v22 offset:27680
    v_mfma_f32_16x16x32_bf16 a[36:39], v[128:131], v[80:83], a[36:39]
    ds_read_b64_tr_b16 v[126:127], v22 offset:32288
    s_waitcnt lgkmcnt(10)
    v_mfma_f32_16x16x32_bf16 a[40:43], v[132:135], v[76:79], a[40:43]
    ds_read_b64_tr_b16 v[128:129], v22 offset:27712
    v_mfma_f32_16x16x32_bf16 a[44:47], v[132:135], v[80:83], a[44:47]
    ds_read_b64_tr_b16 v[130:131], v22 offset:32320
    s_waitcnt lgkmcnt(10)
    v_mfma_f32_16x16x32_bf16 a[48:51], v[136:139], v[76:79], a[48:51]
    ds_read_b64_tr_b16 v[132:133], v22 offset:27744
    v_mfma_f32_16x16x32_bf16 a[52:55], v[136:139], v[80:83], a[52:55]
    ds_read_b64_tr_b16 v[134:135], v22 offset:32352
    s_waitcnt lgkmcnt(10)
    v_mfma_f32_16x16x32_bf16 a[56:59], v[140:143], v[76:79], a[56:59]
    ds_read_b64_tr_b16 v[136:137], v22 offset:27776
    v_mfma_f32_16x16x32_bf16 a[60:63], v[140:143], v[80:83], a[60:63]
    ds_read_b64_tr_b16 v[138:139], v22 offset:32384
    s_waitcnt lgkmcnt(10)
    v_mfma_f32_16x16x32_bf16 a[64:67], v[144:147], v[76:79], a[64:67]
    ds_read_b64_tr_b16 v[140:141], v22 offset:27808
    v_mfma_f32_16x16x32_bf16 a[68:71], v[144:147], v[80:83], a[68:71]
    ds_read_b64_tr_b16 v[142:143], v22 offset:32416
    s_waitcnt lgkmcnt(10)
    v_mfma_f32_16x16x32_bf16 a[0:3], v[148:151], v[84:87], a[0:3]
    ds_read_b64_tr_b16 v[144:145], v22 offset:27840
    v_mfma_f32_16x16x32_bf16 a[4:7], v[148:151], v[88:91], a[4:7]
    ds_read_b64_tr_b16 v[146:147], v22 offset:32448
    s_waitcnt lgkmcnt(10)
    v_mfma_f32_16x16x32_bf16 a[8:11], v[124:127], v[84:87], a[8:11]
    ds_read_b64_tr_b16 v[148:149], v22 offset:27872
    v_mfma_f32_16x16x32_bf16 a[12:15], v[124:127], v[88:91], a[12:15]
    ds_read_b64_tr_b16 v[150:151], v22 offset:32480
    s_waitcnt vmcnt(0)
    s_barrier
    s_waitcnt lgkmcnt(10)
    v_mfma_f32_16x16x32_bf16 a[16:19], v[128:131], v[84:87], a[16:19]
    ds_read_b64_tr_b16 v[124:125], v22 offset:27904
    v_mfma_f32_16x16x32_bf16 a[20:23], v[128:131], v[88:91], a[20:23]
    ds_read_b64_tr_b16 v[126:127], v22 offset:32512
    s_waitcnt lgkmcnt(10)
    v_mfma_f32_16x16x32_bf16 a[24:27], v[132:135], v[84:87], a[24:27]
    ds_read_b64_tr_b16 v[128:129], v23 offset:0
    v_mfma_f32_16x16x32_bf16 a[28:31], v[132:135], v[88:91], a[28:31]
    ds_read_b64_tr_b16 v[130:131], v23 offset:4608
    s_waitcnt lgkmcnt(10)
    v_mfma_f32_16x16x32_bf16 a[32:35], v[136:139], v[84:87], a[32:35]
    ds_read_b64_tr_b16 v[132:133], v23 offset:32
    v_mfma_f32_16x16x32_bf16 a[36:39], v[136:139], v[88:91], a[36:39]
    ds_read_b64_tr_b16 v[134:135], v23 offset:4640
    s_waitcnt lgkmcnt(10)
    v_mfma_f32_16x16x32_bf16 a[40:43], v[140:143], v[84:87], a[40:43]
    ds_read_b64_tr_b16 v[136:137], v23 offset:64
    v_mfma_f32_16x16x32_bf16 a[44:47], v[140:143], v[88:91], a[44:47]
    ds_read_b64_tr_b16 v[138:139], v23 offset:4672
    s_waitcnt lgkmcnt(10)
    v_mfma_f32_16x16x32_bf16 a[48:51], v[144:147], v[84:87], a[48:51]
    ds_read_b64_tr_b16 v[140:141], v23 offset:96
    v_mfma_f32_16x16x32_bf16 a[52:55], v[144:147], v[88:91], a[52:55]
    ds_read_b64_tr_b16 v[142:143], v23 offset:4704
    s_waitcnt lgkmcnt(10)
    v_mfma_f32_16x16x32_bf16 a[56:59], v[148:151], v[84:87], a[56:59]
    ds_read_b64_tr_b16 v[144:145], v23 offset:128
    v_mfma_f32_16x16x32_bf16 a[60:63], v[148:151], v[88:91], a[60:63]
    ds_read_b64_tr_b16 v[146:147], v23 offset:4736
    s_waitcnt lgkmcnt(10)
    v_mfma_f32_16x16x32_bf16 a[64:67], v[124:127], v[84:87], a[64:67]
    ds_read_b64_tr_b16 v[148:149], v23 offset:160
    v_mfma_f32_16x16x32_bf16 a[68:71], v[124:127], v[88:91], a[68:71]
    ds_read_b64_tr_b16 v[150:151], v23 offset:4768
    s_waitcnt lgkmcnt(10)
    v_mfma_f32_16x16x32_bf16 a[0:3], v[128:131], v[92:95], a[0:3]
    ds_read_b64_tr_b16 v[124:125], v23 offset:192
    v_mfma_f32_16x16x32_bf16 a[4:7], v[128:131], v[96:99], a[4:7]
    ds_read_b64_tr_b16 v[126:127], v23 offset:4800
    s_waitcnt lgkmcnt(10)
    v_mfma_f32_16x16x32_bf16 a[8:11], v[132:135], v[92:95], a[8:11]
    ds_read_b64_tr_b16 v[128:129], v23 offset:224
    v_mfma_f32_16x16x32_bf16 a[12:15], v[132:135], v[96:99], a[12:15]
    ds_read_b64_tr_b16 v[130:131], v23 offset:4832
    s_waitcnt lgkmcnt(10)
    v_mfma_f32_16x16x32_bf16 a[16:19], v[136:139], v[92:95], a[16:19]
    ds_read_b64_tr_b16 v[132:133], v23 offset:256
    v_mfma_f32_16x16x32_bf16 a[20:23], v[136:139], v[96:99], a[20:23]
    ds_read_b64_tr_b16 v[134:135], v23 offset:4864
    s_waitcnt lgkmcnt(10)
    v_mfma_f32_16x16x32_bf16 a[24:27], v[140:143], v[92:95], a[24:27]
    ds_read_b64_tr_b16 v[136:137], v23 offset:9216
    v_mfma_f32_16x16x32_bf16 a[28:31], v[140:143], v[96:99], a[28:31]
    ds_read_b64_tr_b16 v[138:139], v23 offset:13824
    s_waitcnt lgkmcnt(10)
    v_mfma_f32_16x16x32_bf16 a[32:35], v[144:147], v[92:95], a[32:35]
    ds_read_b64_tr_b16 v[140:141], v23 offset:9248
    v_mfma_f32_16x16x32_bf16 a[36:39], v[144:147], v[96:99], a[36:39]
    ds_read_b64_tr_b16 v[142:143], v23 offset:13856
    s_waitcnt lgkmcnt(10)
    v_mfma_f32_16x16x32_bf16 a[40:43], v[148:151], v[92:95], a[40:43]
    ds_read_b64_tr_b16 v[144:145], v23 offset:9280
    v_mfma_f32_16x16x32_bf16 a[44:47], v[148:151], v[96:99], a[44:47]
    ds_read_b64_tr_b16 v[146:147], v23 offset:13888
    s_waitcnt lgkmcnt(10)
    v_mfma_f32_16x16x32_bf16 a[48:51], v[124:127], v[92:95], a[48:51]
    ds_read_b64_tr_b16 v[148:149], v23 offset:9312
    v_mfma_f32_16x16x32_bf16 a[52:55], v[124:127], v[96:99], a[52:55]
    ds_read_b64_tr_b16 v[150:151], v23 offset:13920
    s_waitcnt lgkmcnt(10)
    v_mfma_f32_16x16x32_bf16 a[56:59], v[128:131], v[92:95], a[56:59]
    ds_read_b64_tr_b16 v[124:125], v23 offset:9344
    v_mfma_f32_16x16x32_bf16 a[60:63], v[128:131], v[96:99], a[60:63]
    ds_read_b64_tr_b16 v[126:127], v23 offset:13952
    s_waitcnt lgkmcnt(10)
    v_mfma_f32_16x16x32_bf16 a[64:67], v[132:135], v[92:95], a[64:67]
    ds_read_b64_tr_b16 v[128:129], v23 offset:9376
    v_mfma_f32_16x16x32_bf16 a[68:71], v[132:135], v[96:99], a[68:71]
    ds_read_b64_tr_b16 v[130:131], v23 offset:13984
    s_waitcnt lgkmcnt(10)
    v_mfma_f32_16x16x32_bf16 a[0:3], v[136:139], v[100:103], a[0:3]
    ds_read_b64_tr_b16 v[132:133], v23 offset:9408
    v_mfma_f32_16x16x32_bf16 a[4:7], v[136:139], v[104:107], a[4:7]
    ds_read_b64_tr_b16 v[134:135], v23 offset:14016
    s_waitcnt lgkmcnt(10)
    v_mfma_f32_16x16x32_bf16 a[8:11], v[140:143], v[100:103], a[8:11]
    ds_read_b64_tr_b16 v[136:137], v23 offset:9440
    v_mfma_f32_16x16x32_bf16 a[12:15], v[140:143], v[104:107], a[12:15]
    ds_read_b64_tr_b16 v[138:139], v23 offset:14048
    s_waitcnt lgkmcnt(10)
    v_mfma_f32_16x16x32_bf16 a[16:19], v[144:147], v[100:103], a[16:19]
    ds_read_b64_tr_b16 v[140:141], v23 offset:9472
    v_mfma_f32_16x16x32_bf16 a[20:23], v[144:147], v[104:107], a[20:23]
    ds_read_b64_tr_b16 v[142:143], v23 offset:14080
    s_waitcnt lgkmcnt(10)
    v_mfma_f32_16x16x32_bf16 a[24:27], v[148:151], v[100:103], a[24:27]
    ds_read_b64_tr_b16 v[144:145], v23 offset:18432
    v_mfma_f32_16x16x32_bf16 a[28:31], v[148:151], v[104:107], a[28:31]
    ds_read_b64_tr_b16 v[146:147], v23 offset:23040
    s_waitcnt lgkmcnt(10)
    v_mfma_f32_16x16x32_bf16 a[32:35], v[124:127], v[100:103], a[32:35]
    ds_read_b64_tr_b16 v[148:149], v23 offset:18464
    v_mfma_f32_16x16x32_bf16 a[36:39], v[124:127], v[104:107], a[36:39]
    ds_read_b64_tr_b16 v[150:151], v23 offset:23072
    s_waitcnt lgkmcnt(10)
    v_mfma_f32_16x16x32_bf16 a[40:43], v[128:131], v[100:103], a[40:43]
    ds_read_b64_tr_b16 v[124:125], v23 offset:18496
    v_mfma_f32_16x16x32_bf16 a[44:47], v[128:131], v[104:107], a[44:47]
    ds_read_b64_tr_b16 v[126:127], v23 offset:23104
    s_waitcnt lgkmcnt(10)
    v_mfma_f32_16x16x32_bf16 a[48:51], v[132:135], v[100:103], a[48:51]
    ds_read_b64_tr_b16 v[128:129], v23 offset:18528
    v_mfma_f32_16x16x32_bf16 a[52:55], v[132:135], v[104:107], a[52:55]
    ds_read_b64_tr_b16 v[130:131], v23 offset:23136
    s_waitcnt lgkmcnt(10)
    v_mfma_f32_16x16x32_bf16 a[56:59], v[136:139], v[100:103], a[56:59]
    ds_read_b64_tr_b16 v[132:133], v23 offset:18560
    v_mfma_f32_16x16x32_bf16 a[60:63], v[136:139], v[104:107], a[60:63]
    ds_read_b64_tr_b16 v[134:135], v23 offset:23168
    s_waitcnt lgkmcnt(10)
    v_mfma_f32_16x16x32_bf16 a[64:67], v[140:143], v[100:103], a[64:67]
    ds_read_b64_tr_b16 v[136:137], v23 offset:18592
    v_mfma_f32_16x16x32_bf16 a[68:71], v[140:143], v[104:107], a[68:71]
    ds_read_b64_tr_b16 v[138:139], v23 offset:23200
    s_waitcnt lgkmcnt(10)
    v_mfma_f32_16x16x32_bf16 a[0:3], v[144:147], v[108:111], a[0:3]
    ds_read_b64_tr_b16 v[140:141], v23 offset:18624
    v_mfma_f32_16x16x32_bf16 a[4:7], v[144:147], v[112:115], a[4:7]
    ds_read_b64_tr_b16 v[142:143], v23 offset:23232
    s_waitcnt lgkmcnt(10)
    v_mfma_f32_16x16x32_bf16 a[8:11], v[148:151], v[108:111], a[8:11]
    ds_read_b64_tr_b16 v[144:145], v23 offset:18656
    v_mfma_f32_16x16x32_bf16 a[12:15], v[148:151], v[112:115], a[12:15]
    ds_read_b64_tr_b16 v[146:147], v23 offset:23264
    s_waitcnt lgkmcnt(10)
    v_mfma_f32_16x16x32_bf16 a[16:19], v[124:127], v[108:111], a[16:19]
    ds_read_b64_tr_b16 v[148:149], v23 offset:18688
    v_mfma_f32_16x16x32_bf16 a[20:23], v[124:127], v[112:115], a[20:23]
    ds_read_b64_tr_b16 v[150:151], v23 offset:23296
    s_waitcnt lgkmcnt(10)
    v_mfma_f32_16x16x32_bf16 a[24:27], v[128:131], v[108:111], a[24:27]
    ds_read_b64_tr_b16 v[124:125], v23 offset:27648
    v_mfma_f32_16x16x32_bf16 a[28:31], v[128:131], v[112:115], a[28:31]
    ds_read_b64_tr_b16 v[126:127], v23 offset:32256
    s_waitcnt lgkmcnt(10)
    v_mfma_f32_16x16x32_bf16 a[32:35], v[132:135], v[108:111], a[32:35]
    ds_read_b64_tr_b16 v[128:129], v23 offset:27680
    v_mfma_f32_16x16x32_bf16 a[36:39], v[132:135], v[112:115], a[36:39]
    ds_read_b64_tr_b16 v[130:131], v23 offset:32288
    s_waitcnt lgkmcnt(10)
    v_mfma_f32_16x16x32_bf16 a[40:43], v[136:139], v[108:111], a[40:43]
    ds_read_b64_tr_b16 v[132:133], v23 offset:27712
    v_mfma_f32_16x16x32_bf16 a[44:47], v[136:139], v[112:115], a[44:47]
    ds_read_b64_tr_b16 v[134:135], v23 offset:32320
    s_waitcnt lgkmcnt(10)
    v_mfma_f32_16x16x32_bf16 a[48:51], v[140:143], v[108:111], a[48:51]
    ds_read_b64_tr_b16 v[136:137], v23 offset:27744
    v_mfma_f32_16x16x32_bf16 a[52:55], v[140:143], v[112:115], a[52:55]
    ds_read_b64_tr_b16 v[138:139], v23 offset:32352
    s_waitcnt lgkmcnt(10)
    v_mfma_f32_16x16x32_bf16 a[56:59], v[144:147], v[108:111], a[56:59]
    ds_read_b64_tr_b16 v[140:141], v23 offset:27776
    v_mfma_f32_16x16x32_bf16 a[60:63], v[144:147], v[112:115], a[60:63]
    ds_read_b64_tr_b16 v[142:143], v23 offset:32384
    s_waitcnt lgkmcnt(10)
    v_mfma_f32_16x16x32_bf16 a[64:67], v[148:151], v[108:111], a[64:67]
    ds_read_b64_tr_b16 v[144:145], v23 offset:27808
    v_mfma_f32_16x16x32_bf16 a[68:71], v[148:151], v[112:115], a[68:71]
    ds_read_b64_tr_b16 v[146:147], v23 offset:32416
    s_waitcnt lgkmcnt(10)
    v_mfma_f32_16x16x32_bf16 a[0:3], v[124:127], v[116:119], a[0:3]
    ds_read_b64_tr_b16 v[148:149], v23 offset:27840
    v_mfma_f32_16x16x32_bf16 a[4:7], v[124:127], v[120:123], a[4:7]
    ds_read_b64_tr_b16 v[150:151], v23 offset:32448
    s_waitcnt lgkmcnt(10)
    v_mfma_f32_16x16x32_bf16 a[8:11], v[128:131], v[116:119], a[8:11]
    ds_read_b64_tr_b16 v[124:125], v23 offset:27872
    v_mfma_f32_16x16x32_bf16 a[12:15], v[128:131], v[120:123], a[12:15]
    ds_read_b64_tr_b16 v[126:127], v23 offset:32480
    s_waitcnt lgkmcnt(10)
    v_mfma_f32_16x16x32_bf16 a[16:19], v[132:135], v[116:119], a[16:19]
    ds_read_b64_tr_b16 v[128:129], v23 offset:27904
    v_mfma_f32_16x16x32_bf16 a[20:23], v[132:135], v[120:123], a[20:23]
    ds_read_b64_tr_b16 v[130:131], v23 offset:32512
    s_waitcnt lgkmcnt(10)
    v_mfma_f32_16x16x32_bf16 a[24:27], v[136:139], v[116:119], a[24:27]
    v_mfma_f32_16x16x32_bf16 a[28:31], v[136:139], v[120:123], a[28:31]
    s_waitcnt lgkmcnt(8)
    v_mfma_f32_16x16x32_bf16 a[32:35], v[140:143], v[116:119], a[32:35]
    v_mfma_f32_16x16x32_bf16 a[36:39], v[140:143], v[120:123], a[36:39]
    s_waitcnt lgkmcnt(6)
    v_mfma_f32_16x16x32_bf16 a[40:43], v[144:147], v[116:119], a[40:43]
    v_mfma_f32_16x16x32_bf16 a[44:47], v[144:147], v[120:123], a[44:47]
    s_waitcnt lgkmcnt(4)
    v_mfma_f32_16x16x32_bf16 a[48:51], v[148:151], v[116:119], a[48:51]
    v_mfma_f32_16x16x32_bf16 a[52:55], v[148:151], v[120:123], a[52:55]
    s_waitcnt lgkmcnt(2)
    v_mfma_f32_16x16x32_bf16 a[56:59], v[124:127], v[116:119], a[56:59]
    v_mfma_f32_16x16x32_bf16 a[60:63], v[124:127], v[120:123], a[60:63]
    s_waitcnt lgkmcnt(0)
    v_mfma_f32_16x16x32_bf16 a[64:67], v[128:131], v[116:119], a[64:67]
    v_mfma_f32_16x16x32_bf16 a[68:71], v[128:131], v[120:123], a[68:71]
    s_nop 7
    s_nop 7
    s_lshl_b32 s36, s16, 7
    s_lshl_b32 s37, s15, 3
    s_add_u32 s36, s36, s37
    s_lshl_b32 s37, s17, 1
    s_add_u32 s36, s36, s37
    s_mul_i32 s36, s36, 36864
    s_mul_i32 s37, s14, 9216
    s_add_u32 s36, s36, s37
    v_lshlrev_b32 v3, 4, v2
    v_add_u32 v3, s36, v3
    s_mov_b32 s41, 0
    buffer_store_dwordx4 a[0:3], v3, s[28:31], s41 offen sc1
    s_mov_b32 s41, 1024
    buffer_store_dwordx4 a[8:11], v3, s[28:31], s41 offen sc1
    s_mov_b32 s41, 2048
    buffer_store_dwordx4 a[16:19], v3, s[28:31], s41 offen sc1
    s_mov_b32 s41, 3072
    buffer_store_dwordx4 a[24:27], v3, s[28:31], s41 offen sc1
    s_mov_b32 s41, 4096
    buffer_store_dwordx4 a[32:35], v3, s[28:31], s41 offen sc1
    s_mov_b32 s41, 5120
    buffer_store_dwordx4 a[40:43], v3, s[28:31], s41 offen sc1
    s_mov_b32 s41, 6144
    buffer_store_dwordx4 a[48:51], v3, s[28:31], s41 offen sc1
    s_mov_b32 s41, 7168
    buffer_store_dwordx4 a[56:59], v3, s[28:31], s41 offen sc1
    s_mov_b32 s41, 8192
    buffer_store_dwordx4 a[64:67], v3, s[28:31], s41 offen sc1
    s_mov_b32 s41, 36864
    buffer_store_dwordx4 a[4:7], v3, s[28:31], s41 offen sc1
    s_mov_b32 s41, 37888
    buffer_store_dwordx4 a[12:15], v3, s[28:31], s41 offen sc1
    s_mov_b32 s41, 38912
    buffer_store_dwordx4 a[20:23], v3, s[28:31], s41 offen sc1
    s_mov_b32 s41, 39936
    buffer_store_dwordx4 a[28:31], v3, s[28:31], s41 offen sc1
    s_mov_b32 s41, 40960
    buffer_store_dwordx4 a[36:39], v3, s[28:31], s41 offen sc1
    s_mov_b32 s41, 41984
    buffer_store_dwordx4 a[44:47], v3, s[28:31], s41 offen sc1
    s_mov_b32 s41, 43008
    buffer_store_dwordx4 a[52:55], v3, s[28:31], s41 offen sc1
    s_mov_b32 s41, 44032
    buffer_store_dwordx4 a[60:63], v3, s[28:31], s41 offen sc1
    s_mov_b32 s41, 45056
    buffer_store_dwordx4 a[68:71], v3, s[28:31], s41 offen sc1
    s_endpgm
L_gemm2_kernel_conv:
    s_cmp_ge_u32 s2, 144
    s_cbranch_scc1 L_gemm2_kernel_exit
    s_sub_u32 s17, s17, 4
    s_barrier
    s_lshl_b32 s42, s2, 2
    s_add_u32 s42, s42, s17
    s_lshl_b32 s43, s42, 12
    s_add_u32 s64, s44, s43
    s_addc_u32 s65, s45, 0
    s_movk_i32 s66, 4096
    s_mov_b32 s67, 0x00020000
    s_mul_i32 s43, s42, 4608
    s_add_u32 s43, s43, 47222784
    s_add_u32 s68, s10, s43
    s_addc_u32 s69, s11, 0
    s_movk_i32 s70, 4608
    s_mov_b32 s71, 0x00020000
    s_mul_i32 s72, s17, 12928
    s_add_u32 s72, s72, 110592
    v_lshlrev_b32 v160, 4, v2
    v_subrev_u32 v161, 32, v160
    v_subrev_u32 v162, 30, v160
    s_add_u32 m0, s72, 0
    s_nop 0
    buffer_load_dwordx4 v161, s[64:67], 0 offen lds
    s_add_u32 m0, s72, 1024
    s_movk_i32 s43, 992
    buffer_load_dwordx4 v160, s[64:67], s43 offen lds
    s_add_u32 m0, s72, 2048
    s_movk_i32 s43, 2016
    buffer_load_dwordx4 v160, s[64:67], s43 offen lds
    s_add_u32 m0, s72, 3072
    s_movk_i32 s43, 3040
    buffer_load_dwordx4 v160, s[64:67], s43 offen lds
    s_mov_b64 exec, 15
    s_add_u32 m0, s72, 4096
    s_movk_i32 s43, 4064
    buffer_load_dwordx4 v160, s[64:67], s43 offen lds
    s_mov_b64 exec, -1
    s_add_u32 m0, s72, 4160
    s_nop 0
    buffer_load_dwordx4 v162, s[64:67], 0 offen lds
    s_add_u32 m0, s72, 5184
    s_movk_i32 s43, 994
    buffer_load_dwordx4 v160, s[64:67], s43 offen lds
    s_add_u32 m0, s72, 6208
    s_movk_i32 s43, 2018
    buffer_load_dwordx4 v160, s[64:67], s43 offen lds
    s_add_u32 m0, s72, 7232
    s_movk_i32 s43, 3042
    buffer_load_dwordx4 v160, s[64:67], s43 offen lds
    s_mov_b64 exec, 15
    s_add_u32 m0, s72, 8256
    s_movk_i32 s43, 4066
    buffer_load_dwordx4 v160, s[64:67], s43 offen lds
    s_mov_b64 exec, -1
    s_add_u32 m0, s72, 8320
    s_movk_i32 s43, 0
    buffer_load_dwordx4 v160, s[68:71], s43 offen lds
    s_add_u32 m0, s72, 9344
    s_movk_i32 s43, 1024
    buffer_load_dwordx4 v160, s[68:71], s43 offen lds
    s_add_u32 m0, s72, 10368
    s_movk_i32 s43, 2048
    buffer_load_dwordx4 v160, s[68:71], s43 offen lds
    s_add_u32 m0, s72, 11392
    s_movk_i32 s43, 3072
    buffer_load_dwordx4 v160, s[68:71], s43 offen lds
    s_mov_b64 exec, 0xffffffff
    s_add_u32 m0, s72, 12416
    s_movk_i32 s43, 4096
    buffer_load_dwordx4 v160, s[68:71], s43 offen lds
    s_mov_b64 exec, -1
    v_mov_b32 v163, 0
    buffer_load_short_d16 v163, off, s[64:67], 0
    s_lshr_b32 s43, s42, 1
    s_lshl_b32 s43, s43, 2
    s_load_dword s73, s[46:47], s43
    s_barrier
    s_add_u32 s76, s10, 4718592
    s_addc_u32 s77, s11, 0
    s_mov_b32 s78, 2359296
    s_mov_b32 s79, 0x00020000
    v_and_b32 v164, 15, v2
    v_lshrrev_b32 v165, 4, v2
    v_add_u32 v166, 1, v164
    v_and_b32 v167, 1, v166
    v_sub_u32 v166, v166, v167
    v_lshl_add_u32 v166, v165, 3, v166
    v_lshlrev_b32 v166, 1, v166
    v_mul_u32_u24 v167, 4160, v167
    v_add_u32 v166, v166, v167
    v_add_u32 v166, s72, v166
    v_add_u32 v167, 1024, v166
    v_add_u32 v168, 2048, v166
    v_add_u32 v169, 3072, v166
    v_lshlrev_b32 v170, 5, v164
    v_sub_u32 v170, 8800, v170
    v_lshl_add_u32 v170, v165, 4, v170
    v_add_u32 v170, s72, v170
    s_waitcnt vmcnt(0)
    s_barrier
    v_mov_b32 v171, s72
    s_mov_b64 exec, 1
    ds_write_b16 v171, v163 offset:4190
    s_mov_b64 exec, -1
    s_waitcnt lgkmcnt(0)
    ds_read2_b32 v[32:33], v166 offset0:0 offset1:1
    ds_read2_b32 v[34:35], v166 offset0:2 offset1:3
    ds_read2_b32 v[36:37], v166 offset0:128 offset1:129
    ds_read2_b32 v[38:39], v166 offset0:130 offset1:131
    ds_read2_b32 v[40:41], v167 offset0:0 offset1:1
    ds_read2_b32 v[42:43], v167 offset0:2 offset1:3
    ds_read2_b32 v[44:45], v167 offset0:128 offset1:129
    ds_read2_b32 v[46:47], v167 offset0:130 offset1:131
    ds_read2_b32 v[48:49], v168 offset0:0 offset1:1
    ds_read2_b32 v[50:51], v168 offset0:2 offset1:3
    ds_read2_b32 v[52:53], v168 offset0:128 offset1:129
    ds_read2_b32 v[54:55], v168 offset0:130 offset1:131
    ds_read2_b32 v[56:57], v169 offset0:0 offset1:1
    ds_read2_b32 v[58:59], v169 offset0:2 offset1:3
    ds_read2_b32 v[60:61], v169 offset0:128 offset1:129
    ds_read2_b32 v[62:63], v169 offset0:130 offset1:131
    ds_read_b128 v[64:67], v170 offset:3584
    ds_read_b128 v[68:71], v170 offset:3072
    ds_read_b128 v[72:75], v170 offset:2560
    ds_read_b128 v[76:79], v170 offset:2048
    ds_read_b128 v[80:83], v170 offset:1536
    ds_read_b128 v[84:87], v170 offset:1024
    ds_read_b128 v[88:91], v170 offset:512
    ds_read_b128 v[92:95], v170 offset:0
    s_waitcnt lgkmcnt(0)
    v_mfma_f32_16x16x32_bf16 a[0:3], v[32:35], v[64:67], 0
    ds_read2_b32 v[96:97], v166 offset0:16 offset1:17
    v_mfma_f32_16x16x32_bf16 a[4:7], v[32:35], v[68:71], 0
    ds_read2_b32 v[98:99], v166 offset0:18 offset1:19
    v_mfma_f32_16x16x32_bf16 a[8:11], v[32:35], v[72:75], 0
    ds_read2_b32 v[100:101], v166 offset0:144 offset1:145
    v_mfma_f32_16x16x32_bf16 a[12:15], v[32:35], v[76:79], 0
    ds_read2_b32 v[102:103], v166 offset0:146 offset1:147
    v_mfma_f32_16x16x32_bf16 a[16:19], v[32:35], v[80:83], 0
    ds_read2_b32 v[104:105], v167 offset0:16 offset1:17
    v_mfma_f32_16x16x32_bf16 a[20:23], v[32:35], v[84:87], 0
    ds_read2_b32 v[106:107], v167 offset0:18 offset1:19
    v_mfma_f32_16x16x32_bf16 a[24:27], v[32:35], v[88:91], 0
    ds_read2_b32 v[108:109], v167 offset0:144 offset1:145
    v_mfma_f32_16x16x32_bf16 a[28:31], v[32:35], v[92:95], 0
    ds_read2_b32 v[110:111], v167 offset0:146 offset1:147
    v_mfma_f32_16x16x32_bf16 a[4:7], v[36:39], v[64:67], a[4:7]
    ds_read2_b32 v[112:113], v168 offset0:16 offset1:17
    v_mfma_f32_16x16x32_bf16 a[8:11], v[36:39], v[68:71], a[8:11]
    ds_read2_b32 v[114:115], v168 offset0:18 offset1:19
    v_mfma_f32_16x16x32_bf16 a[12:15], v[36:39], v[72:75], a[12:15]
    ds_read2_b32 v[116:117], v168 offset0:144 offset1:145
    v_mfma_f32_16x16x32_bf16 a[16:19], v[36:39], v[76:79], a[16:19]
    ds_read2_b32 v[118:119], v168 offset0:146 offset1:147
    v_mfma_f32_16x16x32_bf16 a[20:23], v[36:39], v[80:83], a[20:23]
    ds_read2_b32 v[120:121], v169 offset0:16 offset1:17
    v_mfma_f32_16x16x32_bf16 a[24:27], v[36:39], v[84:87], a[24:27]
    ds_read2_b32 v[122:123], v169 offset0:18 offset1:19
    v_mfma_f32_16x16x32_bf16 a[28:31], v[36:39], v[88:91], a[28:31]
    ds_read2_b32 v[124:125], v169 offset0:144 offset1:145
    v_mfma_f32_16x16x32_bf16 a[8:11], v[40:43], v[64:67], a[8:11]
    ds_read2_b32 v[126:127], v169 offset0:146 offset1:147
    v_mfma_f32_16x16x32_bf16 a[12:15], v[40:43], v[68:71], a[12:15]
    ds_read_b128 v[128:131], v170 offset:3648
    v_mfma_f32_16x16x32_bf16 a[16:19], v[40:43], v[72:75], a[16:19]
    ds_read_b128 v[132:135], v170 offset:3136
    v_mfma_f32_16x16x32_bf16 a[20:23], v[40:43], v[76:79], a[20:23]
    ds_read_b128 v[136:139], v170 offset:2624
    v_mfma_f32_16x16x32_bf16 a[24:27], v[40:43], v[80:83], a[24:27]
    ds_read_b128 v[140:143], v170 offset:2112
    v_mfma_f32_16x16x32_bf16 a[28:31], v[40:43], v[84:87], a[28:31]
    ds_read_b128 v[144:147], v170 offset:1600
    v_mfma_f32_16x16x32_bf16 a[12:15], v[44:47], v[64:67], a[12:15]
    ds_read_b128 v[148:151], v170 offset:1088
    v_mfma_f32_16x16x32_bf16 a[16:19], v[44:47], v[68:71], a[16:19]
    ds_read_b128 v[152:155], v170 offset:576
    v_mfma_f32_16x16x32_bf16 a[20:23], v[44:47], v[72:75], a[20:23]
    ds_read_b128 v[156:159], v170 offset:64
    v_mfma_f32_16x16x32_bf16 a[24:27], v[44:47], v[76:79], a[24:27]
    v_mfma_f32_16x16x32_bf16 a[28:31], v[44:47], v[80:83], a[28:31]
    v_mfma_f32_16x16x32_bf16 a[16:19], v[48:51], v[64:67], a[16:19]
    v_mfma_f32_16x16x32_bf16 a[20:23], v[48:51], v[68:71], a[20:23]
    v_mfma_f32_16x16x32_bf16 a[24:27], v[48:51], v[72:75], a[24:27]
    v_mfma_f32_16x16x32_bf16 a[28:31], v[48:51], v[76:79], a[28:31]
    v_mfma_f32_16x16x32_bf16 a[20:23], v[52:55], v[64:67], a[20:23]
    v_mfma_f32_16x16x32_bf16 a[24:27], v[52:55], v[68:71], a[24:27]
    v_mfma_f32_16x16x32_bf16 a[28:31], v[52:55], v[72:75], a[28:31]
    v_mfma_f32_16x16x32_bf16 a[24:27], v[56:59], v[64:67], a[24:27]
    v_mfma_f32_16x16x32_bf16 a[28:31], v[56:59], v[68:71], a[28:31]
    v_mfma_f32_16x16x32_bf16 a[28:31], v[60:63], v[64:67], a[28:31]
    s_waitcnt lgkmcnt(0)
    v_mfma_f32_16x16x32_bf16 a[0:3], v[96:99], v[128:131], a[0:3]
    ds_read2_b32 v[32:33], v166 offset0:32 offset1:33
    v_mfma_f32_16x16x32_bf16 a[4:7], v[96:99], v[132:135], a[4:7]
    ds_read2_b32 v[34:35], v166 offset0:34 offset1:35
    v_mfma_f32_16x16x32_bf16 a[8:11], v[96:99], v[136:139], a[8:11]
    ds_read2_b32 v[36:37], v166 offset0:160 offset1:161
    v_mfma_f32_16x16x32_bf16 a[12:15], v[96:99], v[140:143], a[12:15]
    ds_read2_b32 v[38:39], v166 offset0:162 offset1:163
    v_mfma_f32_16x16x32_bf16 a[16:19], v[96:99], v[144:147], a[16:19]
    ds_read2_b32 v[40:41], v167 offset0:32 offset1:33
    v_mfma_f32_16x16x32_bf16 a[20:23], v[96:99], v[148:151], a[20:23]
    ds_read2_b32 v[42:43], v167 offset0:34 offset1:35
    v_mfma_f32_16x16x32_bf16 a[24:27], v[96:99], v[152:155], a[24:27]
    ds_read2_b32 v[44:45], v167 offset0:160 offset1:161
    v_mfma_f32_16x16x32_bf16 a[28:31], v[96:99], v[156:159], a[28:31]
    ds_read2_b32 v[46:47], v167 offset0:162 offset1:163
    v_mfma_f32_16x16x32_bf16 a[4:7], v[100:103], v[128:131], a[4:7]
    ds_read2_b32 v[48:49], v168 offset0:32 offset1:33
    v_mfma_f32_16x16x32_bf16 a[8:11], v[100:103], v[132:135], a[8:11]
    ds_read2_b32 v[50:51], v168 offset0:34 offset1:35
    v_mfma_f32_16x16x32_bf16 a[12:15], v[100:103], v[136:139], a[12:15]
    ds_read2_b32 v[52:53], v168 offset0:160 offset1:161
    v_mfma_f32_16x16x32_bf16 a[16:19], v[100:103], v[140:143], a[16:19]
    ds_read2_b32 v[54:55], v168 offset0:162 offset1:163
    v_mfma_f32_16x16x32_bf16 a[20:23], v[100:103], v[144:147], a[20:23]
    ds_read2_b32 v[56:57], v169 offset0:32 offset1:33
    v_mfma_f32_16x16x32_bf16 a[24:27], v[100:103], v[148:151], a[24:27]
    ds_read2_b32 v[58:59], v169 offset0:34 offset1:35
    v_mfma_f32_16x16x32_bf16 a[28:31], v[100:103], v[152:155], a[28:31]
    ds_read2_b32 v[60:61], v169 offset0:160 offset1:161
    v_mfma_f32_16x16x32_bf16 a[8:11], v[104:107], v[128:131], a[8:11]
    ds_read2_b32 v[62:63], v169 offset0:162 offset1:163
    v_mfma_f32_16x16x32_bf16 a[12:15], v[104:107], v[132:135], a[12:15]
    ds_read_b128 v[64:67], v170 offset:3712
    v_mfma_f32_16x16x32_bf16 a[16:19], v[104:107], v[136:139], a[16:19]
    ds_read_b128 v[68:71], v170 offset:3200
    v_mfma_f32_16x16x32_bf16 a[20:23], v[104:107], v[140:143], a[20:23]
    ds_read_b128 v[72:75], v170 offset:2688
    v_mfma_f32_16x16x32_bf16 a[24:27], v[104:107], v[144:147], a[24:27]
    ds_read_b128 v[76:79], v170 offset:2176
    v_mfma_f32_16x16x32_bf16 a[28:31], v[104:107], v[148:151], a[28:31]
    ds_read_b128 v[80:83], v170 offset:1664
    v_mfma_f32_16x16x32_bf16 a[12:15], v[108:111], v[128:131], a[12:15]
    ds_read_b128 v[84:87], v170 offset:1152
    v_mfma_f32_16x16x32_bf16 a[16:19], v[108:111], v[132:135], a[16:19]
    ds_read_b128 v[88:91], v170 offset:640
    v_mfma_f32_16x16x32_bf16 a[20:23], v[108:111], v[136:139], a[20:23]
    ds_read_b128 v[92:95], v170 offset:128
    v_mfma_f32_16x16x32_bf16 a[24:27], v[108:111], v[140:143], a[24:27]
    v_mfma_f32_16x16x32_bf16 a[28:31], v[108:111], v[144:147], a[28:31]
    v_mfma_f32_16x16x32_bf16 a[16:19], v[112:115], v[128:131], a[16:19]
    v_mfma_f32_16x16x32_bf16 a[20:23], v[112:115], v[132:135], a[20:23]
    v_mfma_f32_16x16x32_bf16 a[24:27], v[112:115], v[136:139], a[24:27]
    v_mfma_f32_16x16x32_bf16 a[28:31], v[112:115], v[140:143], a[28:31]
    v_mfma_f32_16x16x32_bf16 a[20:23], v[116:119], v[128:131], a[20:23]
    v_mfma_f32_16x16x32_bf16 a[24:27], v[116:119], v[132:135], a[24:27]
    v_mfma_f32_16x16x32_bf16 a[28:31], v[116:119], v[136:139], a[28:31]
    v_mfma_f32_16x16x32_bf16 a[24:27], v[120:123], v[128:131], a[24:27]
    v_mfma_f32_16x16x32_bf16 a[28:31], v[120:123], v[132:135], a[28:31]
    v_mfma_f32_16x16x32_bf16 a[28:31], v[124:127], v[128:131], a[28:31]
    s_barrier
    s_waitcnt lgkmcnt(0)
    v_mfma_f32_16x16x32_bf16 a[0:3], v[32:35], v[64:67], a[0:3]
    ds_read2_b32 v[96:97], v166 offset0:48 offset1:49
    v_mfma_f32_16x16x32_bf16 a[4:7], v[32:35], v[68:71], a[4:7]
    ds_read2_b32 v[98:99], v166 offset0:50 offset1:51
    v_mfma_f32_16x16x32_bf16 a[8:11], v[32:35], v[72:75], a[8:11]
    ds_read2_b32 v[100:101], v166 offset0:176 offset1:177
    v_mfma_f32_16x16x32_bf16 a[12:15], v[32:35], v[76:79], a[12:15]
    ds_read2_b32 v[102:103], v166 offset0:178 offset1:179
    v_mfma_f32_16x16x32_bf16 a[16:19], v[32:35], v[80:83], a[16:19]
    ds_read2_b32 v[104:105], v167 offset0:48 offset1:49
    v_mfma_f32_16x16x32_bf16 a[20:23], v[32:35], v[84:87], a[20:23]
    ds_read2_b32 v[106:107], v167 offset0:50 offset1:51
    v_mfma_f32_16x16x32_bf16 a[24:27], v[32:35], v[88:91], a[24:27]
    ds_read2_b32 v[108:109], v167 offset0:176 offset1:177
    v_mfma_f32_16x16x32_bf16 a[28:31], v[32:35], v[92:95], a[28:31]
    ds_read2_b32 v[110:111], v167 offset0:178 offset1:179
    v_mfma_f32_16x16x32_bf16 a[4:7], v[36:39], v[64:67], a[4:7]
    ds_read2_b32 v[112:113], v168 offset0:48 offset1:49
    v_mfma_f32_16x16x32_bf16 a[8:11], v[36:39], v[68:71], a[8:11]
    ds_read2_b32 v[114:115], v168 offset0:50 offset1:51
    v_mfma_f32_16x16x32_bf16 a[12:15], v[36:39], v[72:75], a[12:15]
    ds_read2_b32 v[116:117], v168 offset0:176 offset1:177
    v_mfma_f32_16x16x32_bf16 a[16:19], v[36:39], v[76:79], a[16:19]
    ds_read2_b32 v[118:119], v168 offset0:178 offset1:179
    v_mfma_f32_16x16x32_bf16 a[20:23], v[36:39], v[80:83], a[20:23]
    ds_read2_b32 v[120:121], v169 offset0:48 offset1:49
    v_mfma_f32_16x16x32_bf16 a[24:27], v[36:39], v[84:87], a[24:27]
    ds_read2_b32 v[122:123], v169 offset0:50 offset1:51
    v_mfma_f32_16x16x32_bf16 a[28:31], v[36:39], v[88:91], a[28:31]
    ds_read2_b32 v[124:125], v169 offset0:176 offset1:177
    v_mfma_f32_16x16x32_bf16 a[8:11], v[40:43], v[64:67], a[8:11]
    ds_read2_b32 v[126:127], v169 offset0:178 offset1:179
    v_mfma_f32_16x16x32_bf16 a[12:15], v[40:43], v[68:71], a[12:15]
    ds_read_b128 v[128:131], v170 offset:3776
    v_mfma_f32_16x16x32_bf16 a[16:19], v[40:43], v[72:75], a[16:19]
    ds_read_b128 v[132:135], v170 offset:3264
    v_mfma_f32_16x16x32_bf16 a[20:23], v[40:43], v[76:79], a[20:23]
    ds_read_b128 v[136:139], v170 offset:2752
    v_mfma_f32_16x16x32_bf16 a[24:27], v[40:43], v[80:83], a[24:27]
    ds_read_b128 v[140:143], v170 offset:2240
    v_mfma_f32_16x16x32_bf16 a[28:31], v[40:43], v[84:87], a[28:31]
    ds_read_b128 v[144:147], v170 offset:1728
    v_mfma_f32_16x16x32_bf16 a[12:15], v[44:47], v[64:67], a[12:15]
    ds_read_b128 v[148:151], v170 offset:1216
    v_mfma_f32_16x16x32_bf16 a[16:19], v[44:47], v[68:71], a[16:19]
    ds_read_b128 v[152:155], v170 offset:704
    v_mfma_f32_16x16x32_bf16 a[20:23], v[44:47], v[72:75], a[20:23]
    ds_read_b128 v[156:159], v170 offset:192
    v_mfma_f32_16x16x32_bf16 a[24:27], v[44:47], v[76:79], a[24:27]
    v_mfma_f32_16x16x32_bf16 a[28:31], v[44:47], v[80:83], a[28:31]
    v_mfma_f32_16x16x32_bf16 a[16:19], v[48:51], v[64:67], a[16:19]
    v_mfma_f32_16x16x32_bf16 a[20:23], v[48:51], v[68:71], a[20:23]
    v_mfma_f32_16x16x32_bf16 a[24:27], v[48:51], v[72:75], a[24:27]
    v_mfma_f32_16x16x32_bf16 a[28:31], v[48:51], v[76:79], a[28:31]
    v_mfma_f32_16x16x32_bf16 a[20:23], v[52:55], v[64:67], a[20:23]
    v_mfma_f32_16x16x32_bf16 a[24:27], v[52:55], v[68:71], a[24:27]
    v_mfma_f32_16x16x32_bf16 a[28:31], v[52:55], v[72:75], a[28:31]
    v_mfma_f32_16x16x32_bf16 a[24:27], v[56:59], v[64:67], a[24:27]
    v_mfma_f32_16x16x32_bf16 a[28:31], v[56:59], v[68:71], a[28:31]
    v_mfma_f32_16x16x32_bf16 a[28:31], v[60:63], v[64:67], a[28:31]
    s_waitcnt lgkmcnt(0)
    v_mfma_f32_16x16x32_bf16 a[0:3], v[96:99], v[128:131], a[0:3]
    ds_read2_b32 v[32:33], v166 offset0:64 offset1:65
    v_mfma_f32_16x16x32_bf16 a[4:7], v[96:99], v[132:135], a[4:7]
    ds_read2_b32 v[34:35], v166 offset0:66 offset1:67
    v_mfma_f32_16x16x32_bf16 a[8:11], v[96:99], v[136:139], a[8:11]
    ds_read2_b32 v[36:37], v166 offset0:192 offset1:193
    v_mfma_f32_16x16x32_bf16 a[12:15], v[96:99], v[140:143], a[12:15]
    ds_read2_b32 v[38:39], v166 offset0:194 offset1:195
    v_mfma_f32_16x16x32_bf16 a[16:19], v[96:99], v[144:147], a[16:19]
    ds_read2_b32 v[40:41], v167 offset0:64 offset1:65
    v_mfma_f32_16x16x32_bf16 a[20:23], v[96:99], v[148:151], a[20:23]
    ds_read2_b32 v[42:43], v167 offset0:66 offset1:67
    v_mfma_f32_16x16x32_bf16 a[24:27], v[96:99], v[152:155], a[24:27]
    ds_read2_b32 v[44:45], v167 offset0:192 offset1:193
    v_mfma_f32_16x16x32_bf16 a[28:31], v[96:99], v[156:159], a[28:31]
    ds_read2_b32 v[46:47], v167 offset0:194 offset1:195
    v_mfma_f32_16x16x32_bf16 a[4:7], v[100:103], v[128:131], a[4:7]
    ds_read2_b32 v[48:49], v168 offset0:64 offset1:65
    v_mfma_f32_16x16x32_bf16 a[8:11], v[100:103], v[132:135], a[8:11]
    ds_read2_b32 v[50:51], v168 offset0:66 offset1:67
    v_mfma_f32_16x16x32_bf16 a[12:15], v[100:103], v[136:139], a[12:15]
    ds_read2_b32 v[52:53], v168 offset0:192 offset1:193
    v_mfma_f32_16x16x32_bf16 a[16:19], v[100:103], v[140:143], a[16:19]
    ds_read2_b32 v[54:55], v168 offset0:194 offset1:195
    v_mfma_f32_16x16x32_bf16 a[20:23], v[100:103], v[144:147], a[20:23]
    ds_read2_b32 v[56:57], v169 offset0:64 offset1:65
    v_mfma_f32_16x16x32_bf16 a[24:27], v[100:103], v[148:151], a[24:27]
    ds_read2_b32 v[58:59], v169 offset0:66 offset1:67
    v_mfma_f32_16x16x32_bf16 a[28:31], v[100:103], v[152:155], a[28:31]
    ds_read2_b32 v[60:61], v169 offset0:192 offset1:193
    v_mfma_f32_16x16x32_bf16 a[8:11], v[104:107], v[128:131], a[8:11]
    ds_read2_b32 v[62:63], v169 offset0:194 offset1:195
    v_mfma_f32_16x16x32_bf16 a[12:15], v[104:107], v[132:135], a[12:15]
    ds_read_b128 v[64:67], v170 offset:3840
    v_mfma_f32_16x16x32_bf16 a[16:19], v[104:107], v[136:139], a[16:19]
    ds_read_b128 v[68:71], v170 offset:3328
    v_mfma_f32_16x16x32_bf16 a[20:23], v[104:107], v[140:143], a[20:23]
    ds_read_b128 v[72:75], v170 offset:2816
    v_mfma_f32_16x16x32_bf16 a[24:27], v[104:107], v[144:147], a[24:27]
    ds_read_b128 v[76:79], v170 offset:2304
    v_mfma_f32_16x16x32_bf16 a[28:31], v[104:107], v[148:151], a[28:31]
    ds_read_b128 v[80:83], v170 offset:1792
    v_mfma_f32_16x16x32_bf16 a[12:15], v[108:111], v[128:131], a[12:15]
    ds_read_b128 v[84:87], v170 offset:1280
    v_mfma_f32_16x16x32_bf16 a[16:19], v[108:111], v[132:135], a[16:19]
    ds_read_b128 v[88:91], v170 offset:768
    v_mfma_f32_16x16x32_bf16 a[20:23], v[108:111], v[136:139], a[20:23]
    ds_read_b128 v[92:95], v170 offset:256
    v_mfma_f32_16x16x32_bf16 a[24:27], v[108:111], v[140:143], a[24:27]
    v_mfma_f32_16x16x32_bf16 a[28:31], v[108:111], v[144:147], a[28:31]
    v_mfma_f32_16x16x32_bf16 a[16:19], v[112:115], v[128:131], a[16:19]
    v_mfma_f32_16x16x32_bf16 a[20:23], v[112:115], v[132:135], a[20:23]
    v_mfma_f32_16x16x32_bf16 a[24:27], v[112:115], v[136:139], a[24:27]
    v_mfma_f32_16x16x32_bf16 a[28:31], v[112:115], v[140:143], a[28:31]
    v_mfma_f32_16x16x32_bf16 a[20:23], v[116:119], v[128:131], a[20:23]
    v_mfma_f32_16x16x32_bf16 a[24:27], v[116:119], v[132:135], a[24:27]
    v_mfma_f32_16x16x32_bf16 a[28:31], v[116:119], v[136:139], a[28:31]
    v_mfma_f32_16x16x32_bf16 a[24:27], v[120:123], v[128:131], a[24:27]
    v_mfma_f32_16x16x32_bf16 a[28:31], v[120:123], v[132:135], a[28:31]
    v_mfma_f32_16x16x32_bf16 a[28:31], v[124:127], v[128:131], a[28:31]
    s_barrier
    s_waitcnt lgkmcnt(0)
    v_mfma_f32_16x16x32_bf16 a[0:3], v[32:35], v[64:67], a[0:3]
    ds_read2_b32 v[96:97], v166 offset0:80 offset1:81
    v_mfma_f32_16x16x32_bf16 a[4:7], v[32:35], v[68:71], a[4:7]
    ds_read2_b32 v[98:99], v166 offset0:82 offset1:83
    v_mfma_f32_16x16x32_bf16 a[8:11], v[32:35], v[72:75], a[8:11]
    ds_read2_b32 v[100:101], v166 offset0:208 offset1:209
    v_mfma_f32_16x16x32_bf16 a[12:15], v[32:35], v[76:79], a[12:15]
    ds_read2_b32 v[102:103], v166 offset0:210 offset1:211
    v_mfma_f32_16x16x32_bf16 a[16:19], v[32:35], v[80:83], a[16:19]
    ds_read2_b32 v[104:105], v167 offset0:80 offset1:81
    v_mfma_f32_16x16x32_bf16 a[20:23], v[32:35], v[84:87], a[20:23]
    ds_read2_b32 v[106:107], v167 offset0:82 offset1:83
    v_mfma_f32_16x16x32_bf16 a[24:27], v[32:35], v[88:91], a[24:27]
    ds_read2_b32 v[108:109], v167 offset0:208 offset1:209
    v_mfma_f32_16x16x32_bf16 a[28:31], v[32:35], v[92:95], a[28:31]
    ds_read2_b32 v[110:111], v167 offset0:210 offset1:211
    v_mfma_f32_16x16x32_bf16 a[4:7], v[36:39], v[64:67], a[4:7]
    ds_read2_b32 v[112:113], v168 offset0:80 offset1:81
    v_mfma_f32_16x16x32_bf16 a[8:11], v[36:39], v[68:71], a[8:11]
    ds_read2_b32 v[114:115], v168 offset0:82 offset1:83
    v_mfma_f32_16x16x32_bf16 a[12:15], v[36:39], v[72:75], a[12:15]
    ds_read2_b32 v[116:117], v168 offset0:208 offset1:209
    v_mfma_f32_16x16x32_bf16 a[16:19], v[36:39], v[76:79], a[16:19]
    ds_read2_b32 v[118:119], v168 offset0:210 offset1:211
    v_mfma_f32_16x16x32_bf16 a[20:23], v[36:39], v[80:83], a[20:23]
    ds_read2_b32 v[120:121], v169 offset0:80 offset1:81
    v_mfma_f32_16x16x32_bf16 a[24:27], v[36:39], v[84:87], a[24:27]
    ds_read2_b32 v[122:123], v169 offset0:82 offset1:83
    v_mfma_f32_16x16x32_bf16 a[28:31], v[36:39], v[88:91], a[28:31]
    ds_read2_b32 v[124:125], v169 offset0:208 offset1:209
    v_mfma_f32_16x16x32_bf16 a[8:11], v[40:43], v[64:67], a[8:11]
    ds_read2_b32 v[126:127], v169 offset0:210 offset1:211
    v_mfma_f32_16x16x32_bf16 a[12:15], v[40:43], v[68:71], a[12:15]
    ds_read_b128 v[128:131], v170 offset:3904
    v_mfma_f32_16x16x32_bf16 a[16:19], v[40:43], v[72:75], a[16:19]
    ds_read_b128 v[132:135], v170 offset:3392
    v_mfma_f32_16x16x32_bf16 a[20:23], v[40:43], v[76:79], a[20:23]
    ds_read_b128 v[136:139], v170 offset:2880
    v_mfma_f32_16x16x32_bf16 a[24:27], v[40:43], v[80:83], a[24:27]
    ds_read_b128 v[140:143], v170 offset:2368
    v_mfma_f32_16x16x32_bf16 a[28:31], v[40:43], v[84:87], a[28:31]
    ds_read_b128 v[144:147], v170 offset:1856
    v_mfma_f32_16x16x32_bf16 a[12:15], v[44:47], v[64:67], a[12:15]
    ds_read_b128 v[148:151], v170 offset:1344
    v_mfma_f32_16x16x32_bf16 a[16:19], v[44:47], v[68:71], a[16:19]
    ds_read_b128 v[152:155], v170 offset:832
    v_mfma_f32_16x16x32_bf16 a[20:23], v[44:47], v[72:75], a[20:23]
    ds_read_b128 v[156:159], v170 offset:320
    v_mfma_f32_16x16x32_bf16 a[24:27], v[44:47], v[76:79], a[24:27]
    v_mfma_f32_16x16x32_bf16 a[28:31], v[44:47], v[80:83], a[28:31]
    v_mfma_f32_16x16x32_bf16 a[16:19], v[48:51], v[64:67], a[16:19]
    v_mfma_f32_16x16x32_bf16 a[20:23], v[48:51], v[68:71], a[20:23]
    v_mfma_f32_16x16x32_bf16 a[24:27], v[48:51], v[72:75], a[24:27]
    v_mfma_f32_16x16x32_bf16 a[28:31], v[48:51], v[76:79], a[28:31]
    v_mfma_f32_16x16x32_bf16 a[20:23], v[52:55], v[64:67], a[20:23]
    v_mfma_f32_16x16x32_bf16 a[24:27], v[52:55], v[68:71], a[24:27]
    v_mfma_f32_16x16x32_bf16 a[28:31], v[52:55], v[72:75], a[28:31]
    v_mfma_f32_16x16x32_bf16 a[24:27], v[56:59], v[64:67], a[24:27]
    v_mfma_f32_16x16x32_bf16 a[28:31], v[56:59], v[68:71], a[28:31]
    v_mfma_f32_16x16x32_bf16 a[28:31], v[60:63], v[64:67], a[28:31]
    s_waitcnt lgkmcnt(0)
    v_mfma_f32_16x16x32_bf16 a[0:3], v[96:99], v[128:131], a[0:3]
    ds_read2_b32 v[32:33], v166 offset0:96 offset1:97
    v_mfma_f32_16x16x32_bf16 a[4:7], v[96:99], v[132:135], a[4:7]
    ds_read2_b32 v[34:35], v166 offset0:98 offset1:99
    v_mfma_f32_16x16x32_bf16 a[8:11], v[96:99], v[136:139], a[8:11]
    ds_read2_b32 v[36:37], v166 offset0:224 offset1:225
    v_mfma_f32_16x16x32_bf16 a[12:15], v[96:99], v[140:143], a[12:15]
    ds_read2_b32 v[38:39], v166 offset0:226 offset1:227
    v_mfma_f32_16x16x32_bf16 a[16:19], v[96:99], v[144:147], a[16:19]
    ds_read2_b32 v[40:41], v167 offset0:96 offset1:97
    v_mfma_f32_16x16x32_bf16 a[20:23], v[96:99], v[148:151], a[20:23]
    ds_read2_b32 v[42:43], v167 offset0:98 offset1:99
    v_mfma_f32_16x16x32_bf16 a[24:27], v[96:99], v[152:155], a[24:27]
    ds_read2_b32 v[44:45], v167 offset0:224 offset1:225
    v_mfma_f32_16x16x32_bf16 a[28:31], v[96:99], v[156:159], a[28:31]
    ds_read2_b32 v[46:47], v167 offset0:226 offset1:227
    v_mfma_f32_16x16x32_bf16 a[4:7], v[100:103], v[128:131], a[4:7]
    ds_read2_b32 v[48:49], v168 offset0:96 offset1:97
    v_mfma_f32_16x16x32_bf16 a[8:11], v[100:103], v[132:135], a[8:11]
    ds_read2_b32 v[50:51], v168 offset0:98 offset1:99
    v_mfma_f32_16x16x32_bf16 a[12:15], v[100:103], v[136:139], a[12:15]
    ds_read2_b32 v[52:53], v168 offset0:224 offset1:225
    v_mfma_f32_16x16x32_bf16 a[16:19], v[100:103], v[140:143], a[16:19]
    ds_read2_b32 v[54:55], v168 offset0:226 offset1:227
    v_mfma_f32_16x16x32_bf16 a[20:23], v[100:103], v[144:147], a[20:23]
    ds_read2_b32 v[56:57], v169 offset0:96 offset1:97
    v_mfma_f32_16x16x32_bf16 a[24:27], v[100:103], v[148:151], a[24:27]
    ds_read2_b32 v[58:59], v169 offset0:98 offset1:99
    v_mfma_f32_16x16x32_bf16 a[28:31], v[100:103], v[152:155], a[28:31]
    ds_read2_b32 v[60:61], v169 offset0:224 offset1:225
    v_mfma_f32_16x16x32_bf16 a[8:11], v[104:107], v[128:131], a[8:11]
    ds_read2_b32 v[62:63], v169 offset0:226 offset1:227
    v_mfma_f32_16x16x32_bf16 a[12:15], v[104:107], v[132:135], a[12:15]
    ds_read_b128 v[64:67], v170 offset:3968
    v_mfma_f32_16x16x32_bf16 a[16:19], v[104:107], v[136:139], a[16:19]
    ds_read_b128 v[68:71], v170 offset:3456
    v_mfma_f32_16x16x32_bf16 a[20:23], v[104:107], v[140:143], a[20:23]
    ds_read_b128 v[72:75], v170 offset:2944
    v_mfma_f32_16x16x32_bf16 a[24:27], v[104:107], v[144:147], a[24:27]
    ds_read_b128 v[76:79], v170 offset:2432
    v_mfma_f32_16x16x32_bf16 a[28:31], v[104:107], v[148:151], a[28:31]
    ds_read_b128 v[80:83], v170 offset:1920
    v_mfma_f32_16x16x32_bf16 a[12:15], v[108:111], v[128:131], a[12:15]
    ds_read_b128 v[84:87], v170 offset:1408
    v_mfma_f32_16x16x32_bf16 a[16:19], v[108:111], v[132:135], a[16:19]
    ds_read_b128 v[88:91], v170 offset:896
    v_mfma_f32_16x16x32_bf16 a[20:23], v[108:111], v[136:139], a[20:23]
    ds_read_b128 v[92:95], v170 offset:384
    v_mfma_f32_16x16x32_bf16 a[24:27], v[108:111], v[140:143], a[24:27]
    v_mfma_f32_16x16x32_bf16 a[28:31], v[108:111], v[144:147], a[28:31]
    v_mfma_f32_16x16x32_bf16 a[16:19], v[112:115], v[128:131], a[16:19]
    v_mfma_f32_16x16x32_bf16 a[20:23], v[112:115], v[132:135], a[20:23]
    v_mfma_f32_16x16x32_bf16 a[24:27], v[112:115], v[136:139], a[24:27]
    v_mfma_f32_16x16x32_bf16 a[28:31], v[112:115], v[140:143], a[28:31]
    v_mfma_f32_16x16x32_bf16 a[20:23], v[116:119], v[128:131], a[20:23]
    v_mfma_f32_16x16x32_bf16 a[24:27], v[116:119], v[132:135], a[24:27]
    v_mfma_f32_16x16x32_bf16 a[28:31], v[116:119], v[136:139], a[28:31]
    v_mfma_f32_16x16x32_bf16 a[24:27], v[120:123], v[128:131], a[24:27]
    v_mfma_f32_16x16x32_bf16 a[28:31], v[120:123], v[132:135], a[28:31]
    v_mfma_f32_16x16x32_bf16 a[28:31], v[124:127], v[128:131], a[28:31]
    s_barrier
    s_waitcnt lgkmcnt(0)
    v_mfma_f32_16x16x32_bf16 a[0:3], v[32:35], v[64:67], a[0:3]
    ds_read2_b32 v[96:97], v166 offset0:112 offset1:113
    v_mfma_f32_16x16x32_bf16 a[4:7], v[32:35], v[68:71], a[4:7]
    ds_read2_b32 v[98:99], v166 offset0:114 offset1:115
    v_mfma_f32_16x16x32_bf16 a[8:11], v[32:35], v[72:75], a[8:11]
    ds_read2_b32 v[100:101], v166 offset0:240 offset1:241
    v_mfma_f32_16x16x32_bf16 a[12:15], v[32:35], v[76:79], a[12:15]
    ds_read2_b32 v[102:103], v166 offset0:242 offset1:243
    v_mfma_f32_16x16x32_bf16 a[16:19], v[32:35], v[80:83], a[16:19]
    ds_read2_b32 v[104:105], v167 offset0:112 offset1:113
    v_mfma_f32_16x16x32_bf16 a[20:23], v[32:35], v[84:87], a[20:23]
    ds_read2_b32 v[106:107], v167 offset0:114 offset1:115
    v_mfma_f32_16x16x32_bf16 a[24:27], v[32:35], v[88:91], a[24:27]
    ds_read2_b32 v[108:109], v167 offset0:240 offset1:241
    v_mfma_f32_16x16x32_bf16 a[28:31], v[32:35], v[92:95], a[28:31]
    ds_read2_b32 v[110:111], v167 offset0:242 offset1:243
    v_mfma_f32_16x16x32_bf16 a[4:7], v[36:39], v[64:67], a[4:7]
    ds_read2_b32 v[112:113], v168 offset0:112 offset1:113
    v_mfma_f32_16x16x32_bf16 a[8:11], v[36:39], v[68:71], a[8:11]
    ds_read2_b32 v[114:115], v168 offset0:114 offset1:115
    v_mfma_f32_16x16x32_bf16 a[12:15], v[36:39], v[72:75], a[12:15]
    ds_read2_b32 v[116:117], v168 offset0:240 offset1:241
    v_mfma_f32_16x16x32_bf16 a[16:19], v[36:39], v[76:79], a[16:19]
    ds_read2_b32 v[118:119], v168 offset0:242 offset1:243
    v_mfma_f32_16x16x32_bf16 a[20:23], v[36:39], v[80:83], a[20:23]
    ds_read2_b32 v[120:121], v169 offset0:112 offset1:113
    v_mfma_f32_16x16x32_bf16 a[24:27], v[36:39], v[84:87], a[24:27]
    ds_read2_b32 v[122:123], v169 offset0:114 offset1:115
    v_mfma_f32_16x16x32_bf16 a[28:31], v[36:39], v[88:91], a[28:31]
    ds_read2_b32 v[124:125], v169 offset0:240 offset1:241
    v_mfma_f32_16x16x32_bf16 a[8:11], v[40:43], v[64:67], a[8:11]
    ds_read2_b32 v[126:127], v169 offset0:242 offset1:243
    v_mfma_f32_16x16x32_bf16 a[12:15], v[40:43], v[68:71], a[12:15]
    ds_read_b128 v[128:131], v170 offset:4032
    v_mfma_f32_16x16x32_bf16 a[16:19], v[40:43], v[72:75], a[16:19]
    ds_read_b128 v[132:135], v170 offset:3520
    v_mfma_f32_16x16x32_bf16 a[20:23], v[40:43], v[76:79], a[20:23]
    ds_read_b128 v[136:139], v170 offset:3008
    v_mfma_f32_16x16x32_bf16 a[24:27], v[40:43], v[80:83], a[24:27]
    ds_read_b128 v[140:143], v170 offset:2496
    v_mfma_f32_16x16x32_bf16 a[28:31], v[40:43], v[84:87], a[28:31]
    ds_read_b128 v[144:147], v170 offset:1984
    v_mfma_f32_16x16x32_bf16 a[12:15], v[44:47], v[64:67], a[12:15]
    ds_read_b128 v[148:151], v170 offset:1472
    v_mfma_f32_16x16x32_bf16 a[16:19], v[44:47], v[68:71], a[16:19]
    ds_read_b128 v[152:155], v170 offset:960
    v_mfma_f32_16x16x32_bf16 a[20:23], v[44:47], v[72:75], a[20:23]
    ds_read_b128 v[156:159], v170 offset:448
    v_mfma_f32_16x16x32_bf16 a[24:27], v[44:47], v[76:79], a[24:27]
    v_mfma_f32_16x16x32_bf16 a[28:31], v[44:47], v[80:83], a[28:31]
    v_mfma_f32_16x16x32_bf16 a[16:19], v[48:51], v[64:67], a[16:19]
    v_mfma_f32_16x16x32_bf16 a[20:23], v[48:51], v[68:71], a[20:23]
    v_mfma_f32_16x16x32_bf16 a[24:27], v[48:51], v[72:75], a[24:27]
    v_mfma_f32_16x16x32_bf16 a[28:31], v[48:51], v[76:79], a[28:31]
    v_mfma_f32_16x16x32_bf16 a[20:23], v[52:55], v[64:67], a[20:23]
    v_mfma_f32_16x16x32_bf16 a[24:27], v[52:55], v[68:71], a[24:27]
    v_mfma_f32_16x16x32_bf16 a[28:31], v[52:55], v[72:75], a[28:31]
    v_mfma_f32_16x16x32_bf16 a[24:27], v[56:59], v[64:67], a[24:27]
    v_mfma_f32_16x16x32_bf16 a[28:31], v[56:59], v[68:71], a[28:31]
    v_mfma_f32_16x16x32_bf16 a[28:31], v[60:63], v[64:67], a[28:31]
    s_waitcnt lgkmcnt(0)
    v_mul_u32_u24 v171, 24, v165
    v_sub_u32 v171, v170, v171
    v_mfma_f32_16x16x32_bf16 a[0:3], v[96:99], v[128:131], a[0:3]
    ds_read_b64 v[32:33], v171 offset:3608
    v_mfma_f32_16x16x32_bf16 a[4:7], v[96:99], v[132:135], a[4:7]
    ds_read_b64 v[34:35], v171 offset:3096
    v_mfma_f32_16x16x32_bf16 a[8:11], v[96:99], v[136:139], a[8:11]
    ds_read_b64 v[36:37], v171 offset:2584
    v_mfma_f32_16x16x32_bf16 a[12:15], v[96:99], v[140:143], a[12:15]
    ds_read_b64 v[38:39], v171 offset:2072
    v_mfma_f32_16x16x32_bf16 a[16:19], v[96:99], v[144:147], a[16:19]
    ds_read_b64 v[40:41], v171 offset:1560
    v_mfma_f32_16x16x32_bf16 a[20:23], v[96:99], v[148:151], a[20:23]
    ds_read_b64 v[42:43], v171 offset:1048
    v_mfma_f32_16x16x32_bf16 a[24:27], v[96:99], v[152:155], a[24:27]
    ds_read_b64 v[44:45], v171 offset:536
    v_mfma_f32_16x16x32_bf16 a[28:31], v[96:99], v[156:159], a[28:31]
    ds_read_b64 v[46:47], v171 offset:24
    v_mfma_f32_16x16x32_bf16 a[4:7], v[100:103], v[128:131], a[4:7]
    v_mfma_f32_16x16x32_bf16 a[8:11], v[100:103], v[132:135], a[8:11]
    v_mfma_f32_16x16x32_bf16 a[12:15], v[100:103], v[136:139], a[12:15]
    v_mfma_f32_16x16x32_bf16 a[16:19], v[100:103], v[140:143], a[16:19]
    v_mfma_f32_16x16x32_bf16 a[20:23], v[100:103], v[144:147], a[20:23]
    v_mfma_f32_16x16x32_bf16 a[24:27], v[100:103], v[148:151], a[24:27]
    v_mfma_f32_16x16x32_bf16 a[28:31], v[100:103], v[152:155], a[28:31]
    v_mfma_f32_16x16x32_bf16 a[8:11], v[104:107], v[128:131], a[8:11]
    v_mfma_f32_16x16x32_bf16 a[12:15], v[104:107], v[132:135], a[12:15]
    v_mfma_f32_16x16x32_bf16 a[16:19], v[104:107], v[136:139], a[16:19]
    v_mfma_f32_16x16x32_bf16 a[20:23], v[104:107], v[140:143], a[20:23]
    v_mfma_f32_16x16x32_bf16 a[24:27], v[104:107], v[144:147], a[24:27]
    v_mfma_f32_16x16x32_bf16 a[28:31], v[104:107], v[148:151], a[28:31]
    v_mfma_f32_16x16x32_bf16 a[12:15], v[108:111], v[128:131], a[12:15]
    v_mfma_f32_16x16x32_bf16 a[16:19], v[108:111], v[132:135], a[16:19]
    v_mfma_f32_16x16x32_bf16 a[20:23], v[108:111], v[136:139], a[20:23]
    v_mfma_f32_16x16x32_bf16 a[24:27], v[108:111], v[140:143], a[24:27]
    v_mfma_f32_16x16x32_bf16 a[28:31], v[108:111], v[144:147], a[28:31]
    v_mfma_f32_16x16x32_bf16 a[16:19], v[112:115], v[128:131], a[16:19]
    v_mfma_f32_16x16x32_bf16 a[20:23], v[112:115], v[132:135], a[20:23]
    v_mfma_f32_16x16x32_bf16 a[24:27], v[112:115], v[136:139], a[24:27]
    v_mfma_f32_16x16x32_bf16 a[28:31], v[112:115], v[140:143], a[28:31]
    v_mfma_f32_16x16x32_bf16 a[20:23], v[116:119], v[128:131], a[20:23]
    v_mfma_f32_16x16x32_bf16 a[24:27], v[116:119], v[132:135], a[24:27]
    v_mfma_f32_16x16x32_bf16 a[28:31], v[116:119], v[136:139], a[28:31]
    v_mfma_f32_16x16x32_bf16 a[24:27], v[120:123], v[128:131], a[24:27]
    v_mfma_f32_16x16x32_bf16 a[28:31], v[120:123], v[132:135], a[28:31]
    v_mfma_f32_16x16x32_bf16 a[28:31], v[124:127], v[128:131], a[28:31]
    s_barrier
    s_waitcnt lgkmcnt(0)
    s_and_b32 s43, s42, 1
    s_lshl_b32 s74, s73, 16
    s_and_b32 s73, s73, 0xffff0000
    s_cmp_eq_u32 s43, 1
    s_cselect_b32 s73, s73, s74
    s_lshl_b32 s74, s42, 12
    v_lshlrev_b32 v171, 5, v164
    v_lshl_add_u32 v171, v165, 3, v171
    v_add_u32 v171, s74, v171
    s_nop 4
    v_accvgpr_read_b32 v20, a0
    v_accvgpr_read_b32 v21, a1
    v_accvgpr_read_b32 v22, a2
    v_accvgpr_read_b32 v23, a3
    v_and_b32 v8, 0xffff0000, v33
    v_lshlrev_b32 v9, 16, v33
    v_and_b32 v10, 0xffff0000, v32
    v_lshlrev_b32 v11, 16, v32
    v_mul_f32 v8, s73, v8
    v_mul_f32 v9, s73, v9
    v_mul_f32 v10, s73, v10
    v_mul_f32 v11, s73, v11
    v_cvt_pk_bf16_f32 v12, v8, v9
    v_cvt_pk_bf16_f32 v13, v10, v11
    v_cvt_pk_bf16_f32 v14, v20, v21
    v_cvt_pk_bf16_f32 v15, v22, v23
    v_lshlrev_b32 v8, 16, v12
    v_and_b32 v9, 0xffff0000, v12
    v_lshlrev_b32 v10, 16, v14
    v_and_b32 v11, 0xffff0000, v14
    v_add_f32 v8, v8, v10
    v_add_f32 v9, v9, v11
    v_cvt_pk_bf16_f32 v16, v8, v9
    v_lshlrev_b32 v8, 16, v13
    v_and_b32 v9, 0xffff0000, v13
    v_lshlrev_b32 v10, 16, v15
    v_and_b32 v11, 0xffff0000, v15
    v_add_f32 v8, v8, v10
    v_add_f32 v9, v9, v11
    v_cvt_pk_bf16_f32 v17, v8, v9
    buffer_store_dwordx2 v[16:17], v171, s[76:79], 0 offen offset:0
    v_accvgpr_read_b32 v20, a4
    v_accvgpr_read_b32 v21, a5
    v_accvgpr_read_b32 v22, a6
    v_accvgpr_read_b32 v23, a7
    v_and_b32 v8, 0xffff0000, v35
    v_lshlrev_b32 v9, 16, v35
    v_and_b32 v10, 0xffff0000, v34
    v_lshlrev_b32 v11, 16, v34
    v_mul_f32 v8, s73, v8
    v_mul_f32 v9, s73, v9
    v_mul_f32 v10, s73, v10
    v_mul_f32 v11, s73, v11
    v_cvt_pk_bf16_f32 v12, v8, v9
    v_cvt_pk_bf16_f32 v13, v10, v11
    v_cvt_pk_bf16_f32 v14, v20, v21
    v_cvt_pk_bf16_f32 v15, v22, v23
    v_lshlrev_b32 v8, 16, v12
    v_and_b32 v9, 0xffff0000, v12
    v_lshlrev_b32 v10, 16, v14
    v_and_b32 v11, 0xffff0000, v14
    v_add_f32 v8, v8, v10
    v_add_f32 v9, v9, v11
    v_cvt_pk_bf16_f32 v18, v8, v9
    v_lshlrev_b32 v8, 16, v13
    v_and_b32 v9, 0xffff0000, v13
    v_lshlrev_b32 v10, 16, v15
    v_and_b32 v11, 0xffff0000, v15
    v_add_f32 v8, v8, v10
    v_add_f32 v9, v9, v11
    v_cvt_pk_bf16_f32 v19, v8, v9
    buffer_store_dwordx2 v[18:19], v171, s[76:79], 0 offen offset:512
    v_accvgpr_read_b32 v20, a8
    v_accvgpr_read_b32 v21, a9
    v_accvgpr_read_b32 v22, a10
    v_accvgpr_read_b32 v23, a11
    v_and_b32 v8, 0xffff0000, v37
    v_lshlrev_b32 v9, 16, v37
    v_and_b32 v10, 0xffff0000, v36
    v_lshlrev_b32 v11, 16, v36
    v_mul_f32 v8, s73, v8
    v_mul_f32 v9, s73, v9
    v_mul_f32 v10, s73, v10
    v_mul_f32 v11, s73, v11
    v_cvt_pk_bf16_f32 v12, v8, v9
    v_cvt_pk_bf16_f32 v13, v10, v11
    v_cvt_pk_bf16_f32 v14, v20, v21
    v_cvt_pk_bf16_f32 v15, v22, v23
    v_lshlrev_b32 v8, 16, v12
    v_and_b32 v9, 0xffff0000, v12
    v_lshlrev_b32 v10, 16, v14
    v_and_b32 v11, 0xffff0000, v14
    v_add_f32 v8, v8, v10
    v_add_f32 v9, v9, v11
    v_cvt_pk_bf16_f32 v16, v8, v9
    v_lshlrev_b32 v8, 16, v13
    v_and_b32 v9, 0xffff0000, v13
    v_lshlrev_b32 v10, 16, v15
    v_and_b32 v11, 0xffff0000, v15
    v_add_f32 v8, v8, v10
    v_add_f32 v9, v9, v11
    v_cvt_pk_bf16_f32 v17, v8, v9
    buffer_store_dwordx2 v[16:17], v171, s[76:79], 0 offen offset:1024
    v_accvgpr_read_b32 v20, a12
    v_accvgpr_read_b32 v21, a13
    v_accvgpr_read_b32 v22, a14
    v_accvgpr_read_b32 v23, a15
    v_and_b32 v8, 0xffff0000, v39
    v_lshlrev_b32 v9, 16, v39
    v_and_b32 v10, 0xffff0000, v38
    v_lshlrev_b32 v11, 16, v38
    v_mul_f32 v8, s73, v8
    v_mul_f32 v9, s73, v9
    v_mul_f32 v10, s73, v10
    v_mul_f32 v11, s73, v11
    v_cvt_pk_bf16_f32 v12, v8, v9
    v_cvt_pk_bf16_f32 v13, v10, v11
    v_cvt_pk_bf16_f32 v14, v20, v21
    v_cvt_pk_bf16_f32 v15, v22, v23
    v_lshlrev_b32 v8, 16, v12
    v_and_b32 v9, 0xffff0000, v12
    v_lshlrev_b32 v10, 16, v14
    v_and_b32 v11, 0xffff0000, v14
    v_add_f32 v8, v8, v10
    v_add_f32 v9, v9, v11
    v_cvt_pk_bf16_f32 v18, v8, v9
    v_lshlrev_b32 v8, 16, v13
    v_and_b32 v9, 0xffff0000, v13
    v_lshlrev_b32 v10, 16, v15
    v_and_b32 v11, 0xffff0000, v15
    v_add_f32 v8, v8, v10
    v_add_f32 v9, v9, v11
    v_cvt_pk_bf16_f32 v19, v8, v9
    buffer_store_dwordx2 v[18:19], v171, s[76:79], 0 offen offset:1536
    v_accvgpr_read_b32 v20, a16
    v_accvgpr_read_b32 v21, a17
    v_accvgpr_read_b32 v22, a18
    v_accvgpr_read_b32 v23, a19
    v_and_b32 v8, 0xffff0000, v41
    v_lshlrev_b32 v9, 16, v41
    v_and_b32 v10, 0xffff0000, v40
    v_lshlrev_b32 v11, 16, v40
    v_mul_f32 v8, s73, v8
    v_mul_f32 v9, s73, v9
    v_mul_f32 v10, s73, v10
    v_mul_f32 v11, s73, v11
    v_cvt_pk_bf16_f32 v12, v8, v9
    v_cvt_pk_bf16_f32 v13, v10, v11
    v_cvt_pk_bf16_f32 v14, v20, v21
    v_cvt_pk_bf16_f32 v15, v22, v23
    v_lshlrev_b32 v8, 16, v12
    v_and_b32 v9, 0xffff0000, v12
    v_lshlrev_b32 v10, 16, v14
    v_and_b32 v11, 0xffff0000, v14
    v_add_f32 v8, v8, v10
    v_add_f32 v9, v9, v11
    v_cvt_pk_bf16_f32 v16, v8, v9
    v_lshlrev_b32 v8, 16, v13
    v_and_b32 v9, 0xffff0000, v13
    v_lshlrev_b32 v10, 16, v15
    v_and_b32 v11, 0xffff0000, v15
    v_add_f32 v8, v8, v10
    v_add_f32 v9, v9, v11
    v_cvt_pk_bf16_f32 v17, v8, v9
    buffer_store_dwordx2 v[16:17], v171, s[76:79], 0 offen offset:2048
    v_accvgpr_read_b32 v20, a20
    v_accvgpr_read_b32 v21, a21
    v_accvgpr_read_b32 v22, a22
    v_accvgpr_read_b32 v23, a23
    v_and_b32 v8, 0xffff0000, v43
    v_lshlrev_b32 v9, 16, v43
    v_and_b32 v10, 0xffff0000, v42
    v_lshlrev_b32 v11, 16, v42
    v_mul_f32 v8, s73, v8
    v_mul_f32 v9, s73, v9
    v_mul_f32 v10, s73, v10
    v_mul_f32 v11, s73, v11
    v_cvt_pk_bf16_f32 v12, v8, v9
    v_cvt_pk_bf16_f32 v13, v10, v11
    v_cvt_pk_bf16_f32 v14, v20, v21
    v_cvt_pk_bf16_f32 v15, v22, v23
    v_lshlrev_b32 v8, 16, v12
    v_and_b32 v9, 0xffff0000, v12
    v_lshlrev_b32 v10, 16, v14
    v_and_b32 v11, 0xffff0000, v14
    v_add_f32 v8, v8, v10
    v_add_f32 v9, v9, v11
    v_cvt_pk_bf16_f32 v18, v8, v9
    v_lshlrev_b32 v8, 16, v13
    v_and_b32 v9, 0xffff0000, v13
    v_lshlrev_b32 v10, 16, v15
    v_and_b32 v11, 0xffff0000, v15
    v_add_f32 v8, v8, v10
    v_add_f32 v9, v9, v11
    v_cvt_pk_bf16_f32 v19, v8, v9
    buffer_store_dwordx2 v[18:19], v171, s[76:79], 0 offen offset:2560
    v_accvgpr_read_b32 v20, a24
    v_accvgpr_read_b32 v21, a25
    v_accvgpr_read_b32 v22, a26
    v_accvgpr_read_b32 v23, a27
    v_and_b32 v8, 0xffff0000, v45
    v_lshlrev_b32 v9, 16, v45
    v_and_b32 v10, 0xffff0000, v44
    v_lshlrev_b32 v11, 16, v44
    v_mul_f32 v8, s73, v8
    v_mul_f32 v9, s73, v9
    v_mul_f32 v10, s73, v10
    v_mul_f32 v11, s73, v11
    v_cvt_pk_bf16_f32 v12, v8, v9
    v_cvt_pk_bf16_f32 v13, v10, v11
    v_cvt_pk_bf16_f32 v14, v20, v21
    v_cvt_pk_bf16_f32 v15, v22, v23
    v_lshlrev_b32 v8, 16, v12
    v_and_b32 v9, 0xffff0000, v12
    v_lshlrev_b32 v10, 16, v14
    v_and_b32 v11, 0xffff0000, v14
    v_add_f32 v8, v8, v10
    v_add_f32 v9, v9, v11
    v_cvt_pk_bf16_f32 v16, v8, v9
    v_lshlrev_b32 v8, 16, v13
    v_and_b32 v9, 0xffff0000, v13
    v_lshlrev_b32 v10, 16, v15
    v_and_b32 v11, 0xffff0000, v15
    v_add_f32 v8, v8, v10
    v_add_f32 v9, v9, v11
    v_cvt_pk_bf16_f32 v17, v8, v9
    buffer_store_dwordx2 v[16:17], v171, s[76:79], 0 offen offset:3072
    v_accvgpr_read_b32 v20, a28
    v_accvgpr_read_b32 v21, a29
    v_accvgpr_read_b32 v22, a30
    v_accvgpr_read_b32 v23, a31
    v_and_b32 v8, 0xffff0000, v47
    v_lshlrev_b32 v9, 16, v47
    v_and_b32 v10, 0xffff0000, v46
    v_lshlrev_b32 v11, 16, v46
    v_mul_f32 v8, s73, v8
    v_mul_f32 v9, s73, v9
    v_mul_f32 v10, s73, v10
    v_mul_f32 v11, s73, v11
    v_cvt_pk_bf16_f32 v12, v8, v9
    v_cvt_pk_bf16_f32 v13, v10, v11
    v_cvt_pk_bf16_f32 v14, v20, v21
    v_cvt_pk_bf16_f32 v15, v22, v23
    v_lshlrev_b32 v8, 16, v12
    v_and_b32 v9, 0xffff0000, v12
    v_lshlrev_b32 v10, 16, v14
    v_and_b32 v11, 0xffff0000, v14
    v_add_f32 v8, v8, v10
    v_add_f32 v9, v9, v11
    v_cvt_pk_bf16_f32 v18, v8, v9
    v_lshlrev_b32 v8, 16, v13
    v_and_b32 v9, 0xffff0000, v13
    v_lshlrev_b32 v10, 16, v15
    v_and_b32 v11, 0xffff0000, v15
    v_add_f32 v8, v8, v10
    v_add_f32 v9, v9, v11
    v_cvt_pk_bf16_f32 v19, v8, v9
    buffer_store_dwordx2 v[18:19], v171, s[76:79], 0 offen offset:3584
    s_endpgm
L_gemm2_kernel_exit:
    s_endpgm
.globl final_kernel
.p2align 8
.type final_kernel,@function
final_kernel:

    s_cmp_ge_u32 s2, 1152
    s_cbranch_scc1 L_final_kernel_exit
    s_load_dwordx2 s[4:5], s[0:1], 0
    s_load_dwordx2 s[6:7], s[0:1], 80
    s_load_dwordx2 s[10:11], s[0:1], 96
    v_lshrrev_b32 v1, 6, v0
    v_and_b32 v2, 63, v0
    v_readfirstlane_b32 s12, v1
    s_lshl_b32 s13, s2, 2
    s_nop 1
    s_add_u32 s13, s13, s12
    s_mov_b32 s14, 0x71c71c8
    s_mul_hi_u32 s15, s13, s14
    s_mul_i32 s16, s15, 36
    s_sub_u32 s16, s13, s16
    s_waitcnt lgkmcnt(0)
    s_mov_b32 s20, s4
    s_mov_b32 s21, s5
    s_mov_b32 s22, 2359296
    s_mov_b32 s23, 0x00020000
    s_mov_b32 s24, s6
    s_mov_b32 s25, s7
    s_mov_b32 s26, 2359296
    s_mov_b32 s27, 0x00020000
    s_add_u32 s28, s10, 2359296
    s_addc_u32 s29, s11, 0
    s_mov_b32 s30, 2359296
    s_mov_b32 s31, 0x00020000
    s_add_u32 s32, s10, 4718592
    s_addc_u32 s33, s11, 0
    s_mov_b32 s34, 2359296
    s_mov_b32 s35, 0x00020000
    s_add_u32 s36, s10, 25952256
    s_addc_u32 s37, s11, 0
    s_mov_b32 s38, 18874368
    s_mov_b32 s39, 0x00020000
    s_lshl_b32 s17, s13, 10
    v_lshlrev_b32 v3, 4, v2
    v_add_u32 v3, s17, v3
    s_mov_b32 s18, 0
    buffer_load_dwordx4 v[8:11], v3, s[36:39], s18 offen
    s_mov_b32 s18, 4718592
    buffer_load_dwordx4 v[12:15], v3, s[36:39], s18 offen
    s_mov_b32 s18, 9437184
    buffer_load_dwordx4 v[16:19], v3, s[36:39], s18 offen
    s_mov_b32 s18, 14155776
    buffer_load_dwordx4 v[20:23], v3, s[36:39], s18 offen
    v_and_b32 v4, 15, v2
    s_lshl_b32 s17, s15, 4
    v_add_u32 v4, s17, v4
    s_movk_i32 s18, 1152
    v_mul_lo_u32 v4, v4, s18
    v_lshrrev_b32 v5, 4, v2
    v_lshl_add_u32 v4, v5, 3, v4
    s_lshl_b32 s17, s16, 5
    v_add_u32 v4, s17, v4
    buffer_load_dwordx2 v[24:25], v4, s[20:23], 0 offen
    buffer_load_dwordx2 v[26:27], v4, s[28:31], 0 offen
    s_lshl_b32 s17, s16, 16
    s_lshl_b32 s18, s15, 5
    s_add_u32 s17, s17, s18
    v_lshlrev_b32 v5, 14, v5
    v_and_b32 v6, 15, v2
    v_lshl_add_u32 v5, v6, 1, v5
    v_add_u32 v5, s17, v5
    v_mov_b32 v40, 0
    v_mov_b32 v41, 0
    v_mov_b32 v42, 0
    v_mov_b32 v43, 0
    s_movk_i32 s17, 4096
    s_movk_i32 s18, 8192
    s_movk_i32 s19, 12288
    buffer_load_short_d16_hi v40, v5, s[32:35], 0 offen
    buffer_load_short_d16_hi v41, v5, s[32:35], s17 offen
    buffer_load_short_d16_hi v42, v5, s[32:35], s18 offen
    buffer_load_short_d16_hi v43, v5, s[32:35], s19 offen
    s_waitcnt vmcnt(0) lgkmcnt(0)
    v_add_f32 v8, v8, v12
    v_add_f32 v16, v16, v20
    v_add_f32 v8, v8, v16
    v_add_f32 v9, v9, v13
    v_add_f32 v17, v17, v21
    v_add_f32 v9, v9, v17
    v_add_f32 v10, v10, v14
    v_add_f32 v18, v18, v22
    v_add_f32 v10, v10, v18
    v_add_f32 v11, v11, v15
    v_add_f32 v19, v19, v23
    v_add_f32 v11, v11, v19
    v_cvt_pk_bf16_f32 v12, v8, v9
    v_cvt_pk_bf16_f32 v13, v10, v11
    v_lshlrev_b32 v30, 16, v26
    v_and_b32 v31, 0xffff0000, v26
    v_mul_f32 v30, v30, v40
    v_mul_f32 v31, v31, v41
    v_cvt_pk_bf16_f32 v34, v30, v31
    v_lshlrev_b32 v30, 16, v34
    v_and_b32 v31, 0xffff0000, v34
    v_lshlrev_b32 v32, 16, v24
    v_and_b32 v33, 0xffff0000, v24
    v_add_f32 v30, v30, v32
    v_add_f32 v31, v31, v33
    v_cvt_pk_bf16_f32 v34, v30, v31
    v_lshlrev_b32 v30, 16, v34
    v_and_b32 v31, 0xffff0000, v34
    v_lshlrev_b32 v32, 16, v12
    v_and_b32 v33, 0xffff0000, v12
    v_add_f32 v30, v30, v32
    v_add_f32 v31, v31, v33
    v_cvt_pk_bf16_f32 v36, v30, v31
    v_lshlrev_b32 v30, 16, v27
    v_and_b32 v31, 0xffff0000, v27
    v_mul_f32 v30, v30, v42
    v_mul_f32 v31, v31, v43
    v_cvt_pk_bf16_f32 v34, v30, v31
    v_lshlrev_b32 v30, 16, v34
    v_and_b32 v31, 0xffff0000, v34
    v_lshlrev_b32 v32, 16, v25
    v_and_b32 v33, 0xffff0000, v25
    v_add_f32 v30, v30, v32
    v_add_f32 v31, v31, v33
    v_cvt_pk_bf16_f32 v34, v30, v31
    v_lshlrev_b32 v30, 16, v34
    v_and_b32 v31, 0xffff0000, v34
    v_lshlrev_b32 v32, 16, v13
    v_and_b32 v33, 0xffff0000, v13
    v_add_f32 v30, v30, v32
    v_add_f32 v31, v31, v33
    v_cvt_pk_bf16_f32 v37, v30, v31
    buffer_store_dwordx2 v[36:37], v4, s[24:27], 0 offen
L_final_kernel_exit:
    s_endpgm
.section .rodata,"a"
.p2align 6
.amdhsa_kernel prep_kernel
  .amdhsa_next_free_vgpr 128
  .amdhsa_next_free_sgpr 96
  .amdhsa_accum_offset 128
  .amdhsa_group_segment_fixed_size 0
  .amdhsa_kernarg_size 104
  .amdhsa_user_sgpr_count 2
  .amdhsa_user_sgpr_kernarg_segment_ptr 1
  .amdhsa_system_sgpr_workgroup_id_x 1
.end_amdhsa_kernel
.p2align 6
.amdhsa_kernel gemm1_kernel
  .amdhsa_next_free_vgpr 428
  .amdhsa_next_free_sgpr 96
  .amdhsa_accum_offset 172
  .amdhsa_group_segment_fixed_size 0
  .amdhsa_kernarg_size 104
  .amdhsa_user_sgpr_count 2
  .amdhsa_user_sgpr_kernarg_segment_ptr 1
  .amdhsa_system_sgpr_workgroup_id_x 1
.end_amdhsa_kernel
.p2align 6
.amdhsa_kernel gemm2_kernel
  .amdhsa_next_free_vgpr 256
  .amdhsa_next_free_sgpr 96
  .amdhsa_accum_offset 176
  .amdhsa_group_segment_fixed_size 0
  .amdhsa_kernarg_size 104
  .amdhsa_user_sgpr_count 2
  .amdhsa_user_sgpr_kernarg_segment_ptr 1
  .amdhsa_system_sgpr_workgroup_id_x 1
.end_amdhsa_kernel
.p2align 6
.amdhsa_kernel final_kernel
  .amdhsa_next_free_vgpr 44
  .amdhsa_next_free_sgpr 48
  .amdhsa_accum_offset 44
  .amdhsa_group_segment_fixed_size 0
  .amdhsa_kernarg_size 104
  .amdhsa_user_sgpr_count 2
  .amdhsa_user_sgpr_kernarg_segment_ptr 1
  .amdhsa_system_sgpr_workgroup_id_x 1
.end_amdhsa_kernel
```
